```python
import torch

def _softmax(x, axis=-1):
    return torch.softmax(x, dim=axis)
def _gelu(x):
    return torch.nn.functional.gelu(x, approximate="tanh")
def _silu(x):
    return torch.nn.functional.silu(x)
def _sigmoid(x):
    return torch.sigmoid(x)
def _layernorm(x, axis=-1, eps=1e-5):
    m = x.mean(dim=axis, keepdim=True)
    v = x.var(dim=axis, keepdim=True, unbiased=False)
    return (x - m) / torch.sqrt(v + eps)
def _scatter_add(tgt, idx, src, axis=0):
    return tgt.clone().index_add_(axis, idx, src)
def _segment_sum(src, seg, n):
    out = torch.zeros((n,) + src.shape[1:], dtype=src.dtype)
    return out.index_add_(0, seg, src)
def _pad(x, pw):
    flat = tuple(v for pair in reversed(pw) for v in pair)
    return torch.nn.functional.pad(x, flat)

kernel_name = 'interleave_layers__linear_attn_block__grouped_kv_mqa__prompt'

def setup_inputs():

    _w = (lambda a: (lambda t: t.to(torch.bfloat16) if t.is_floating_point() else t)(torch.as_tensor(a)))
    def _A_setup():
        B, S, D = 1, 2048, 640
        return {
            "x": _w((lambda *s: torch.randn(*s, dtype=torch.bfloat16) * 0.05)(B, S, D)),
            "wqkv": _w((lambda *s: torch.randn(*s, dtype=torch.bfloat16) * 0.1)(D, 3 * D)),
            "wo": _w((lambda *s: torch.randn(*s, dtype=torch.bfloat16) * 0.05)(D, D)),
        }
    _A_in = _A_setup()

    def _B_setup():
        B, S, D, H = 1, 2048, 640, 32
        Dh = D // H
        return {
            "x": _w((lambda *s: torch.randn(*s, dtype=torch.bfloat16) * 0.05)(B, S, D)),
            "wq": _w((lambda *s: torch.randn(*s, dtype=torch.bfloat16) * 0.1)(D, H * Dh)),
            "wk": _w((lambda *s: torch.randn(*s, dtype=torch.bfloat16) * 0.1)(D, Dh)),
            "wv": _w((lambda *s: torch.randn(*s, dtype=torch.bfloat16) * 0.05)(D, Dh)),
            "wo": _w((lambda *s: torch.randn(*s, dtype=torch.bfloat16) * 0.05)(H * Dh, D)),
        }
    _B_in = _B_setup()

    return {
        "A_x": _A_in["x"],
        "A_wqkv": _A_in["wqkv"],
        "A_wo": _A_in["wo"],
        "B_x": _B_in["x"],
        "B_wq": _B_in["wq"],
        "B_wk": _B_in["wk"],
        "B_wv": _B_in["wv"],
        "B_wo": _B_in["wo"],
    }

def reference(A_x, A_wqkv, A_wo, B_x, B_wq, B_wk, B_wv, B_wo):
    def _A_ref(x, wqkv, wo):
        B, S, D = x.shape
        H = 32; Dh = D // H
        qkv = (lambda x, *d: x.permute(*d))((x @ wqkv).reshape(B, S, 3, H, Dh), 2, 0, 3, 1, 4)
        q, k, v = qkv[0], qkv[1], qkv[2]
        phi = lambda t: torch.where(t > 0, t + 1, torch.exp(t)) + 1e-6
        pq, pk = phi(q), phi(k)
        kv = torch.einsum("bhsd,bhse->bhde", pk, v)
        z = torch.einsum("bhsd->bhd", pk)
        num = torch.einsum("bhqd,bhde->bhqe", pq, kv)
        den = torch.einsum("bhqd,bhd->bhq", pq, z)[..., None] + 1e-6
        o = num / den
        return (lambda x, *d: x.permute(*d))(o, 0, 2, 1, 3).reshape(B, S, D) @ wo

    def _B_ref(x, wq, wk, wv, wo):
        B, S, D = x.shape
        H = 32
        Dh = D // H
        q = (lambda x, *d: x.permute(*d))((x @ wq).reshape(B, S, H, Dh), 0, 2, 1, 3)
        k = x @ wk
        v = x @ wv
        scores = torch.einsum("bhqd,bkd->bhqk", q, k) * (Dh ** -0.5)
        p = _softmax(scores, axis=-1)
        o = torch.einsum("bhqk,bkd->bhqd", p, v)
        return (lambda x, *d: x.permute(*d))(o, 0, 2, 1, 3).reshape(B, S, H * Dh) @ wo

    x = A_x
    x = x + _A_ref(_layernorm(x, axis=-1), A_wqkv, A_wo)
    x = x + _B_ref(_layernorm(x, axis=-1), B_wq, B_wk, B_wv, B_wo)
    x = x + _A_ref(_layernorm(x, axis=-1), A_wqkv, A_wo)
    x = x + _B_ref(_layernorm(x, axis=-1), B_wq, B_wk, B_wv, B_wo)
    return x
```

```asm
; @launch grid=(256,1,1) block=(256,1,1) lds=163840
.amdgcn_target "amdgcn-amd-amdhsa--gfx950"
.text
.globl interleave_layers__linear_attn_block__grouped_kv_mqa__prompt_kernel
.p2align 8
.type interleave_layers__linear_attn_block__grouped_kv_mqa__prompt_kernel,@function
interleave_layers__linear_attn_block__grouped_kv_mqa__prompt_kernel:
    s_cmp_ge_u32 s2, 256
    s_cbranch_scc1 L_abort
    s_load_dwordx16 s[64:79], s[0:1], 0
    s_load_dwordx4 s[80:83], s[0:1], 64
    s_load_dwordx2 s[84:85], s[0:1], 80
    v_lshrrev_b32 v1, 6, v0
    v_and_b32 v0, 63, v0
    s_mov_b32 s30, s2
    v_readfirstlane_b32 s22, v1
    v_lshlrev_b32 v1, 4, v0
    v_and_b32 v2, 15, v0
    v_lshrrev_b32 v3, 4, v0
    s_and_b32 s40, s2, 7
    s_lshr_b32 s41, s2, 3
    s_lshl_b32 s23, s40, 2
    s_lshr_b32 s42, s41, 3
    s_add_u32 s23, s23, s42
    s_and_b32 s24, s41, 7
    s_lshr_b32 s25, s40, 1
    s_lshl_b32 s25, s25, 2
    s_lshr_b32 s42, s41, 3
    s_add_u32 s25, s25, s42
    s_and_b32 s26, s40, 1
    s_lshl_b32 s26, s26, 3
    s_add_u32 s26, s26, s24
    s_lshl_b32 s29, s23, 2
    s_add_u32 s29, s29, s22
    s_mov_b32 s27, 0
    s_mov_b32 s19, 0x00020000
    s_lshr_b32 s92, s30, 3
    s_and_b32 s100, s30, 7
    s_mov_b32 s57, 0
    s_mov_b32 s56, 3
    s_mov_b32 s63, 0
    s_mov_b32 s95, 8
    s_mov_b32 s96, 16
    s_mov_b32 s97, 4
    v_lshrrev_b32 v12, 1, v0
    v_and_b32 v13, 3, v12
    v_bfe_u32 v14, v12, 2, 1
    v_bfe_u32 v15, v12, 3, 1
    v_lshrrev_b32 v16, 4, v12
    v_and_b32 v17, 1, v0
    s_cmp_lt_u32 s22, 2
    s_cbranch_scc1 L_px
    s_cmp_lt_u32 s92, 20
    s_cbranch_scc0 L_pn
    s_mov_b32 s56, 0
    s_lshl_b32 s57, s100, 8
    s_lshl_b32 s50, s92, 3
    s_add_u32 s57, s57, s50
    s_add_u32 s57, s57, 1024
    s_lshl_b32 s100, s100, 1
    s_add_u32 s100, s100, s22
    s_sub_u32 s100, s100, 2
    s_lshl_b32 s58, s22, 13
    s_lshl_b32 s94, s92, 5
    s_mul_i32 s98, s100, 80
    v_add_u32 v18, s94, v13
    v_mad_u32_u24 v18, v14, s95, v18
    v_mad_u32_u24 v18, v15, s96, v18
    v_mad_u32_u24 v18, v16, s97, v18
    v_mul_u32_u24 v18, 3840, v18
    v_lshl_add_u32 v19, v17, 4, v18
    v_mul_u32_u24 v20, 1280, v17
    v_add_u32 v20, v20, v18
    v_lshl_add_u32 v21, v17, 5, v18
    s_mov_b32 s18, 2457600
    s_waitcnt lgkmcnt(0)
    s_mov_b32 s16, s66
    s_mov_b32 s17, s67
    s_add_u32 m0, s58, 0
    s_nop 0
    buffer_load_dwordx4 v19, s[16:19], s98 offen offset:0 lds
    s_add_u32 m0, s58, 984
    s_nop 0
    buffer_load_dwordx4 v19, s[16:19], s98 offen offset:40 lds
    s_add_u32 m0, s58, 768
    s_nop 0
    buffer_load_dwordx4 v19, s[16:19], s98 offen offset:1280 lds
    s_add_u32 m0, s58, 1760
    s_nop 0
    buffer_load_dwordx4 v19, s[16:19], s98 offen offset:1312 lds
    s_add_u32 m0, s58, 2752
    s_nop 0
    buffer_load_dwordx4 v20, s[16:19], s98 offen offset:1344 lds
    s_add_u32 m0, s58, 2560
    s_nop 0
    buffer_load_dwordx4 v19, s[16:19], s98 offen offset:2560 lds
    s_add_u32 m0, s58, 3552
    s_nop 0
    buffer_load_dwordx4 v19, s[16:19], s98 offen offset:2592 lds
    s_add_u32 m0, s58, 7136
    s_nop 0
    buffer_load_dwordx4 v21, s[16:19], s98 offen offset:32 lds
    s_mul_i32 s99, s100, 153600
    s_add_u32 s99, s99, 1048576
    s_mul_i32 s50, s92, 2560
    s_add_u32 s37, s99, s50
    s_add_u32 s37, s37, 102400
    s_mul_i32 s50, s92, 5120
    s_add_u32 s99, s99, s50
    s_mul_i32 s63, s100, 10240
    s_lshl_b32 s50, s92, 9
    s_add_u32 s63, s63, s50
    s_add_u32 s63, s63, 65536
    s_branch L_pn
L_px:
    s_lshl_b32 s37, s25, 3
    s_lshr_b32 s50, s26, 1
    s_add_u32 s37, s37, s50
    s_and_b32 s38, s26, 1
    s_lshl_b32 s38, s38, 1
    s_add_u32 s38, s38, s22
    s_mul_i32 s50, s37, 20480
    s_mul_i32 s51, s38, 320
    s_add_u32 s50, s50, s51
    v_mul_u32_u24 v8, 1280, v2
    v_lshl_add_u32 v8, v3, 4, v8
    s_mov_b32 s10, 2621440
    s_mov_b32 s11, 0x00020000
    s_waitcnt lgkmcnt(0)
    s_mov_b32 s8, s64
    s_mov_b32 s9, s65
    buffer_load_dwordx4 v[160:163], v8, s[8:11], s50 offen offset:0
    buffer_load_dwordx4 v[164:167], v8, s[8:11], s50 offen offset:64
    buffer_load_dwordx4 v[168:171], v8, s[8:11], s50 offen offset:128
    buffer_load_dwordx4 v[172:175], v8, s[8:11], s50 offen offset:192
    buffer_load_dwordx4 v[176:179], v8, s[8:11], s50 offen offset:256
L_pn:
    s_waitcnt lgkmcnt(0)
    s_load_dwordx2 s[20:21], s[84:85], 0
    s_mov_b32 s4, s84
    s_mov_b32 s5, s85
    s_mov_b32 s6, 0x10000000
    s_mov_b32 s7, 0x00020000
    s_mov_b32 s88, s84
    s_mov_b32 s89, s85
    s_mov_b32 s90, 16777216
    s_mov_b32 s91, 0x00020000
    s_mov_b32 s8, s64
    s_mov_b32 s9, s65
    s_mov_b32 s10, 2621440
    s_mov_b32 s11, 0x00020000
    s_mov_b32 s12, s80
    s_mov_b32 s13, s81
    s_mov_b32 s14, 2621440
    s_mov_b32 s15, 0x00020000
    s_mov_b32 s32, 0x3fb8aa3b
    s_mov_b32 s33, 0x3fb8aa3b
    s_mov_b32 s34, 0xffff
    s_mov_b32 s35, 0
    s_cmp_eq_u32 s22, 1
    s_cbranch_scc0 L_pf
    s_lshl_b32 s50, s30, 9
    s_add_u32 s50, s50, 12582912
    v_lshlrev_b32 v9, 7, v0
    s_mov_b64 exec, 7
    buffer_load_dword v31, v9, s[4:7], s50 offen
    s_mov_b64 exec, -1
L_pf:
    v_lshlrev_b32 v32, 3, v0
    v_and_b32 v8, 7, v0
    v_lshl_add_u32 v8, v3, 3, v8
    v_lshlrev_b32 v8, 4, v8
    v_add_u32 v35, 104448, v8
    v_mov_b32 v243, 0
    v_lshlrev_b32 v54, 3, v2
    v_mov_b32 v8, 0x3f803f80
    v_mov_b32 v9, 0x3f803f80
    v_mov_b32 v10, 0x3f803f80
    v_mov_b32 v11, 0x3f803f80
    s_cmp_lt_u32 s22, 2
    s_waitcnt lgkmcnt(0)
    s_cbranch_scc1 L_px2
    s_cmp_eq_u32 s56, 0
    s_cbranch_scc0 L_pJ0
    v_add_u32 v12, s58, v32
    v_lshrrev_b32 v13, 2, v0
    v_lshlrev_b32 v13, 5, v13
    v_add_u32 v13, s58, v13
    v_and_b32 v17, 1, v0
    v_bfe_u32 v15, v0, 1, 1
    v_lshl_add_u32 v15, v15, 10, v13
    v_lshl_add_u32 v15, v17, 4, v15
    v_subrev_u32 v16, 104448, v35
    v_lshlrev_b32 v18, 2, v0
    v_cmp_eq_u32 s[48:49], 1, v3
    v_cmp_eq_u32 s[52:53], 2, v3
    v_cmp_eq_u32 s[46:47], 3, v3
    s_add_u32 s50, s99, 4096
    s_add_u32 s51, s63, 256
    v_mul_u32_u24 v14, 24, v17
    v_add_u32 v14, v14, v13
    s_waitcnt vmcnt(0)
    ds_read_b64_tr_b16 v[128:129], v12 offset:0
    ds_read_b64_tr_b16 v[130:131], v12 offset:512
    ds_read_b64_tr_b16 v[132:133], v12 offset:1024
    ds_read_b64_tr_b16 v[134:135], v12 offset:1536
    ds_read_b64_tr_b16 v[136:137], v12 offset:2048
    ds_read_b64_tr_b16 v[138:139], v12 offset:2560
    ds_read_b64_tr_b16 v[140:141], v12 offset:3072
    ds_read_b64_tr_b16 v[142:143], v12 offset:3584
    ds_read_b64_tr_b16 v[144:145], v12 offset:4096
    ds_read_b64_tr_b16 v[146:147], v12 offset:4608
    ds_read_b64_tr_b16 v[148:149], v12 offset:5120
    ds_read_b64_tr_b16 v[150:151], v12 offset:5632
    ds_read_b64_tr_b16 v[152:153], v12 offset:6144
    ds_read_b64_tr_b16 v[154:155], v12 offset:6656
    ds_read_b64_tr_b16 v[156:157], v14 offset:7168
    ds_read_b64_tr_b16 v[158:159], v14 offset:7680
    s_waitcnt lgkmcnt(14)
    buffer_store_dwordx4 v[128:131], v1, s[4:7], s37 offen offset:0 sc1
    s_waitcnt lgkmcnt(12)
    buffer_store_dwordx4 v[132:135], v1, s[4:7], s37 offen offset:1024 sc1
    s_waitcnt lgkmcnt(10)
    buffer_store_dwordx4 v[136:139], v1, s[4:7], s99 offen offset:0 sc1
    s_waitcnt lgkmcnt(8)
    buffer_store_dwordx4 v[140:143], v1, s[4:7], s99 offen offset:1024 sc1
    s_waitcnt lgkmcnt(6)
    buffer_store_dwordx4 v[144:147], v1, s[4:7], s99 offen offset:2048 sc1
    s_waitcnt lgkmcnt(4)
    buffer_store_dwordx4 v[148:151], v1, s[4:7], s99 offen offset:3072 sc1
    s_waitcnt lgkmcnt(2)
    buffer_store_dwordx4 v[152:155], v1, s[4:7], s50 offen offset:0 sc1
    s_waitcnt lgkmcnt(0)
    s_mov_b32 exec_lo, 0xff00ff
    s_mov_b32 exec_hi, 0xff00ff
    buffer_store_dwordx4 v[156:159], v16, s[4:7], s37 offen offset:2048 sc1
    s_mov_b64 exec, -1
    v_mfma_f32_16x16x32_bf16 v[64:67], v[8:11], v[128:131], 0
    v_mfma_f32_16x16x32_bf16 v[68:71], v[8:11], v[132:135], 0
    v_mfma_f32_16x16x32_bf16 v[72:75], v[8:11], v[136:139], 0
    v_mfma_f32_16x16x32_bf16 v[76:79], v[8:11], v[140:143], 0
    v_mfma_f32_16x16x32_bf16 v[80:83], v[8:11], v[144:147], 0
    v_mfma_f32_16x16x32_bf16 v[84:87], v[8:11], v[148:151], 0
    v_mfma_f32_16x16x32_bf16 v[88:91], v[8:11], v[152:155], 0
    v_mfma_f32_16x16x32_bf16 v[92:95], v[8:11], v[156:159], 0
    s_nop 1
    v_cndmask_b32 v64, v64, v68, s[48:49]
    v_cndmask_b32 v64, v64, v72, s[52:53]
    v_cndmask_b32 v64, v64, v76, s[46:47]
    buffer_store_dword v64, v18, s[4:7], s63 offen sc1
    v_cndmask_b32 v80, v80, v84, s[48:49]
    v_cndmask_b32 v80, v80, v88, s[52:53]
    v_cndmask_b32 v80, v80, v92, s[46:47]
    buffer_store_dword v80, v18, s[4:7], s51 offen sc1
    s_waitcnt vmcnt(0)
    s_branch L_pJ0
L_px2:
    s_mul_i32 s50, s37, 20480
    s_mul_i32 s51, s38, 5120
    s_add_u32 s50, s50, s51
    s_add_u32 s50, s50, 9437184
    s_add_u32 s51, s50, 4096
    v_and_b32 v6, 3, v2
    v_lshrrev_b32 v7, 2, v2
    v_cmp_eq_u32 s[40:41], 1, v6
    v_cmp_eq_u32 s[42:43], 2, v6
    v_cmp_eq_u32 s[44:45], 3, v6
    v_cmp_eq_u32 s[46:47], v7, v3
    s_waitcnt vmcnt(0)
    buffer_store_dwordx4 v[160:163], v1, s[4:7], s50 offen offset:0 sc1
    v_mfma_f32_16x16x32_bf16 v[96:99], v[8:11], v[160:163], 0
    v_mfma_f32_16x16x32_bf16 v[100:103], v[160:163], v[160:163], 0
    buffer_store_dwordx4 v[164:167], v1, s[4:7], s50 offen offset:1024 sc1
    v_mfma_f32_16x16x32_bf16 v[96:99], v[8:11], v[164:167], v[96:99]
    v_mfma_f32_16x16x32_bf16 v[100:103], v[164:167], v[164:167], v[100:103]
    buffer_store_dwordx4 v[168:171], v1, s[4:7], s50 offen offset:2048 sc1
    v_mfma_f32_16x16x32_bf16 v[96:99], v[8:11], v[168:171], v[96:99]
    v_mfma_f32_16x16x32_bf16 v[100:103], v[168:171], v[168:171], v[100:103]
    buffer_store_dwordx4 v[172:175], v1, s[4:7], s50 offen offset:3072 sc1
    v_mfma_f32_16x16x32_bf16 v[96:99], v[8:11], v[172:175], v[96:99]
    v_mfma_f32_16x16x32_bf16 v[100:103], v[172:175], v[172:175], v[100:103]
    buffer_store_dwordx4 v[176:179], v1, s[4:7], s51 offen offset:0 sc1
    v_mfma_f32_16x16x32_bf16 v[96:99], v[8:11], v[176:179], v[96:99]
    v_mfma_f32_16x16x32_bf16 v[100:103], v[176:179], v[176:179], v[100:103]
    s_lshl_b32 s50, s37, 11
    s_lshl_b32 s51, s38, 8
    s_add_u32 s50, s50, s51
    s_add_u32 s50, s50, 12058624
    v_mov_b32 v4, 0
    v_mov_b32 v5, 0
    v_lshlrev_b32 v20, 4, v2
    s_nop 0
    v_cndmask_b32 v97, v100, v101, s[40:41]
    v_cndmask_b32 v97, v97, v102, s[42:43]
    v_cndmask_b32 v97, v97, v103, s[44:45]
    s_mov_b64 exec, s[46:47]
    buffer_store_dwordx4 v[96:99], v20, s[4:7], s50 offen sc1
    buffer_store_dwordx4 v[4:7], v20, s[4:7], s50 offen offset:1024 sc1
    s_mov_b64 exec, -1
    s_mul_i32 s50, s92, 26
    s_lshr_b32 s50, s50, 8
    s_mul_i32 s51, s50, 10
    s_sub_u32 s51, s92, s51
    s_mov_b32 s92, s50
    s_mul_i32 s58, s22, 5120
    s_add_u32 s58, s58, 133120
    s_cmp_lt_u32 s92, 3
    s_cbranch_scc1 L_pB
    s_lshl_b32 s51, s51, 3
    s_add_u32 s51, s51, s100
    s_cmp_lt_u32 s51, 10
    s_cbranch_scc1 L_pE
    s_waitcnt vmcnt(0)
    s_branch L_pJ0
L_pE:
    s_mov_b32 s56, 2
    s_lshl_b32 s93, s51, 1
    s_add_u32 s93, s93, s22
    s_lshl_b32 s94, s93, 5
    s_mov_b32 s18, 25600
    v_add_u32 v18, s94, v13
    v_mad_u32_u24 v18, v14, s95, v18
    v_mad_u32_u24 v18, v15, s96, v18
    v_mad_u32_u24 v18, v16, s97, v18
    v_mul_u32_u24 v18, 40, v18
    v_lshl_add_u32 v19, v17, 4, v18
    s_mov_b32 s16, s74
    s_mov_b32 s17, s75
    s_mov_b32 m0, s58
    s_nop 0
    buffer_load_dwordx4 v19, s[16:19], 0 offen lds
    s_add_u32 m0, s58, 992
    s_nop 0
    buffer_load_dwordx4 v18, s[16:19], 0 offen offset:32 lds
    s_mov_b32 s16, s76
    s_mov_b32 s17, s77
    s_add_u32 m0, s58, 2048
    s_nop 0
    buffer_load_dwordx4 v19, s[16:19], 0 offen lds
    s_add_u32 m0, s58, 3040
    s_nop 0
    buffer_load_dwordx4 v18, s[16:19], 0 offen offset:32 lds
    s_mul_i32 s99, s93, 1536
    s_add_u32 s99, s99, 7340032
    s_lshl_b32 s63, s93, 9
    s_add_u32 s63, s63, 393216
    s_waitcnt vmcnt(4)
    s_branch L_pJ0
L_pB:
    s_mov_b32 s56, 1
    s_lshl_b32 s93, s51, 1
    s_add_u32 s93, s93, s22
    s_mov_b32 s18, 819200
    s_cmp_eq_u32 s92, 0
    s_cbranch_scc1 L_pB0
    s_cmp_eq_u32 s92, 1
    s_cbranch_scc1 L_pB1
    s_mov_b32 s16, s78
    s_mov_b32 s17, s79
    s_mov_b32 s99, 6291456
    s_mul_i32 s50, s93, 52
    s_lshr_b32 s50, s50, 8
    s_mul_i32 s51, s50, 5
    s_sub_u32 s51, s93, s51
    s_mul_i32 s94, s50, 160
    s_mov_b32 s95, 20
    s_cmp_eq_u32 s51, 2
    s_cbranch_scc1 L_pD2
    s_cmp_gt_u32 s51, 2
    s_cselect_b32 s52, 1, 0
    s_sub_u32 s51, s51, s52
    s_mul_i32 s51, s51, 40
    s_add_u32 s94, s94, s51
    s_mov_b32 s96, 4
    s_mov_b32 s97, 8
    s_branch L_pBc
L_pD2:
    s_add_u32 s94, s94, 16
    s_mov_b32 s96, 80
    s_mov_b32 s97, 40
    s_branch L_pBc
L_pB1:
    s_mov_b32 s16, s72
    s_mov_b32 s17, s73
    s_mov_b32 s99, 5242880
    s_lshl_b32 s94, s93, 5
    s_mul_i32 s63, s100, 10240
    s_lshl_b32 s50, s93, 9
    s_add_u32 s63, s63, s50
    s_add_u32 s63, s63, 262144
    s_branch L_pBc
L_pB0:
    s_mov_b32 s16, s68
    s_mov_b32 s17, s69
    s_mov_b32 s99, 4194304
    s_mov_b32 s97, 20
    s_cmp_lt_u32 s93, 16
    s_cbranch_scc1 L_pB0a
    s_sub_u32 s50, s93, 16
    s_mul_i32 s94, s50, 160
    s_add_u32 s94, s94, 16
    s_mov_b32 s95, 40
    s_mov_b32 s96, 80
    s_branch L_pBc
L_pB0a:
    s_mul_i32 s94, s93, 40
    s_mov_b32 s95, 4
    s_mov_b32 s96, 8
L_pBc:
    s_mul_i32 s98, s100, 160
    s_and_b32 s50, s100, 1
    s_cmp_eq_u32 s50, 1
    s_cselect_b32 s51, 0, 128
    s_add_u32 s51, s51, s98
    s_lshl_b32 s50, s50, 5
    s_add_u32 s98, s98, s50
    v_add_u32 v18, s94, v13
    v_mad_u32_u24 v18, v14, s95, v18
    v_mad_u32_u24 v18, v15, s96, v18
    v_mad_u32_u24 v18, v16, s97, v18
    v_mul_u32_u24 v18, 1280, v18
    v_lshl_add_u32 v19, v17, 4, v18
    s_add_u32 m0, s58, 0
    s_nop 0
    buffer_load_dwordx4 v19, s[16:19], s98 offen offset:0 lds
    s_add_u32 m0, s58, 992
    s_nop 0
    buffer_load_dwordx4 v19, s[16:19], s98 offen offset:32 lds
    s_add_u32 m0, s58, 1984
    s_nop 0
    buffer_load_dwordx4 v19, s[16:19], s98 offen offset:64 lds
    s_add_u32 m0, s58, 2976
    s_nop 0
    buffer_load_dwordx4 v19, s[16:19], s98 offen offset:96 lds
    s_add_u32 m0, s58, 4096
    s_nop 0
    buffer_load_dwordx4 v19, s[16:19], s51 offen lds
    s_mul_i32 s50, s100, 102400
    s_add_u32 s99, s99, s50
    s_mul_i32 s50, s93, 5120
    s_add_u32 s99, s99, s50
    s_waitcnt vmcnt(5)
    s_branch L_pJ0
L_pJ0:
    s_add_u32 s20, s20, 0x7f4a7c15
    s_addc_u32 s21, s21, 0x9e3779b9
    v_mov_b32 v4, s20
    v_mov_b32 v5, s21
    v_and_b32 v18, 15, v0
    v_and_b32 v19, 7, v0
    v_lshrrev_b32 v6, 3, v18
    v_lshl_add_u32 v19, v19, 3, v6
    s_lshr_b32 s46, s25, 2
    s_lshl_b32 s46, s46, 1
    s_and_b32 s47, s25, 3
    s_lshl_b32 s47, s47, 6
    s_add_u32 s46, s46, s47
    v_add_lshl_u32 v19, v19, s46, 9
    s_lshl_b32 s46, s26, 3
    s_add_u32 s46, s46, 160
    v_add_u32 v19, s46, v19
    v_lshrrev_b32 v6, 2, v18
    v_lshlrev_b32 v6, 1, v6
    v_and_b32 v18, 3, v18
    v_lshl_add_u32 v6, v18, 6, v6
    s_and_b32 s46, s30, 7
    s_lshl_b32 s46, s46, 1
    v_and_b32 v18, 1, v3
    v_add_u32 v18, s46, v18
    v_lshrrev_b32 v7, 3, v18
    v_add_u32 v6, v6, v7
    v_and_b32 v18, 7, v18
    v_lshl_add_u32 v6, v18, 3, v6
    v_lshlrev_b32 v6, 9, v6
    s_lshr_b32 s46, s30, 3
    s_lshl_b32 s46, s46, 3
    v_add_u32 v7, s46, v6
    s_mov_b32 exec_lo, 0
    v_mov_b32 v7, v19
    s_mov_b32 exec_lo, -1
    s_cmp_eq_u32 s57, 0
    s_cselect_b32 s38, 0, -1
    s_mov_b32 s39, 0xffff
    s_lshl_b32 s37, s30, 9
    s_add_u32 s37, s37, 12582912
    s_mov_b32 s36, 12582912
    s_lshr_b32 s50, s30, 3
    s_and_b32 s51, s30, 7
    s_lshl_b32 s51, s51, 7
    s_lshl_b32 s51, s51, 1
    s_lshl_b32 s57, s50, 3
    s_add_u32 s57, s57, s51
    s_add_u32 s57, s57, 4096
    s_cmp_lt_u32 s50, 20
    s_cselect_b32 s57, s57, 0
    s_sub_u32 s51, s30, 240
    s_cmp_lt_u32 s51, 10
    s_cbranch_scc0 L_pfl
    s_lshl_b32 s57, s51, 3
    s_add_u32 s57, s57, 6144
L_pfl:
    s_cmp_eq_u32 s22, 3
    s_waitcnt lgkmcnt(0)
    s_barrier
    s_cbranch_scc1 L_h_1
    s_branch L_h_2
L_h_1:
    s_mov_b64 exec, s[38:39]
    buffer_store_dwordx2 v[4:5], v7, s[4:7], s36 offen sc1
    s_mov_b64 exec, -1
L_h_2:
    v_subrev_u32 v8, 104448, v35
    v_add_u32 v33, 61440, v1
    v_add_u32 v34, 102400, v1
    v_mov_b32 v36, 158496
    v_mov_b32 v37, 1
    ds_write_b32 v36, v243
    ds_write_b32 v36, v243 offset:4
    v_add_u32 v38, 51200, v1
    v_add_u32 v57, 103424, v8
    v_add_u32 v58, 102400, v1
    v_mov_b32 v240, 0x358637bd
    v_mov_b32 v241, 0
    s_mov_b32 exec_hi, 0
    v_mov_b32 v241, v240
    s_mov_b32 exec_hi, -1
    v_mov_b32 v242, 0x3f80
    s_lshl_b32 s40, s22, 5
    v_add_u32 v8, s40, v2
    v_mul_u32_u24 v8, 168, v8
    v_add_u32 v41, 81056, v8
    v_lshl_add_u32 v8, v3, 3, v8
    v_add_u32 v39, 80896, v8
    v_lshrrev_b32 v9, 1, v3
    v_lshl_add_u32 v40, v9, 6, v39
    v_lshrrev_b32 v8, 5, v0
    v_lshlrev_b32 v8, 3, v8
    v_bfe_u32 v9, v0, 2, 2
    v_add_u32 v8, v8, v9
    v_mul_u32_u24 v8, 168, v8
    v_add_u32 v8, 80896, v8
    v_and_b32 v9, 1, v3
    v_lshlrev_b32 v9, 2, v9
    v_and_b32 v10, 3, v0
    v_add_u32 v9, v9, v10
    s_and_b32 s40, s22, 1
    s_mul_i32 s40, s40, 5
    v_add_u32 v10, s40, v9
    v_add_u32 v11, 10, v10
    v_cmp_lt_u32 s[42:43], 4, v9
    v_mov_b32 v9, 20
    s_nop 0
    v_cndmask_b32 v11, v11, v9, s[42:43]
    v_lshl_add_u32 v42, v10, 3, v8
    v_lshl_add_u32 v43, v11, 3, v8
    v_and_b32 v8, 31, v0
    v_lshrrev_b32 v9, 5, v0
    v_mul_u32_u24 v10, 21, v9
    v_add_lshl_u32 v44, v8, v10, 3
    s_lshl_b32 s40, s22, 9
    v_add_u32 v45, s40, v32
    v_add_u32 v46, 156160, v45
    v_mul_u32_u24 v8, 168, v3
    v_add_u32 v47, 156160, v8
    v_add_u32 v48, v54, v47
    v_add_u32 v49, 156160, v54
    v_and_b32 v8, 3, v0
    v_lshlrev_b32 v8, 3, v8
    v_add_u32 v50, v8, v47
    v_add_u32 v51, 156160, v8
    v_lshlrev_b32 v8, 4, v2
    v_mov_b32 v52, v8
    v_lshrrev_b32 v9, 1, v3
    v_and_b32 v10, 1, v3
    v_lshl_add_u32 v53, v9, 8, v8
    v_lshl_add_u32 v246, v3, 9, v8
    v_lshlrev_b32 v252, 4, v3
    v_add_u32 v252, 154624, v252
    s_lshl_b32 s50, s29, 4
    v_add_u32 v8, s50, v2
    v_mul_u32_u24 v8, 1280, v8
    s_and_b32 s40, s24, 1
    s_cmp_eq_u32 s40, 1
    s_cselect_b32 s51, 0, 128
    s_lshl_b32 s50, s40, 5
    s_mul_i32 s52, s24, 160
    s_add_u32 s50, s50, s52
    s_add_u32 s51, s51, s52
    v_lshl_add_u32 v9, v3, 3, v8
    v_add_u32 v56, s51, v9
    v_lshl_add_u32 v8, v3, 4, v8
    v_add_u32 v55, s50, v8
    s_mul_i32 s66, s29, 20480
    s_lshr_b32 s40, s24, 1
    s_mul_i32 s40, s40, 5120
    s_add_u32 s40, s40, s66
    s_and_b32 s41, s24, 1
    s_lshl_b32 s65, s41, 9
    s_add_u32 s65, s65, s40
    s_add_u32 s65, s65, 2048
    s_mul_i32 s41, s41, 3072
    s_add_u32 s64, s40, s41
    s_lshl_b32 s67, s30, 7
    s_lshl_b32 s40, s26, 4
    s_add_u32 s40, s40, s25
    s_mul_i32 s68, s40, 1792
    s_mul_i32 s41, s22, 840
    s_add_u32 s68, s68, s41
    s_add_u32 s68, s68, 65536
    s_lshl_b32 s69, s25, 3
    s_add_u32 s69, s69, 12582912
    s_lshl_b32 s40, s25, 2
    s_add_u32 s40, s40, s22
    s_mul_i32 s41, s40, 40960
    s_add_u32 s41, s41, 1048576
    s_lshl_b32 s70, s26, 10
    s_add_u32 s70, s70, s41
    s_lshl_b32 s71, s26, 8
    s_add_u32 s71, s71, s41
    s_add_u32 s71, s71, 16384
    s_lshl_b32 s72, s26, 3
    s_add_u32 s72, s72, 12648448
    s_lshl_b32 s76, s29, 11
    s_lshl_b32 s41, s24, 8
    s_add_u32 s76, s76, s41
    s_mul_i32 s77, s24, 102400
    s_mul_i32 s78, s26, 153600
    v_lshrrev_b32 v8, 2, v0
    v_lshlrev_b32 v8, 1, v8
    v_and_b32 v9, 3, v0
    v_lshl_add_u32 v8, v9, 6, v8
    s_lshr_b32 s40, s26, 3
    s_lshl_b32 s41, s24, 3
    s_add_u32 s40, s40, s41
    v_add_lshl_u32 v8, v8, s40, 7
    v_accvgpr_write_b32 a244, v8
    s_lshr_b32 s40, s25, 1
    s_and_b32 s41, s25, 1
    s_lshl_b32 s41, s41, 7
    s_add_u32 s40, s40, s41
    v_add_lshl_u32 v8, v32, s40, 7
    v_accvgpr_write_b32 a245, v8
    s_lshl_b32 s41, s24, 3
    s_sub_u32 s40, s30, s41
    v_add_lshl_u32 v8, v32, s40, 7
    v_accvgpr_write_b32 a246, v8
    s_cmp_eq_u32 s22, 2
    s_cbranch_scc0 L_tch
    v_and_b32 v8, 7, v0
    v_bfe_u32 v9, v0, 3, 1
    v_lshlrev_b32 v9, 24, v9
    v_lshl_add_u32 v10, v8, 16, v9
    s_add_u32 s40, s67, 12582912
    v_add_u32 v10, s40, v10
    s_and_b32 s40, s30, 31
    s_lshl_b32 s40, s40, 10
    s_add_u32 s40, s40, 12779520
    v_lshl_add_u32 v11, v8, 7, v9
    v_add_u32 v6, s40, v11
    s_mov_b64 exec, 0xffff0000
    v_mov_b32 v10, v6
    s_lshl_b32 s40, s23, 10
    s_add_u32 s40, s40, 6488064
    s_mov_b32 exec_lo, 0
    s_mov_b32 exec_hi, 0xffff
    v_add_u32 v10, s40, v11
    s_lshl_b32 s40, s23, 11
    s_add_u32 s40, s40, 6422528
    s_mov_b32 exec_hi, 0xffff0000
    v_lshl_add_u32 v10, v8, 8, v9
    v_add_u32 v10, s40, v10
    s_mov_b32 s40, 16777216
    s_cmp_eq_u32 s24, 0
    s_cselect_b32 s41, -1, 0
    s_and_b32 exec_hi, exec_hi, s41
    s_cbranch_execz L_tch1
    buffer_load_dword v31, v10, s[4:7], s40 offen offset:128
L_tch1:
    s_mov_b32 exec_lo, -1
    s_mov_b32 exec_hi, s41
    buffer_load_dword v31, v10, s[4:7], s40 offen
    s_mov_b64 exec, -1
    v_and_b32 v8, 31, v0
    v_lshrrev_b32 v9, 5, v0
    v_lshlrev_b32 v9, 24, v9
    v_lshl_add_u32 v10, v8, 7, v9
    s_lshl_b32 s40, s26, 4
    s_add_u32 s40, s40, s25
    s_mul_i32 s40, s40, 1792
    s_add_u32 s40, s40, 16842752
    s_mov_b32 exec_lo, 0x3fff
    s_mov_b32 exec_hi, 0x3fff
    buffer_load_dword v31, v10, s[4:7], s40 offen
    s_mov_b64 exec, -1
L_tch:
    s_cmp_eq_u32 s56, 3
    s_cbranch_scc1 L_uJ
    s_cmp_eq_u32 s56, 0
    s_cbranch_scc1 L_uJ
    v_add_u32 v12, s58, v32
    v_lshrrev_b32 v13, 2, v0
    v_lshlrev_b32 v13, 5, v13
    v_add_u32 v13, s58, v13
    v_and_b32 v17, 1, v0
    v_bfe_u32 v15, v0, 1, 1
    v_lshl_add_u32 v15, v15, 10, v13
    v_lshl_add_u32 v15, v17, 4, v15
    v_subrev_u32 v16, 104448, v35
    v_lshlrev_b32 v18, 2, v0
    v_cmp_eq_u32 s[48:49], 1, v3
    v_cmp_eq_u32 s[52:53], 2, v3
    v_cmp_eq_u32 s[46:47], 3, v3
    s_add_u32 s50, s99, 4096
    s_add_u32 s51, s63, 256
    v_mov_b32 v8, 0x3f803f80
    v_mov_b32 v9, 0x3f803f80
    v_mov_b32 v10, 0x3f803f80
    v_mov_b32 v11, 0x3f803f80
    s_cmp_eq_u32 s56, 2
    s_waitcnt vmcnt(0)
    s_cbranch_scc1 L_uE
    ds_read_b64_tr_b16 v[168:169], v15 offset:0
    ds_read_b64_tr_b16 v[170:171], v15 offset:512
    ds_read_b64_tr_b16 v[172:173], v15 offset:8
    ds_read_b64_tr_b16 v[174:175], v15 offset:520
    ds_read_b64_tr_b16 v[176:177], v15 offset:2048
    ds_read_b64_tr_b16 v[178:179], v15 offset:2560
    ds_read_b64_tr_b16 v[180:181], v15 offset:2056
    ds_read_b64_tr_b16 v[182:183], v15 offset:2568
    ds_read_b64_tr_b16 v[184:185], v12 offset:4096
    ds_read_b64_tr_b16 v[186:187], v12 offset:4608
    s_waitcnt lgkmcnt(8)
    buffer_store_dwordx4 v[168:171], v1, s[4:7], s99 offen offset:0 sc1
    s_waitcnt lgkmcnt(6)
    buffer_store_dwordx4 v[172:175], v1, s[4:7], s99 offen offset:1024 sc1
    s_waitcnt lgkmcnt(4)
    buffer_store_dwordx4 v[176:179], v1, s[4:7], s99 offen offset:2048 sc1
    s_waitcnt lgkmcnt(2)
    buffer_store_dwordx4 v[180:183], v1, s[4:7], s99 offen offset:3072 sc1
    s_waitcnt lgkmcnt(0)
    buffer_store_dwordx4 v[184:187], v1, s[4:7], s50 offen offset:0 sc1
    s_branch L_uC
L_uE:
    ds_read_b64_tr_b16 v[168:169], v12 offset:0
    ds_read_b64_tr_b16 v[170:171], v12 offset:512
    ds_read_b64_tr_b16 v[172:173], v12 offset:1024
    ds_read_b64_tr_b16 v[174:175], v12 offset:1536
    ds_read_b64_tr_b16 v[184:185], v12 offset:2048
    ds_read_b64_tr_b16 v[186:187], v12 offset:2560
    ds_read_b64_tr_b16 v[188:189], v12 offset:3072
    ds_read_b64_tr_b16 v[190:191], v12 offset:3584
    s_add_u32 s50, s99, 0x10000
    s_add_u32 s51, s63, 10240
    s_waitcnt lgkmcnt(0)
    buffer_store_dwordx4 v[168:171], v1, s[4:7], s99 offen offset:0 sc1
    buffer_store_dwordx4 v[184:187], v1, s[4:7], s50 offen offset:0 sc1
    s_mov_b32 exec_lo, 0xff00ff
    s_mov_b32 exec_hi, 0xff00ff
    buffer_store_dwordx4 v[172:175], v16, s[4:7], s99 offen offset:1024 sc1
    s_mov_b64 exec, -1
    s_mov_b32 exec_lo, 0xff00ff
    s_mov_b32 exec_hi, 0xff00ff
    buffer_store_dwordx4 v[188:191], v16, s[4:7], s50 offen offset:1024 sc1
    s_mov_b64 exec, -1
L_uC:
    s_cmp_eq_u32 s63, 0
    s_cbranch_scc1 L_uJ
    v_mfma_f32_16x16x32_bf16 v[192:195], v[8:11], v[168:171], 0
    v_mfma_f32_16x16x32_bf16 v[196:199], v[8:11], v[172:175], 0
    v_mfma_f32_16x16x32_bf16 v[200:203], v[8:11], v[176:179], 0
    v_mfma_f32_16x16x32_bf16 v[204:207], v[8:11], v[180:183], 0
    v_mfma_f32_16x16x32_bf16 v[208:211], v[8:11], v[184:187], 0
    v_mfma_f32_16x16x32_bf16 v[212:215], v[8:11], v[188:191], 0
    s_nop 3
    v_cndmask_b32 v192, v192, v196, s[48:49]
    v_cndmask_b32 v192, v192, v200, s[52:53]
    v_cndmask_b32 v192, v192, v204, s[46:47]
    buffer_store_dword v192, v18, s[4:7], s63 offen sc1
    v_cndmask_b32 v208, v208, v212, s[48:49]
    v_cndmask_b32 v208, v208, v216, s[52:53]
    v_cndmask_b32 v208, v208, v220, s[46:47]
    buffer_store_dword v208, v18, s[4:7], s51 offen sc1
L_uJ:
    v_lshlrev_b32 v8, 4, v2
    v_lshrrev_b32 v9, 1, v3
    s_lshr_b32 s41, s22, 1
    s_lshl_b32 s41, s41, 8
    s_and_b32 s42, s22, 1
    s_lshl_b32 s42, s42, 6
    s_add_u32 s42, s42, s41
    v_and_b32 v11, 3, v2
    v_lshlrev_b32 v11, 4, v11
    v_bfe_u32 v6, v2, 2, 1
    v_lshl_add_u32 v11, v6, 7, v11
    v_add_u32 v11, s42, v11
    v_lshl_add_u32 v245, v3, 9, v11
    v_lshrrev_b32 v6, 3, v2
    v_lshl_add_u32 v11, v6, 10, v11
    v_lshl_add_u32 v244, v9, 9, v11
    s_cmp_eq_u32 s24, 0
    s_cbranch_scc1 L_c1
    v_lshl_add_u32 v244, v9, 11, v8
    v_lshlrev_b32 v245, 2, v2
    v_add_u32 v245, 155648, v245
L_c1:
    s_lshl_b32 s43, s22, 7
    s_add_u32 s43, s43, 157952
    v_add_u32 v247, s43, v54
    v_lshlrev_b32 v8, 5, v3
    v_add_u32 v248, s43, v8
    s_mul_i32 s42, s22, 3072
    s_add_u32 s42, s42, 133120
    v_add_u32 v249, s42, v1
    v_add_u32 v250, s42, v32
    s_and_b32 s40, s24, 1
    s_lshl_b32 s41, s40, 2
    s_xor_b32 s40, s40, 1
    s_lshl_b32 s40, s40, 4
    v_lshlrev_b32 v8, 1, v3
    v_add_u32 v8, s41, v8
    v_add_u32 v8, 0, v8
    v_mul_u32_u24 v9, 52, v8
    v_lshrrev_b32 v9, 8, v9
    v_mul_u32_u24 v10, 5, v9
    v_sub_u32 v8, v8, v10
    v_and_b32 v10, 1, v9
    v_lshl_add_u32 v10, v10, 4, v2
    v_lshrrev_b32 v9, 1, v9
    v_mul_u32_u24 v9, 1536, v9
    v_add_u32 v9, s42, v9
    v_lshrrev_b32 v11, 1, v8
    v_lshl_add_u32 v11, v11, 5, v10
    v_lshlrev_b32 v11, 4, v11
    v_and_b32 v6, 1, v8
    v_lshl_add_u32 v11, v6, 3, v11
    v_lshlrev_b32 v10, 3, v10
    v_add_u32 v10, 1024, v10
    v_cmp_eq_u32 s[44:45], 4, v8
    s_nop 1
    v_cndmask_b32 v11, v11, v10, s[44:45]
    v_add_u32 v59, v9, v11
    v_lshlrev_b32 v8, 1, v3
    v_add_u32 v8, s41, v8
    v_add_u32 v8, 1, v8
    v_mul_u32_u24 v9, 52, v8
    v_lshrrev_b32 v9, 8, v9
    v_mul_u32_u24 v10, 5, v9
    v_sub_u32 v8, v8, v10
    v_and_b32 v10, 1, v9
    v_lshl_add_u32 v10, v10, 4, v2
    v_lshrrev_b32 v9, 1, v9
    v_mul_u32_u24 v9, 1536, v9
    v_add_u32 v9, s42, v9
    v_lshrrev_b32 v11, 1, v8
    v_lshl_add_u32 v11, v11, 5, v10
    v_lshlrev_b32 v11, 4, v11
    v_and_b32 v6, 1, v8
    v_lshl_add_u32 v11, v6, 3, v11
    v_lshlrev_b32 v10, 3, v10
    v_add_u32 v10, 1024, v10
    v_cmp_eq_u32 s[44:45], 4, v8
    s_nop 1
    v_cndmask_b32 v11, v11, v10, s[44:45]
    v_add_u32 v60, v9, v11
    v_lshlrev_b32 v8, 1, v3
    v_add_u32 v8, s41, v8
    v_add_u32 v8, 8, v8
    v_mul_u32_u24 v9, 52, v8
    v_lshrrev_b32 v9, 8, v9
    v_mul_u32_u24 v10, 5, v9
    v_sub_u32 v8, v8, v10
    v_and_b32 v10, 1, v9
    v_lshl_add_u32 v10, v10, 4, v2
    v_lshrrev_b32 v9, 1, v9
    v_mul_u32_u24 v9, 1536, v9
    v_add_u32 v9, s42, v9
    v_lshrrev_b32 v11, 1, v8
    v_lshl_add_u32 v11, v11, 5, v10
    v_lshlrev_b32 v11, 4, v11
    v_and_b32 v6, 1, v8
    v_lshl_add_u32 v11, v6, 3, v11
    v_lshlrev_b32 v10, 3, v10
    v_add_u32 v10, 1024, v10
    v_cmp_eq_u32 s[44:45], 4, v8
    s_nop 1
    v_cndmask_b32 v11, v11, v10, s[44:45]
    v_add_u32 v61, v9, v11
    v_lshlrev_b32 v8, 1, v3
    v_add_u32 v8, s41, v8
    v_add_u32 v8, 9, v8
    v_mul_u32_u24 v9, 52, v8
    v_lshrrev_b32 v9, 8, v9
    v_mul_u32_u24 v10, 5, v9
    v_sub_u32 v8, v8, v10
    v_and_b32 v10, 1, v9
    v_lshl_add_u32 v10, v10, 4, v2
    v_lshrrev_b32 v9, 1, v9
    v_mul_u32_u24 v9, 1536, v9
    v_add_u32 v9, s42, v9
    v_lshrrev_b32 v11, 1, v8
    v_lshl_add_u32 v11, v11, 5, v10
    v_lshlrev_b32 v11, 4, v11
    v_and_b32 v6, 1, v8
    v_lshl_add_u32 v11, v6, 3, v11
    v_lshlrev_b32 v10, 3, v10
    v_add_u32 v10, 1024, v10
    v_cmp_eq_u32 s[44:45], 4, v8
    s_nop 1
    v_cndmask_b32 v11, v11, v10, s[44:45]
    v_add_u32 v62, v9, v11
    v_add_u32 v8, s40, v3
    v_mul_u32_u24 v9, 52, v8
    v_lshrrev_b32 v9, 8, v9
    v_mul_u32_u24 v10, 5, v9
    v_sub_u32 v8, v8, v10
    v_and_b32 v10, 1, v9
    v_lshl_add_u32 v10, v10, 4, v2
    v_lshrrev_b32 v9, 1, v9
    v_mul_u32_u24 v9, 1536, v9
    v_add_u32 v9, s42, v9
    v_lshrrev_b32 v11, 1, v8
    v_lshl_add_u32 v11, v11, 5, v10
    v_lshlrev_b32 v11, 4, v11
    v_and_b32 v6, 1, v8
    v_lshl_add_u32 v11, v6, 3, v11
    v_lshlrev_b32 v10, 3, v10
    v_add_u32 v10, 1024, v10
    v_cmp_eq_u32 s[44:45], 4, v8
    s_nop 1
    v_cndmask_b32 v11, v11, v10, s[44:45]
    v_add_u32 v63, v9, v11
    s_lshl_b32 s73, s23, 11
    s_add_u32 s73, s73, 6422528
    s_lshl_b32 s74, s23, 10
    s_add_u32 s74, s74, 6488064
    s_lshl_b32 s42, s23, 12
    s_lshl_b32 s41, s22, 9
    s_add_u32 s42, s42, s41
    s_add_u32 s42, s42, 6553600
    s_cmp_eq_u32 s24, 0
    s_cselect_b32 s73, s73, s42
    s_lshr_b32 s75, s23, 2
    s_lshl_b32 s75, s75, 7
    s_lshl_b32 s41, s24, 5
    s_add_u32 s75, s75, s41
    s_and_b32 s41, s23, 3
    s_lshl_b32 s41, s41, 3
    s_add_u32 s75, s75, s41
    s_add_u32 s75, s75, 12779520
    s_lshr_b32 s40, s23, 3
    s_lshl_b32 s40, s40, 1
    s_lshr_b32 s41, s23, 1
    s_and_b32 s41, s41, 3
    s_lshl_b32 s41, s41, 6
    s_add_u32 s40, s40, s41
    v_lshrrev_b32 v8, 1, v0
    v_lshlrev_b32 v8, 3, v8
    v_and_b32 v9, 1, v0
    v_add_u32 v8, v8, v9
    v_add_lshl_u32 v8, v8, s40, 7
    v_accvgpr_write_b32 a247, v8
    v_lshrrev_b32 v8, 3, v0
    v_lshlrev_b32 v8, 7, v8
    v_and_b32 v9, 7, v0
    v_lshl_add_u32 v253, v9, 3, v8
    buffer_load_dwordx4 a[224:227], v55, s[8:11], 0 offen
    buffer_load_dwordx4 a[228:231], v55, s[8:11], 0 offen offset:64
    buffer_load_dwordx2 a[232:233], v56, s[8:11], 0 offen
    s_lshl_b32 s44, s25, 2
    s_add_u32 s44, s44, s22
    s_mul_i32 s40, s44, 40960
    s_add_u32 s40, s40, 9437184
    s_add_u32 s42, s40, 20480
    s_lshl_b32 s41, s44, 12
    s_add_u32 s41, s41, 12058624
    s_mul_i32 s48, s26, 10240
    s_add_u32 s48, s48, 65536
    s_mul_i32 s54, s22, 5120
    s_add_u32 s55, s78, s54
    s_add_u32 s55, s55, 1048576
    s_mul_i32 s50, s22, 13312
    s_min_u32 s50, s50, 37888
    s_add_u32 s0, s50, 102400
    s_add_u32 s1, s78, s0
    s_add_u32 s1, s1, 1048576
    s_cmp_eq_u32 s22, 3
    s_cselect_b32 s57, s57, 0
    s_cmp_eq_u32 s22, 3
    s_cbranch_scc0 L_h_3
    s_mov_b32 exec_lo, 0xffffffff
    s_mov_b32 exec_hi, 0xf
    s_mov_b32 s36, 0
L_poll_4:
    buffer_load_dwordx2 v[4:5], v32, s[4:7], s37 offen sc1
    s_add_u32 s36, s36, 1
    s_cmp_gt_u32 s36, 2097152
    s_cbranch_scc1 L_abort
    s_waitcnt vmcnt(0)
    v_cmp_ne_u64 vcc, s[20:21], v[4:5]
    s_cbranch_vccnz L_poll_4
    s_mov_b64 exec, -1
L_h_3:
    s_barrier
    s_mov_b32 m0, s54
    s_nop 0
    buffer_load_dwordx4 v1, s[4:7], s55 offen offset:0 sc1 lds
    buffer_load_dwordx4 v1, s[4:7], s55 offen offset:1024 sc1 lds
    buffer_load_dwordx4 v1, s[4:7], s55 offen offset:2048 sc1 lds
    buffer_load_dwordx4 v1, s[4:7], s55 offen offset:3072 sc1 lds
    s_add_u32 m0, s54, 1024
    s_add_u32 s55, s55, 1024
    buffer_load_dwordx4 v1, s[4:7], s55 offen offset:3072 sc1 lds
    s_add_u32 s54, s54, 20480
    s_add_u32 s55, s55, 19456
    buffer_load_dwordx4 a[0:3], v1, s[88:91], s40 offen offset:0 sc1
    buffer_load_dwordx4 a[80:83], v1, s[88:91], s42 offen offset:0 sc1
    buffer_load_dwordx4 a[4:7], v1, s[88:91], s40 offen offset:1024 sc1
    buffer_load_dwordx4 a[84:87], v1, s[88:91], s42 offen offset:1024 sc1
    buffer_load_dwordx4 a[8:11], v1, s[88:91], s40 offen offset:2048 sc1
    buffer_load_dwordx4 a[88:91], v1, s[88:91], s42 offen offset:2048 sc1
    buffer_load_dwordx4 a[12:15], v1, s[88:91], s40 offen offset:3072 sc1
    buffer_load_dwordx4 a[92:95], v1, s[88:91], s42 offen offset:3072 sc1
    s_mov_b32 m0, s54
    s_nop 0
    buffer_load_dwordx4 v1, s[4:7], s55 offen offset:0 sc1 lds
    buffer_load_dwordx4 v1, s[4:7], s55 offen offset:1024 sc1 lds
    buffer_load_dwordx4 v1, s[4:7], s55 offen offset:2048 sc1 lds
    buffer_load_dwordx4 v1, s[4:7], s55 offen offset:3072 sc1 lds
    s_add_u32 m0, s54, 1024
    s_add_u32 s55, s55, 1024
    buffer_load_dwordx4 v1, s[4:7], s55 offen offset:3072 sc1 lds
    s_add_u32 s54, s54, 20480
    s_add_u32 s55, s55, 19456
    v_and_b32 v6, 7, v0
    v_lshlrev_b32 v6, 4, v6
    v_lshrrev_b32 v7, 3, v0
    v_lshl_add_u32 v6, v7, 9, v6
    s_lshl_b32 s39, s22, 7
    v_add_u32 v6, s39, v6
    v_mov_b32 v200, 0
    v_mov_b32 v201, 0
    v_mov_b32 v202, 0
    v_mov_b32 v203, 0
    buffer_load_dwordx4 v[192:195], v6, s[4:7], s48 offen sc1
    s_add_u32 s48, s48, 4096
    buffer_load_dwordx4 v[196:199], v6, s[4:7], s48 offen sc1
    s_add_u32 s48, s48, 4096
    s_mov_b32 exec_hi, 0
    buffer_load_dwordx4 v[200:203], v6, s[4:7], s48 offen sc1
    s_mov_b32 exec_hi, -1
    buffer_load_dwordx2 v[20:21], v246, s[88:91], s41 offen offset:0 sc1
    buffer_load_dwordx2 v[22:23], v246, s[88:91], s41 offen offset:256 sc1
    buffer_load_dwordx2 v[24:25], v246, s[88:91], s41 offen offset:2048 sc1
    buffer_load_dwordx2 v[26:27], v246, s[88:91], s41 offen offset:2304 sc1
    v_mov_b32 v4, s20
    v_mov_b32 v5, s21
L_P1:
    s_cmp_eq_u32 s27, 0
    s_cselect_b64 vcc, 0, -1
    s_waitcnt lgkmcnt(0)
    s_cbranch_vccz L_s_5o
    s_waitcnt vmcnt(10)
    s_barrier
L_s_5:
    ds_read_b128 v[128:131], v1 offset:0
    ds_read_b128 v[132:135], v1 offset:1024
    ds_read_b128 v[136:139], v1 offset:2048
    ds_read_b128 v[140:143], v1 offset:3072
    ds_read_b128 v[144:147], v1 offset:4096
    ds_read_b128 v[148:151], v1 offset:5120
    ds_read_b128 v[152:155], v1 offset:6144
    ds_read_b128 v[156:159], v1 offset:7168
    ds_read_b128 v[160:163], v1 offset:8192
    ds_read_b128 v[164:167], v1 offset:9216
    s_waitcnt lgkmcnt(5)
    v_mfma_f32_16x16x32_bf16 v[72:75], v[128:131], a[0:3], 0
    ds_read_b128 v[168:171], v1 offset:10240
    v_mfma_f32_16x16x32_bf16 v[104:107], v[128:131], a[80:83], 0
    s_cbranch_vccz L_w_6o
L_w_6:
    v_mfma_f32_16x16x32_bf16 v[76:79], v[132:135], a[0:3], 0
    ds_read_b128 v[172:175], v1 offset:11264
    v_mfma_f32_16x16x32_bf16 v[108:111], v[132:135], a[80:83], 0
    s_add_u32 s40, s40, 4096
    buffer_load_dwordx4 a[16:19], v1, s[88:91], s40 offen offset:0 sc1
    v_mfma_f32_16x16x32_bf16 v[80:83], v[136:139], a[0:3], 0
    ds_read_b128 v[176:179], v1 offset:12288
    v_mfma_f32_16x16x32_bf16 v[112:115], v[136:139], a[80:83], 0
    s_add_u32 s42, s42, 4096
    buffer_load_dwordx4 a[96:99], v1, s[88:91], s42 offen offset:0 sc1
    v_mfma_f32_16x16x32_bf16 v[84:87], v[140:143], a[0:3], 0
    ds_read_b128 v[180:183], v1 offset:13312
    v_mfma_f32_16x16x32_bf16 v[116:119], v[140:143], a[80:83], 0
    buffer_load_dwordx4 a[20:23], v1, s[88:91], s40 offen offset:1024 sc1
    v_mfma_f32_16x16x32_bf16 v[88:91], v[144:147], a[0:3], 0
    ds_read_b128 v[184:187], v1 offset:14336
    v_mfma_f32_16x16x32_bf16 v[120:123], v[144:147], a[80:83], 0
    buffer_load_dwordx4 a[100:103], v1, s[88:91], s42 offen offset:1024 sc1
    s_waitcnt vmcnt(12)
    s_waitcnt lgkmcnt(5)
    v_mfma_f32_16x16x32_bf16 v[72:75], v[148:151], a[4:7], v[72:75]
    ds_read_b128 v[128:131], v1 offset:15360
    v_mfma_f32_16x16x32_bf16 v[104:107], v[148:151], a[84:87], v[104:107]
    s_cbranch_vccz L_w_7o
L_w_7:
    v_mfma_f32_16x16x32_bf16 v[76:79], v[152:155], a[4:7], v[76:79]
    ds_read_b128 v[132:135], v1 offset:16384
    v_mfma_f32_16x16x32_bf16 v[108:111], v[152:155], a[84:87], v[108:111]
    buffer_load_dwordx4 a[24:27], v1, s[88:91], s40 offen offset:2048 sc1
    v_mfma_f32_16x16x32_bf16 v[80:83], v[156:159], a[4:7], v[80:83]
    ds_read_b128 v[136:139], v1 offset:17408
    v_mfma_f32_16x16x32_bf16 v[112:115], v[156:159], a[84:87], v[112:115]
    buffer_load_dwordx4 a[104:107], v1, s[88:91], s42 offen offset:2048 sc1
    v_mfma_f32_16x16x32_bf16 v[84:87], v[160:163], a[4:7], v[84:87]
    ds_read_b128 v[140:143], v1 offset:18432
    v_mfma_f32_16x16x32_bf16 v[116:119], v[160:163], a[84:87], v[116:119]
    buffer_load_dwordx4 a[28:31], v1, s[88:91], s40 offen offset:3072 sc1
    v_mfma_f32_16x16x32_bf16 v[88:91], v[164:167], a[4:7], v[88:91]
    ds_read_b128 v[144:147], v1 offset:19456
    v_mfma_f32_16x16x32_bf16 v[120:123], v[164:167], a[84:87], v[120:123]
    buffer_load_dwordx4 a[108:111], v1, s[88:91], s42 offen offset:3072 sc1
    s_cbranch_vccz L_s_8o
    s_waitcnt vmcnt(14)
L_s_8:
    s_waitcnt lgkmcnt(5)
    v_mfma_f32_16x16x32_bf16 v[72:75], v[168:171], a[8:11], v[72:75]
    ds_read_b128 v[148:151], v1 offset:20480
    v_mfma_f32_16x16x32_bf16 v[104:107], v[168:171], a[88:91], v[104:107]
    s_cbranch_vccz L_w_9o
L_w_9:
    v_mfma_f32_16x16x32_bf16 v[76:79], v[172:175], a[8:11], v[76:79]
    ds_read_b128 v[152:155], v1 offset:21504
    v_mfma_f32_16x16x32_bf16 v[108:111], v[172:175], a[88:91], v[108:111]
    s_add_u32 s40, s40, 4096
    buffer_load_dwordx4 a[32:35], v1, s[88:91], s40 offen offset:0 sc1
    v_mfma_f32_16x16x32_bf16 v[80:83], v[176:179], a[8:11], v[80:83]
    ds_read_b128 v[156:159], v1 offset:22528
    v_mfma_f32_16x16x32_bf16 v[112:115], v[176:179], a[88:91], v[112:115]
    s_add_u32 s42, s42, 4096
    buffer_load_dwordx4 a[112:115], v1, s[88:91], s42 offen offset:0 sc1
    v_mfma_f32_16x16x32_bf16 v[84:87], v[180:183], a[8:11], v[84:87]
    ds_read_b128 v[160:163], v1 offset:23552
    v_mfma_f32_16x16x32_bf16 v[116:119], v[180:183], a[88:91], v[116:119]
    buffer_load_dwordx4 a[36:39], v1, s[88:91], s40 offen offset:1024 sc1
    v_mfma_f32_16x16x32_bf16 v[88:91], v[184:187], a[8:11], v[88:91]
    ds_read_b128 v[164:167], v1 offset:24576
    v_mfma_f32_16x16x32_bf16 v[120:123], v[184:187], a[88:91], v[120:123]
    buffer_load_dwordx4 a[116:119], v1, s[88:91], s42 offen offset:1024 sc1
    s_waitcnt vmcnt(16)
    s_waitcnt lgkmcnt(5)
    v_mfma_f32_16x16x32_bf16 v[72:75], v[128:131], a[12:15], v[72:75]
    ds_read_b128 v[168:171], v1 offset:25600
    v_mfma_f32_16x16x32_bf16 v[104:107], v[128:131], a[92:95], v[104:107]
    s_cbranch_vccz L_w_10o
L_w_10:
    v_mfma_f32_16x16x32_bf16 v[76:79], v[132:135], a[12:15], v[76:79]
    ds_read_b128 v[172:175], v1 offset:26624
    v_mfma_f32_16x16x32_bf16 v[108:111], v[132:135], a[92:95], v[108:111]
    buffer_load_dwordx4 a[40:43], v1, s[88:91], s40 offen offset:2048 sc1
    v_mfma_f32_16x16x32_bf16 v[80:83], v[136:139], a[12:15], v[80:83]
    ds_read_b128 v[176:179], v1 offset:27648
    v_mfma_f32_16x16x32_bf16 v[112:115], v[136:139], a[92:95], v[112:115]
    buffer_load_dwordx4 a[120:123], v1, s[88:91], s42 offen offset:2048 sc1
    v_mfma_f32_16x16x32_bf16 v[84:87], v[140:143], a[12:15], v[84:87]
    ds_read_b128 v[180:183], v1 offset:28672
    v_mfma_f32_16x16x32_bf16 v[116:119], v[140:143], a[92:95], v[116:119]
    buffer_load_dwordx4 a[44:47], v1, s[88:91], s40 offen offset:3072 sc1
    v_mfma_f32_16x16x32_bf16 v[88:91], v[144:147], a[12:15], v[88:91]
    ds_read_b128 v[184:187], v1 offset:29696
    v_mfma_f32_16x16x32_bf16 v[120:123], v[144:147], a[92:95], v[120:123]
    buffer_load_dwordx4 a[124:127], v1, s[88:91], s42 offen offset:3072 sc1
    s_waitcnt vmcnt(14)
    s_waitcnt lgkmcnt(5)
    v_mfma_f32_16x16x32_bf16 v[72:75], v[148:151], a[16:19], v[72:75]
    ds_read_b128 v[128:131], v1 offset:30720
    v_mfma_f32_16x16x32_bf16 v[104:107], v[148:151], a[96:99], v[104:107]
    s_cbranch_vccz L_w_11o
L_w_11:
    v_mfma_f32_16x16x32_bf16 v[76:79], v[152:155], a[16:19], v[76:79]
    ds_read_b128 v[132:135], v1 offset:31744
    v_mfma_f32_16x16x32_bf16 v[108:111], v[152:155], a[96:99], v[108:111]
    s_add_u32 s40, s40, 4096
    buffer_load_dwordx4 a[48:51], v1, s[88:91], s40 offen offset:0 sc1
    v_mfma_f32_16x16x32_bf16 v[80:83], v[156:159], a[16:19], v[80:83]
    ds_read_b128 v[136:139], v1 offset:32768
    v_mfma_f32_16x16x32_bf16 v[112:115], v[156:159], a[96:99], v[112:115]
    v_mfma_f32_16x16x32_bf16 v[84:87], v[160:163], a[16:19], v[84:87]
    ds_read_b128 v[140:143], v1 offset:33792
    v_mfma_f32_16x16x32_bf16 v[116:119], v[160:163], a[96:99], v[116:119]
    s_add_u32 s42, s42, 4096
    buffer_load_dwordx4 a[128:131], v1, s[88:91], s42 offen offset:0 sc1
    v_mfma_f32_16x16x32_bf16 v[88:91], v[164:167], a[16:19], v[88:91]
    ds_read_b128 v[144:147], v1 offset:34816
    v_mfma_f32_16x16x32_bf16 v[120:123], v[164:167], a[96:99], v[120:123]
    s_waitcnt vmcnt(14)
    s_waitcnt lgkmcnt(5)
    v_mfma_f32_16x16x32_bf16 v[72:75], v[168:171], a[20:23], v[72:75]
    ds_read_b128 v[148:151], v1 offset:35840
    v_mfma_f32_16x16x32_bf16 v[104:107], v[168:171], a[100:103], v[104:107]
    v_add_f32 v20, v20, v22
    s_cbranch_vccz L_w_12o
L_w_12:
    v_mfma_f32_16x16x32_bf16 v[76:79], v[172:175], a[20:23], v[76:79]
    ds_read_b128 v[152:155], v1 offset:36864
    v_mfma_f32_16x16x32_bf16 v[108:111], v[172:175], a[100:103], v[108:111]
    v_add_f32 v21, v21, v23
    buffer_load_dwordx4 a[52:55], v1, s[88:91], s40 offen offset:1024 sc1
    v_mfma_f32_16x16x32_bf16 v[80:83], v[176:179], a[20:23], v[80:83]
    ds_read_b128 v[156:159], v1 offset:37888
    v_mfma_f32_16x16x32_bf16 v[112:115], v[176:179], a[100:103], v[112:115]
    v_mov_b32 v22, v20
    v_mfma_f32_16x16x32_bf16 v[84:87], v[180:183], a[20:23], v[84:87]
    ds_read_b128 v[160:163], v1 offset:38912
    v_mfma_f32_16x16x32_bf16 v[116:119], v[180:183], a[100:103], v[116:119]
    v_mov_b32 v23, v21
    buffer_load_dwordx4 a[132:135], v1, s[88:91], s42 offen offset:1024 sc1
    v_mfma_f32_16x16x32_bf16 v[88:91], v[184:187], a[20:23], v[88:91]
    ds_read_b128 v[164:167], v1 offset:39936
    v_mfma_f32_16x16x32_bf16 v[120:123], v[184:187], a[100:103], v[120:123]
    v_permlane32_swap_b32 v20, v22
    s_cbranch_vccz L_s_13o
    s_waitcnt vmcnt(14)
L_s_13:
    s_waitcnt lgkmcnt(5)
    v_mfma_f32_16x16x32_bf16 v[72:75], v[128:131], a[24:27], v[72:75]
    ds_read_b128 v[168:171], v1 offset:40960
    v_mfma_f32_16x16x32_bf16 v[104:107], v[128:131], a[104:107], v[104:107]
    v_permlane32_swap_b32 v21, v23
    s_cbranch_vccz L_w_14o
L_w_14:
    v_mfma_f32_16x16x32_bf16 v[76:79], v[132:135], a[24:27], v[76:79]
    ds_read_b128 v[172:175], v1 offset:41984
    v_mfma_f32_16x16x32_bf16 v[108:111], v[132:135], a[104:107], v[108:111]
    v_add_f32 v20, v20, v22
    buffer_load_dwordx4 a[56:59], v1, s[88:91], s40 offen offset:2048 sc1
    v_mfma_f32_16x16x32_bf16 v[80:83], v[136:139], a[24:27], v[80:83]
    ds_read_b128 v[176:179], v1 offset:43008
    v_mfma_f32_16x16x32_bf16 v[112:115], v[136:139], a[104:107], v[112:115]
    v_add_f32 v21, v21, v23
    v_mfma_f32_16x16x32_bf16 v[84:87], v[140:143], a[24:27], v[84:87]
    ds_read_b128 v[180:183], v1 offset:44032
    v_mfma_f32_16x16x32_bf16 v[116:119], v[140:143], a[104:107], v[116:119]
    v_mov_b32 v22, v20
    buffer_load_dwordx4 a[136:139], v1, s[88:91], s42 offen offset:2048 sc1
    v_mfma_f32_16x16x32_bf16 v[88:91], v[144:147], a[24:27], v[88:91]
    ds_read_b128 v[184:187], v1 offset:45056
    v_mfma_f32_16x16x32_bf16 v[120:123], v[144:147], a[104:107], v[120:123]
    v_mov_b32 v23, v21
    s_waitcnt vmcnt(14)
    s_waitcnt lgkmcnt(5)
    v_mfma_f32_16x16x32_bf16 v[72:75], v[148:151], a[28:31], v[72:75]
    ds_read_b128 v[128:131], v1 offset:46080
    v_mfma_f32_16x16x32_bf16 v[104:107], v[148:151], a[108:111], v[104:107]
    v_permlane16_swap_b32 v20, v22
    s_cbranch_vccz L_w_15o
L_w_15:
    v_mfma_f32_16x16x32_bf16 v[76:79], v[152:155], a[28:31], v[76:79]
    ds_read_b128 v[132:135], v1 offset:47104
    v_mfma_f32_16x16x32_bf16 v[108:111], v[152:155], a[108:111], v[108:111]
    v_permlane16_swap_b32 v21, v23
    buffer_load_dwordx4 a[60:63], v1, s[88:91], s40 offen offset:3072 sc1
    v_mfma_f32_16x16x32_bf16 v[80:83], v[156:159], a[28:31], v[80:83]
    ds_read_b128 v[136:139], v1 offset:48128
    v_mfma_f32_16x16x32_bf16 v[112:115], v[156:159], a[108:111], v[112:115]
    v_add_f32 v20, v20, v22
    v_mfma_f32_16x16x32_bf16 v[84:87], v[160:163], a[28:31], v[84:87]
    ds_read_b128 v[140:143], v1 offset:49152
    v_mfma_f32_16x16x32_bf16 v[116:119], v[160:163], a[108:111], v[116:119]
    v_add_f32 v21, v21, v23
    buffer_load_dwordx4 a[140:143], v1, s[88:91], s42 offen offset:3072 sc1
    v_mfma_f32_16x16x32_bf16 v[88:91], v[164:167], a[28:31], v[88:91]
    ds_read_b128 v[144:147], v1 offset:50176
    v_mfma_f32_16x16x32_bf16 v[120:123], v[164:167], a[108:111], v[120:123]
    v_mul_f32 v20, 0x3acccccd, v20
    s_waitcnt vmcnt(14)
    s_waitcnt lgkmcnt(5)
    v_mfma_f32_16x16x32_bf16 v[72:75], v[168:171], a[32:35], v[72:75]
    ds_read_b128 v[148:151], v1 offset:51200
    v_mfma_f32_16x16x32_bf16 v[104:107], v[168:171], a[112:115], v[104:107]
    v_mul_f32 v22, v20, v20
    s_cbranch_vccz L_w_16o
L_w_16:
    v_mfma_f32_16x16x32_bf16 v[76:79], v[172:175], a[32:35], v[76:79]
    ds_read_b128 v[152:155], v1 offset:52224
    v_mfma_f32_16x16x32_bf16 v[108:111], v[172:175], a[112:115], v[108:111]
    v_mov_b32 v23, 0x3727c5ac
    s_add_u32 s40, s40, 4096
    buffer_load_dwordx4 a[64:67], v1, s[88:91], s40 offen offset:0 sc1
    v_mfma_f32_16x16x32_bf16 v[80:83], v[176:179], a[32:35], v[80:83]
    ds_read_b128 v[156:159], v1 offset:53248
    v_mfma_f32_16x16x32_bf16 v[112:115], v[176:179], a[112:115], v[112:115]
    v_sub_f32 v22, v23, v22
    v_mfma_f32_16x16x32_bf16 v[84:87], v[180:183], a[32:35], v[84:87]
    ds_read_b128 v[160:163], v1 offset:54272
    v_mfma_f32_16x16x32_bf16 v[116:119], v[180:183], a[112:115], v[116:119]
    v_fmac_f32 v22, 0x3acccccd, v21
    s_add_u32 s42, s42, 4096
    buffer_load_dwordx4 a[144:147], v1, s[88:91], s42 offen offset:0 sc1
    v_mfma_f32_16x16x32_bf16 v[88:91], v[184:187], a[32:35], v[88:91]
    ds_read_b128 v[164:167], v1 offset:55296
    v_mfma_f32_16x16x32_bf16 v[120:123], v[184:187], a[112:115], v[120:123]
    v_max_f32 v22, v22, v23
    s_waitcnt vmcnt(14)
    s_waitcnt lgkmcnt(5)
    v_mfma_f32_16x16x32_bf16 v[72:75], v[128:131], a[36:39], v[72:75]
    ds_read_b128 v[168:171], v1 offset:56320
    v_mfma_f32_16x16x32_bf16 v[104:107], v[128:131], a[116:119], v[104:107]
    v_rsq_f32 v28, v22
    s_cbranch_vccz L_w_17o
L_w_17:
    v_mfma_f32_16x16x32_bf16 v[76:79], v[132:135], a[36:39], v[76:79]
    ds_read_b128 v[172:175], v1 offset:57344
    v_mfma_f32_16x16x32_bf16 v[108:111], v[132:135], a[116:119], v[108:111]
    v_mul_f32 v29, v20, v28
    buffer_load_dwordx4 a[68:71], v1, s[88:91], s40 offen offset:1024 sc1
    v_mfma_f32_16x16x32_bf16 v[80:83], v[136:139], a[36:39], v[80:83]
    ds_read_b128 v[176:179], v1 offset:58368
    v_mfma_f32_16x16x32_bf16 v[112:115], v[136:139], a[116:119], v[112:115]
    v_sub_f32 v29, 0, v29
    v_mfma_f32_16x16x32_bf16 v[84:87], v[140:143], a[36:39], v[84:87]
    ds_read_b128 v[180:183], v1 offset:59392
    v_mfma_f32_16x16x32_bf16 v[116:119], v[140:143], a[116:119], v[116:119]
    v_add_f32 v24, v24, v26
    buffer_load_dwordx4 a[148:151], v1, s[88:91], s42 offen offset:1024 sc1
    v_mfma_f32_16x16x32_bf16 v[88:91], v[144:147], a[36:39], v[88:91]
    ds_read_b128 v[184:187], v1 offset:60416
    v_mfma_f32_16x16x32_bf16 v[120:123], v[144:147], a[116:119], v[120:123]
    v_add_f32 v25, v25, v27
    s_cbranch_vccz L_s_18o
    s_waitcnt vmcnt(14)
L_s_18:
    s_waitcnt lgkmcnt(5)
    v_mfma_f32_16x16x32_bf16 v[72:75], v[148:151], a[40:43], v[72:75]
    ds_read_b128 v[128:131], v33 offset:0
    v_mfma_f32_16x16x32_bf16 v[104:107], v[148:151], a[120:123], v[104:107]
    v_mov_b32 v26, v24
    s_cbranch_vccz L_w_19o
L_w_19:
    v_mfma_f32_16x16x32_bf16 v[76:79], v[152:155], a[40:43], v[76:79]
    ds_read_b128 v[132:135], v33 offset:1024
    v_mfma_f32_16x16x32_bf16 v[108:111], v[152:155], a[120:123], v[108:111]
    v_mov_b32 v27, v25
    buffer_load_dwordx4 a[72:75], v1, s[88:91], s40 offen offset:2048 sc1
    v_mfma_f32_16x16x32_bf16 v[80:83], v[156:159], a[40:43], v[80:83]
    ds_read_b128 v[136:139], v33 offset:2048
    v_mfma_f32_16x16x32_bf16 v[112:115], v[156:159], a[120:123], v[112:115]
    v_permlane32_swap_b32 v24, v26
    v_mfma_f32_16x16x32_bf16 v[84:87], v[160:163], a[40:43], v[84:87]
    ds_read_b128 v[140:143], v33 offset:3072
    v_mfma_f32_16x16x32_bf16 v[116:119], v[160:163], a[120:123], v[116:119]
    v_permlane32_swap_b32 v25, v27
    buffer_load_dwordx4 a[152:155], v1, s[88:91], s42 offen offset:2048 sc1
    v_mfma_f32_16x16x32_bf16 v[88:91], v[164:167], a[40:43], v[88:91]
    ds_read_b128 v[144:147], v33 offset:4096
    v_mfma_f32_16x16x32_bf16 v[120:123], v[164:167], a[120:123], v[120:123]
    v_add_f32 v24, v24, v26
    s_waitcnt vmcnt(14)
    s_waitcnt lgkmcnt(5)
    v_mfma_f32_16x16x32_bf16 v[72:75], v[168:171], a[44:47], v[72:75]
    ds_read_b128 v[148:151], v33 offset:5120
    v_mfma_f32_16x16x32_bf16 v[104:107], v[168:171], a[124:127], v[104:107]
    v_add_f32 v25, v25, v27
    s_cbranch_vccz L_w_20o
L_w_20:
    v_mfma_f32_16x16x32_bf16 v[76:79], v[172:175], a[44:47], v[76:79]
    ds_read_b128 v[152:155], v33 offset:6144
    v_mfma_f32_16x16x32_bf16 v[108:111], v[172:175], a[124:127], v[108:111]
    v_mov_b32 v26, v24
    buffer_load_dwordx4 a[76:79], v1, s[88:91], s40 offen offset:3072 sc1
    v_mfma_f32_16x16x32_bf16 v[80:83], v[176:179], a[44:47], v[80:83]
    ds_read_b128 v[156:159], v33 offset:7168
    v_mfma_f32_16x16x32_bf16 v[112:115], v[176:179], a[124:127], v[112:115]
    v_mov_b32 v27, v25
    v_mfma_f32_16x16x32_bf16 v[84:87], v[180:183], a[44:47], v[84:87]
    ds_read_b128 v[160:163], v33 offset:8192
    v_mfma_f32_16x16x32_bf16 v[116:119], v[180:183], a[124:127], v[116:119]
    v_permlane16_swap_b32 v24, v26
    buffer_load_dwordx4 a[156:159], v1, s[88:91], s42 offen offset:3072 sc1
    v_mfma_f32_16x16x32_bf16 v[88:91], v[184:187], a[44:47], v[88:91]
    ds_read_b128 v[164:167], v33 offset:9216
    v_mfma_f32_16x16x32_bf16 v[120:123], v[184:187], a[124:127], v[120:123]
    v_permlane16_swap_b32 v25, v27
    s_waitcnt vmcnt(14)
    s_waitcnt lgkmcnt(5)
    v_mfma_f32_16x16x32_bf16 v[72:75], v[128:131], a[48:51], v[72:75]
    ds_read_b128 v[168:171], v33 offset:10240
    v_mfma_f32_16x16x32_bf16 v[104:107], v[128:131], a[128:131], v[104:107]
    v_add_f32 v24, v24, v26
    v_mfma_f32_16x16x32_bf16 v[76:79], v[132:135], a[48:51], v[76:79]
    ds_read_b128 v[172:175], v33 offset:11264
    v_mfma_f32_16x16x32_bf16 v[108:111], v[132:135], a[128:131], v[108:111]
    v_add_f32 v25, v25, v27
    s_mov_b32 m0, s0
    s_nop 0
    buffer_load_dwordx4 v1, s[4:7], s1 offen offset:0 sc1 lds
    v_mfma_f32_16x16x32_bf16 v[80:83], v[136:139], a[48:51], v[80:83]
    ds_read_b128 v[176:179], v33 offset:12288
    v_mfma_f32_16x16x32_bf16 v[112:115], v[136:139], a[128:131], v[112:115]
    v_mul_f32 v24, 0x3acccccd, v24
    v_mfma_f32_16x16x32_bf16 v[84:87], v[140:143], a[48:51], v[84:87]
    ds_read_b128 v[180:183], v33 offset:13312
    v_mfma_f32_16x16x32_bf16 v[116:119], v[140:143], a[128:131], v[116:119]
    v_mul_f32 v26, v24, v24
    buffer_load_dwordx4 v1, s[4:7], s1 offen offset:1024 sc1 lds
    v_mfma_f32_16x16x32_bf16 v[88:91], v[144:147], a[48:51], v[88:91]
    ds_read_b128 v[184:187], v33 offset:14336
    v_mfma_f32_16x16x32_bf16 v[120:123], v[144:147], a[128:131], v[120:123]
    v_mov_b32 v27, 0x3727c5ac
    s_waitcnt vmcnt(14)
    s_waitcnt lgkmcnt(5)
    v_mfma_f32_16x16x32_bf16 v[72:75], v[148:151], a[52:55], v[72:75]
    ds_read_b128 v[128:131], v33 offset:15360
    v_mfma_f32_16x16x32_bf16 v[104:107], v[148:151], a[132:135], v[104:107]
    v_sub_f32 v26, v27, v26
    v_mfma_f32_16x16x32_bf16 v[76:79], v[152:155], a[52:55], v[76:79]
    ds_read_b128 v[132:135], v33 offset:16384
    v_mfma_f32_16x16x32_bf16 v[108:111], v[152:155], a[132:135], v[108:111]
    v_fmac_f32 v26, 0x3acccccd, v25
    buffer_load_dwordx4 v1, s[4:7], s1 offen offset:2048 sc1 lds
    v_mfma_f32_16x16x32_bf16 v[80:83], v[156:159], a[52:55], v[80:83]
    ds_read_b128 v[136:139], v33 offset:17408
    v_mfma_f32_16x16x32_bf16 v[112:115], v[156:159], a[132:135], v[112:115]
    v_max_f32 v26, v26, v27
    v_mfma_f32_16x16x32_bf16 v[84:87], v[160:163], a[52:55], v[84:87]
    ds_read_b128 v[140:143], v33 offset:18432
    v_mfma_f32_16x16x32_bf16 v[116:119], v[160:163], a[132:135], v[116:119]
    v_rsq_f32 v30, v26
    buffer_load_dwordx4 v1, s[4:7], s1 offen offset:3072 sc1 lds
    v_mfma_f32_16x16x32_bf16 v[88:91], v[164:167], a[52:55], v[88:91]
    ds_read_b128 v[144:147], v33 offset:19456
    v_mfma_f32_16x16x32_bf16 v[120:123], v[164:167], a[132:135], v[120:123]
    v_mul_f32 v31, v24, v30
    s_cbranch_vccz L_s_21o
    s_waitcnt vmcnt(14)
L_s_21:
    s_waitcnt lgkmcnt(5)
    v_mfma_f32_16x16x32_bf16 v[72:75], v[168:171], a[56:59], v[72:75]
    ds_read_b128 v[148:151], v33 offset:20480
    v_mfma_f32_16x16x32_bf16 v[104:107], v[168:171], a[136:139], v[104:107]
    v_sub_f32 v31, 0, v31
    v_mfma_f32_16x16x32_bf16 v[76:79], v[172:175], a[56:59], v[76:79]
    ds_read_b128 v[152:155], v33 offset:21504
    v_mfma_f32_16x16x32_bf16 v[108:111], v[172:175], a[136:139], v[108:111]
    s_add_u32 s0, s0, 4096
    s_add_u32 s1, s1, 4096
    s_mov_b32 m0, s0
    s_nop 0
    buffer_load_dwordx4 v1, s[4:7], s1 offen offset:0 sc1 lds
    v_mfma_f32_16x16x32_bf16 v[80:83], v[176:179], a[56:59], v[80:83]
    ds_read_b128 v[156:159], v33 offset:22528
    v_mfma_f32_16x16x32_bf16 v[112:115], v[176:179], a[136:139], v[112:115]
    v_mfma_f32_16x16x32_bf16 v[84:87], v[180:183], a[56:59], v[84:87]
    ds_read_b128 v[160:163], v33 offset:23552
    v_mfma_f32_16x16x32_bf16 v[116:119], v[180:183], a[136:139], v[116:119]
    buffer_load_dwordx4 v1, s[4:7], s1 offen offset:1024 sc1 lds
    v_mfma_f32_16x16x32_bf16 v[88:91], v[184:187], a[56:59], v[88:91]
    ds_read_b128 v[164:167], v33 offset:24576
    v_mfma_f32_16x16x32_bf16 v[120:123], v[184:187], a[136:139], v[120:123]
    s_waitcnt vmcnt(14)
    s_waitcnt lgkmcnt(5)
    v_mfma_f32_16x16x32_bf16 v[72:75], v[128:131], a[60:63], v[72:75]
    ds_read_b128 v[168:171], v33 offset:25600
    v_mfma_f32_16x16x32_bf16 v[104:107], v[128:131], a[140:143], v[104:107]
    v_mfma_f32_16x16x32_bf16 v[76:79], v[132:135], a[60:63], v[76:79]
    ds_read_b128 v[172:175], v33 offset:26624
    v_mfma_f32_16x16x32_bf16 v[108:111], v[132:135], a[140:143], v[108:111]
    buffer_load_dwordx4 v1, s[4:7], s1 offen offset:2048 sc1 lds
    v_mfma_f32_16x16x32_bf16 v[80:83], v[136:139], a[60:63], v[80:83]
    ds_read_b128 v[176:179], v33 offset:27648
    v_mfma_f32_16x16x32_bf16 v[112:115], v[136:139], a[140:143], v[112:115]
    v_mfma_f32_16x16x32_bf16 v[84:87], v[140:143], a[60:63], v[84:87]
    ds_read_b128 v[180:183], v33 offset:28672
    v_mfma_f32_16x16x32_bf16 v[116:119], v[140:143], a[140:143], v[116:119]
    buffer_load_dwordx4 v1, s[4:7], s1 offen offset:3072 sc1 lds
    v_mfma_f32_16x16x32_bf16 v[88:91], v[144:147], a[60:63], v[88:91]
    ds_read_b128 v[184:187], v33 offset:29696
    v_mfma_f32_16x16x32_bf16 v[120:123], v[144:147], a[140:143], v[120:123]
    s_waitcnt vmcnt(14)
    s_waitcnt lgkmcnt(5)
    v_mfma_f32_16x16x32_bf16 v[72:75], v[148:151], a[64:67], v[72:75]
    ds_read_b128 v[128:131], v33 offset:30720
    v_mfma_f32_16x16x32_bf16 v[104:107], v[148:151], a[144:147], v[104:107]
    v_mfma_f32_16x16x32_bf16 v[76:79], v[152:155], a[64:67], v[76:79]
    ds_read_b128 v[132:135], v33 offset:31744
    v_mfma_f32_16x16x32_bf16 v[108:111], v[152:155], a[144:147], v[108:111]
    s_add_u32 s0, s0, 4096
    s_add_u32 s1, s1, 4096
    s_mov_b32 m0, s0
    s_nop 0
    buffer_load_dwordx4 v1, s[4:7], s1 offen offset:0 sc1 lds
    v_mfma_f32_16x16x32_bf16 v[80:83], v[156:159], a[64:67], v[80:83]
    ds_read_b128 v[136:139], v33 offset:32768
    v_mfma_f32_16x16x32_bf16 v[112:115], v[156:159], a[144:147], v[112:115]
    v_mfma_f32_16x16x32_bf16 v[84:87], v[160:163], a[64:67], v[84:87]
    ds_read_b128 v[140:143], v33 offset:33792
    v_mfma_f32_16x16x32_bf16 v[116:119], v[160:163], a[144:147], v[116:119]
    buffer_load_dwordx4 v1, s[4:7], s1 offen offset:1024 sc1 lds
    v_mfma_f32_16x16x32_bf16 v[88:91], v[164:167], a[64:67], v[88:91]
    ds_read_b128 v[144:147], v33 offset:34816
    v_mfma_f32_16x16x32_bf16 v[120:123], v[164:167], a[144:147], v[120:123]
    s_waitcnt vmcnt(14)
    s_waitcnt lgkmcnt(5)
    v_mfma_f32_16x16x32_bf16 v[72:75], v[168:171], a[68:71], v[72:75]
    ds_read_b128 v[148:151], v33 offset:35840
    v_mfma_f32_16x16x32_bf16 v[104:107], v[168:171], a[148:151], v[104:107]
    v_mfma_f32_16x16x32_bf16 v[76:79], v[172:175], a[68:71], v[76:79]
    ds_read_b128 v[152:155], v33 offset:36864
    v_mfma_f32_16x16x32_bf16 v[108:111], v[172:175], a[148:151], v[108:111]
    buffer_load_dwordx4 v1, s[4:7], s1 offen offset:2048 sc1 lds
    v_mfma_f32_16x16x32_bf16 v[80:83], v[176:179], a[68:71], v[80:83]
    ds_read_b128 v[156:159], v33 offset:37888
    v_mfma_f32_16x16x32_bf16 v[112:115], v[176:179], a[148:151], v[112:115]
    v_mfma_f32_16x16x32_bf16 v[84:87], v[180:183], a[68:71], v[84:87]
    ds_read_b128 v[160:163], v33 offset:38912
    v_mfma_f32_16x16x32_bf16 v[116:119], v[180:183], a[148:151], v[116:119]
    buffer_load_dwordx4 v1, s[4:7], s1 offen offset:3072 sc1 lds
    v_mfma_f32_16x16x32_bf16 v[88:91], v[184:187], a[68:71], v[88:91]
    ds_read_b128 v[164:167], v33 offset:39936
    v_mfma_f32_16x16x32_bf16 v[120:123], v[184:187], a[148:151], v[120:123]
    ds_read_b128 v[192:195], v252 offset:0
    ds_read_b128 v[196:199], v252 offset:64
    ds_read_b128 v[200:203], v252 offset:128
    ds_read_b128 v[204:207], v252 offset:192
    ds_read_b128 v[208:211], v252 offset:256
    ds_read_b128 v[212:215], v252 offset:320
    ds_read_b128 v[216:219], v252 offset:384
    ds_read_b128 v[220:223], v252 offset:448
    s_waitcnt vmcnt(14)
    s_waitcnt lgkmcnt(13)
    v_mfma_f32_16x16x32_bf16 v[72:75], v[128:131], a[72:75], v[72:75]
    v_mfma_f32_16x16x32_bf16 v[104:107], v[128:131], a[152:155], v[104:107]
    v_mfma_f32_16x16x32_bf16 v[76:79], v[132:135], a[72:75], v[76:79]
    v_mfma_f32_16x16x32_bf16 v[108:111], v[132:135], a[152:155], v[108:111]
    s_add_u32 s0, s0, 4096
    s_add_u32 s1, s1, 4096
    s_mov_b32 m0, s0
    s_nop 0
    buffer_load_dwordx4 v1, s[4:7], s1 offen offset:0 sc1 lds
    v_mfma_f32_16x16x32_bf16 v[80:83], v[136:139], a[72:75], v[80:83]
    v_mfma_f32_16x16x32_bf16 v[112:115], v[136:139], a[152:155], v[112:115]
    v_mfma_f32_16x16x32_bf16 v[84:87], v[140:143], a[72:75], v[84:87]
    v_mfma_f32_16x16x32_bf16 v[116:119], v[140:143], a[152:155], v[116:119]
    v_mfma_f32_16x16x32_bf16 v[88:91], v[144:147], a[72:75], v[88:91]
    v_mfma_f32_16x16x32_bf16 v[120:123], v[144:147], a[152:155], v[120:123]
    s_waitcnt vmcnt(13)
    s_waitcnt lgkmcnt(8)
    s_barrier
    v_mfma_f32_16x16x32_bf16 v[72:75], v[148:151], a[76:79], v[72:75]
    v_mfma_f32_16x16x32_bf16 v[104:107], v[148:151], a[156:159], v[104:107]
    v_mfma_f32_16x16x32_bf16 v[76:79], v[152:155], a[76:79], v[76:79]
    v_mfma_f32_16x16x32_bf16 v[108:111], v[152:155], a[156:159], v[108:111]
    v_mfma_f32_16x16x32_bf16 v[80:83], v[156:159], a[76:79], v[80:83]
    v_mfma_f32_16x16x32_bf16 v[112:115], v[156:159], a[156:159], v[112:115]
    v_mfma_f32_16x16x32_bf16 v[84:87], v[160:163], a[76:79], v[84:87]
    v_mfma_f32_16x16x32_bf16 v[116:119], v[160:163], a[156:159], v[116:119]
    v_mfma_f32_16x16x32_bf16 v[88:91], v[164:167], a[76:79], v[88:91]
    v_mfma_f32_16x16x32_bf16 v[120:123], v[164:167], a[156:159], v[120:123]
    s_waitcnt lgkmcnt(0)
    s_add_u32 s88, s88, 16777216
    s_addc_u32 s89, s89, 0
    v_pk_fma_f32 v[8:9], v[200:201], v[28:29], v[240:241] op_sel:[0,1,0] op_sel_hi:[1,1,0]
    v_pk_fma_f32 v[10:11], v[202:203], v[28:29], v[240:241] op_sel:[0,1,0] op_sel_hi:[1,1,0]
    v_pk_fma_f32 v[72:73], v[72:73], v[28:29], v[8:9] op_sel:[0,0,0] op_sel_hi:[1,0,1]
    v_pk_fma_f32 v[74:75], v[74:75], v[28:29], v[10:11] op_sel:[0,0,0] op_sel_hi:[1,0,1]
    v_pk_mul_f32 v[12:13], v[72:73], s[32:33]
    v_pk_mul_f32 v[14:15], v[74:75], s[32:33]
    v_exp_f32 v12, v12 clamp
    v_exp_f32 v13, v13 clamp
    v_exp_f32 v14, v14 clamp
    v_exp_f32 v15, v15 clamp
    v_max_f32 v72, v240, v72
    v_max_f32 v73, v240, v73
    v_max_f32 v74, v240, v74
    v_max_f32 v75, v240, v75
    v_pk_add_f32 v[72:73], v[72:73], v[12:13]
    v_pk_add_f32 v[74:75], v[74:75], v[14:15]
    v_cvt_pk_bf16_f32 v16, v72, v73
    v_cvt_pk_bf16_f32 v17, v74, v75
    ds_write_b64 v39, v[16:17] offset:0
    v_pk_fma_f32 v[8:9], v[204:205], v[28:29], v[240:241] op_sel:[0,1,0] op_sel_hi:[1,1,0]
    v_pk_fma_f32 v[10:11], v[206:207], v[28:29], v[240:241] op_sel:[0,1,0] op_sel_hi:[1,1,0]
    v_pk_fma_f32 v[76:77], v[76:77], v[28:29], v[8:9] op_sel:[0,0,0] op_sel_hi:[1,0,1]
    v_pk_fma_f32 v[78:79], v[78:79], v[28:29], v[10:11] op_sel:[0,0,0] op_sel_hi:[1,0,1]
    v_pk_mul_f32 v[12:13], v[76:77], s[32:33]
    v_pk_mul_f32 v[14:15], v[78:79], s[32:33]
    v_exp_f32 v12, v12 clamp
    v_exp_f32 v13, v13 clamp
    v_exp_f32 v14, v14 clamp
    v_exp_f32 v15, v15 clamp
    v_max_f32 v76, v240, v76
    v_max_f32 v77, v240, v77
    v_max_f32 v78, v240, v78
    v_max_f32 v79, v240, v79
    v_pk_add_f32 v[76:77], v[76:77], v[12:13]
    v_pk_add_f32 v[78:79], v[78:79], v[14:15]
    v_cvt_pk_bf16_f32 v18, v76, v77
    v_cvt_pk_bf16_f32 v19, v78, v79
    ds_write_b64 v39, v[18:19] offset:32
    v_pk_fma_f32 v[8:9], v[208:209], v[28:29], v[240:241] op_sel:[0,1,1] op_sel_hi:[1,1,1]
    v_pk_fma_f32 v[10:11], v[210:211], v[28:29], v[240:241] op_sel:[0,1,1] op_sel_hi:[1,1,1]
    v_pk_fma_f32 v[80:81], v[80:81], v[28:29], v[8:9] op_sel:[0,0,0] op_sel_hi:[1,0,1]
    v_pk_fma_f32 v[82:83], v[82:83], v[28:29], v[10:11] op_sel:[0,0,0] op_sel_hi:[1,0,1]
    s_mov_b32 exec_hi, 0
    v_pk_mul_f32 v[12:13], v[80:81], s[32:33]
    v_pk_mul_f32 v[14:15], v[82:83], s[32:33]
    v_exp_f32 v12, v12 clamp
    v_exp_f32 v13, v13 clamp
    v_exp_f32 v14, v14 clamp
    v_exp_f32 v15, v15 clamp
    v_max_f32 v80, v240, v80
    v_max_f32 v81, v240, v81
    v_max_f32 v82, v240, v82
    v_max_f32 v83, v240, v83
    v_pk_add_f32 v[80:81], v[80:81], v[12:13]
    v_pk_add_f32 v[82:83], v[82:83], v[14:15]
    s_mov_b32 exec_hi, -1
    v_cvt_pk_bf16_f32 v16, v80, v81
    v_cvt_pk_bf16_f32 v17, v82, v83
    ds_write_b64 v40, v[16:17] offset:64
    v_pk_mul_f32 v[8:9], v[212:213], v[28:29] op_sel:[0,1] op_sel_hi:[1,1]
    v_pk_mul_f32 v[10:11], v[214:215], v[28:29] op_sel:[0,1] op_sel_hi:[1,1]
    v_pk_fma_f32 v[84:85], v[84:85], v[28:29], v[8:9] op_sel:[0,0,0] op_sel_hi:[1,0,1]
    v_pk_fma_f32 v[86:87], v[86:87], v[28:29], v[10:11] op_sel:[0,0,0] op_sel_hi:[1,0,1]
    v_cvt_pk_bf16_f32 v18, v84, v85
    v_cvt_pk_bf16_f32 v19, v86, v87
    ds_write_b64 v39, v[18:19] offset:80
    v_pk_mul_f32 v[8:9], v[216:217], v[28:29] op_sel:[0,1] op_sel_hi:[1,1]
    v_pk_mul_f32 v[10:11], v[218:219], v[28:29] op_sel:[0,1] op_sel_hi:[1,1]
    v_pk_fma_f32 v[88:89], v[88:89], v[28:29], v[8:9] op_sel:[0,0,0] op_sel_hi:[1,0,1]
    v_pk_fma_f32 v[90:91], v[90:91], v[28:29], v[10:11] op_sel:[0,0,0] op_sel_hi:[1,0,1]
    v_cvt_pk_bf16_f32 v16, v88, v89
    v_cvt_pk_bf16_f32 v17, v90, v91
    ds_write_b64 v39, v[16:17] offset:112
    ds_write_b64 v41, v[242:243] offset:0
    v_pk_fma_f32 v[8:9], v[200:201], v[30:31], v[240:241] op_sel:[0,1,0] op_sel_hi:[1,1,0]
    v_pk_fma_f32 v[10:11], v[202:203], v[30:31], v[240:241] op_sel:[0,1,0] op_sel_hi:[1,1,0]
    v_pk_fma_f32 v[104:105], v[104:105], v[30:31], v[8:9] op_sel:[0,0,0] op_sel_hi:[1,0,1]
    v_pk_fma_f32 v[106:107], v[106:107], v[30:31], v[10:11] op_sel:[0,0,0] op_sel_hi:[1,0,1]
    v_pk_mul_f32 v[12:13], v[104:105], s[32:33]
    v_pk_mul_f32 v[14:15], v[106:107], s[32:33]
    v_exp_f32 v12, v12 clamp
    v_exp_f32 v13, v13 clamp
    v_exp_f32 v14, v14 clamp
    v_exp_f32 v15, v15 clamp
    v_max_f32 v104, v240, v104
    v_max_f32 v105, v240, v105
    v_max_f32 v106, v240, v106
    v_max_f32 v107, v240, v107
    v_pk_add_f32 v[104:105], v[104:105], v[12:13]
    v_pk_add_f32 v[106:107], v[106:107], v[14:15]
    v_cvt_pk_bf16_f32 v18, v104, v105
    v_cvt_pk_bf16_f32 v19, v106, v107
    ds_write_b64 v39, v[18:19] offset:2688
    v_pk_fma_f32 v[8:9], v[204:205], v[30:31], v[240:241] op_sel:[0,1,0] op_sel_hi:[1,1,0]
    v_pk_fma_f32 v[10:11], v[206:207], v[30:31], v[240:241] op_sel:[0,1,0] op_sel_hi:[1,1,0]
    v_pk_fma_f32 v[108:109], v[108:109], v[30:31], v[8:9] op_sel:[0,0,0] op_sel_hi:[1,0,1]
    v_pk_fma_f32 v[110:111], v[110:111], v[30:31], v[10:11] op_sel:[0,0,0] op_sel_hi:[1,0,1]
    v_pk_mul_f32 v[12:13], v[108:109], s[32:33]
    v_pk_mul_f32 v[14:15], v[110:111], s[32:33]
    v_exp_f32 v12, v12 clamp
    v_exp_f32 v13, v13 clamp
    v_exp_f32 v14, v14 clamp
    v_exp_f32 v15, v15 clamp
    v_max_f32 v108, v240, v108
    v_max_f32 v109, v240, v109
    v_max_f32 v110, v240, v110
    v_max_f32 v111, v240, v111
    v_pk_add_f32 v[108:109], v[108:109], v[12:13]
    v_pk_add_f32 v[110:111], v[110:111], v[14:15]
    v_cvt_pk_bf16_f32 v16, v108, v109
    v_cvt_pk_bf16_f32 v17, v110, v111
    ds_write_b64 v39, v[16:17] offset:2720
    v_pk_fma_f32 v[8:9], v[208:209], v[30:31], v[240:241] op_sel:[0,1,1] op_sel_hi:[1,1,1]
    v_pk_fma_f32 v[10:11], v[210:211], v[30:31], v[240:241] op_sel:[0,1,1] op_sel_hi:[1,1,1]
    v_pk_fma_f32 v[112:113], v[112:113], v[30:31], v[8:9] op_sel:[0,0,0] op_sel_hi:[1,0,1]
    v_pk_fma_f32 v[114:115], v[114:115], v[30:31], v[10:11] op_sel:[0,0,0] op_sel_hi:[1,0,1]
    s_mov_b32 exec_hi, 0
    v_pk_mul_f32 v[12:13], v[112:113], s[32:33]
    v_pk_mul_f32 v[14:15], v[114:115], s[32:33]
    v_exp_f32 v12, v12 clamp
    v_exp_f32 v13, v13 clamp
    v_exp_f32 v14, v14 clamp
    v_exp_f32 v15, v15 clamp
    v_max_f32 v112, v240, v112
    v_max_f32 v113, v240, v113
    v_max_f32 v114, v240, v114
    v_max_f32 v115, v240, v115
    v_pk_add_f32 v[112:113], v[112:113], v[12:13]
    v_pk_add_f32 v[114:115], v[114:115], v[14:15]
    s_mov_b32 exec_hi, -1
    v_cvt_pk_bf16_f32 v18, v112, v113
    v_cvt_pk_bf16_f32 v19, v114, v115
    ds_write_b64 v40, v[18:19] offset:2752
    v_pk_mul_f32 v[8:9], v[212:213], v[30:31] op_sel:[0,1] op_sel_hi:[1,1]
    v_pk_mul_f32 v[10:11], v[214:215], v[30:31] op_sel:[0,1] op_sel_hi:[1,1]
    v_pk_fma_f32 v[116:117], v[116:117], v[30:31], v[8:9] op_sel:[0,0,0] op_sel_hi:[1,0,1]
    v_pk_fma_f32 v[118:119], v[118:119], v[30:31], v[10:11] op_sel:[0,0,0] op_sel_hi:[1,0,1]
    v_cvt_pk_bf16_f32 v16, v116, v117
    v_cvt_pk_bf16_f32 v17, v118, v119
    ds_write_b64 v39, v[16:17] offset:2768
    v_pk_mul_f32 v[8:9], v[216:217], v[30:31] op_sel:[0,1] op_sel_hi:[1,1]
    v_pk_mul_f32 v[10:11], v[218:219], v[30:31] op_sel:[0,1] op_sel_hi:[1,1]
    v_pk_fma_f32 v[120:121], v[120:121], v[30:31], v[8:9] op_sel:[0,0,0] op_sel_hi:[1,0,1]
    v_pk_fma_f32 v[122:123], v[122:123], v[30:31], v[10:11] op_sel:[0,0,0] op_sel_hi:[1,0,1]
    v_cvt_pk_bf16_f32 v18, v120, v121
    v_cvt_pk_bf16_f32 v19, v122, v123
    ds_write_b64 v39, v[18:19] offset:2800
    ds_write_b64 v41, v[242:243] offset:2688
    s_cmp_eq_u32 s22, 3
    s_cbranch_scc0 L_p1_w23a
    s_cbranch_vccnz L_p1_w23a
    s_lshl_b32 s54, s24, 8
    v_mov_b32 v8, s54
    v_mov_b32 v9, 1888
    v_cmp_lt_u32 s[50:51], 19, v0
    s_nop 1
    v_cndmask_b32 v8, v8, v9, s[50:51]
    v_add_u32 v8, v8, v32
    s_mov_b32 s54, 4096
    s_mov_b64 exec, 0x3fffffff
    s_mov_b32 s36, 0
L_poll_22:
    buffer_load_dwordx2 v[4:5], v8, s[4:7], s54 offen sc1
    s_add_u32 s36, s36, 1
    s_cmp_gt_u32 s36, 2097152
    s_cbranch_scc1 L_abort
    s_waitcnt vmcnt(0)
    v_cmp_ne_u64 vcc, s[20:21], v[4:5]
    s_cbranch_vccnz L_poll_22
    s_mov_b64 exec, -1
L_p1_w23a:
    s_mul_i32 s54, s22, 18432
    s_add_u32 s55, s77, s54
    s_add_u32 s55, s55, 4194304
    s_cmp_eq_u32 s27, 0
    s_waitcnt vmcnt(0) lgkmcnt(0)
    s_barrier
    s_cbranch_scc1 L_p1_cso
L_p1_cs:
    s_cmp_ge_u32 s22, 2
    s_cbranch_scc1 L_p1_j
    ds_read_b64_tr_b16 v[128:129], v42 offset:0
    ds_read_b64_tr_b16 v[130:131], v42 offset:672
    ds_read_b64_tr_b16 v[160:161], v43 offset:0
    ds_read_b64_tr_b16 v[162:163], v43 offset:672
    ds_read_b64_tr_b16 v[132:133], v42 offset:2688
    ds_read_b64_tr_b16 v[134:135], v42 offset:3360
    ds_read_b64_tr_b16 v[164:165], v43 offset:2688
    ds_read_b64_tr_b16 v[166:167], v43 offset:3360
    ds_read_b64_tr_b16 v[136:137], v42 offset:5376
    ds_read_b64_tr_b16 v[138:139], v42 offset:6048
    ds_read_b64_tr_b16 v[168:169], v43 offset:5376
    ds_read_b64_tr_b16 v[170:171], v43 offset:6048
    s_waitcnt lgkmcnt(8)
    v_mfma_f32_32x32x16_bf16 v[72:87], v[128:131], v[160:163], 0
    ds_read_b64_tr_b16 v[140:141], v42 offset:8064
    ds_read_b64_tr_b16 v[142:143], v42 offset:8736
    ds_read_b64_tr_b16 v[172:173], v43 offset:8064
    ds_read_b64_tr_b16 v[174:175], v43 offset:8736
    s_waitcnt lgkmcnt(8)
    v_mfma_f32_32x32x16_bf16 v[72:87], v[132:135], v[164:167], v[72:87]
    ds_read_b64_tr_b16 v[144:145], v42 offset:10752
    ds_read_b64_tr_b16 v[146:147], v42 offset:11424
    ds_read_b64_tr_b16 v[176:177], v43 offset:10752
    ds_read_b64_tr_b16 v[178:179], v43 offset:11424
    s_waitcnt lgkmcnt(8)
    v_mfma_f32_32x32x16_bf16 v[72:87], v[136:139], v[168:171], v[72:87]
    ds_read_b64_tr_b16 v[148:149], v42 offset:13440
    ds_read_b64_tr_b16 v[150:151], v42 offset:14112
    ds_read_b64_tr_b16 v[180:181], v43 offset:13440
    ds_read_b64_tr_b16 v[182:183], v43 offset:14112
    s_waitcnt lgkmcnt(8)
    v_mfma_f32_32x32x16_bf16 v[72:87], v[140:143], v[172:175], v[72:87]
    ds_read_b64_tr_b16 v[152:153], v42 offset:16128
    ds_read_b64_tr_b16 v[154:155], v42 offset:16800
    ds_read_b64_tr_b16 v[184:185], v43 offset:16128
    ds_read_b64_tr_b16 v[186:187], v43 offset:16800
    s_waitcnt lgkmcnt(8)
    v_mfma_f32_32x32x16_bf16 v[72:87], v[144:147], v[176:179], v[72:87]
    ds_read_b64_tr_b16 v[156:157], v42 offset:18816
    ds_read_b64_tr_b16 v[158:159], v42 offset:19488
    ds_read_b64_tr_b16 v[188:189], v43 offset:18816
    ds_read_b64_tr_b16 v[190:191], v43 offset:19488
    s_waitcnt lgkmcnt(8)
    v_mfma_f32_32x32x16_bf16 v[72:87], v[148:151], v[180:183], v[72:87]
    s_waitcnt lgkmcnt(4)
    v_mfma_f32_32x32x16_bf16 v[72:87], v[152:155], v[184:187], v[72:87]
    s_waitcnt lgkmcnt(0)
    v_mfma_f32_32x32x16_bf16 v[72:87], v[156:159], v[188:191], v[72:87]
    v_mov_b32 v4, s20
    v_mov_b32 v5, s21
    v_accvgpr_read_b32 v7, a244
    s_nop 8
    v_cvt_pk_bf16_f32 v72, v72, v73
    v_cvt_pk_bf16_f32 v73, v74, v75
    v_cvt_pk_bf16_f32 v74, v76, v77
    v_cvt_pk_bf16_f32 v75, v78, v79
    v_cvt_pk_bf16_f32 v76, v80, v81
    v_cvt_pk_bf16_f32 v77, v82, v83
    s_mov_b32 exec_lo, 0x1fffff
    s_mov_b32 exec_hi, 0x1fffff
    buffer_store_dwordx2 v[72:73], v44, s[88:91], s68 offen sc1
    buffer_store_dwordx2 v[74:75], v44, s[88:91], s68 offen offset:336 sc1
    s_mov_b32 exec_hi, 0
    buffer_store_dwordx2 v[76:77], v44, s[88:91], s68 offen offset:672 sc1
    s_mov_b64 exec, -1
L_p1_j:
    ds_read_b128 v[128:131], v34 offset:0
    ds_read_b128 v[132:135], v34 offset:1024
    ds_read_b128 v[136:139], v35 offset:0
    ds_read_b128 v[140:143], v34 offset:2560
    ds_read_b128 v[144:147], v34 offset:3584
    ds_read_b128 v[148:151], v35 offset:2560
    s_waitcnt lgkmcnt(3)
    v_mfma_f32_16x16x32_bf16 v[64:67], v[128:131], a[0:3], 0
    ds_read_b128 v[152:155], v34 offset:5120
    v_mfma_f32_16x16x32_bf16 v[96:99], v[128:131], a[80:83], 0
    v_mfma_f32_16x16x32_bf16 v[68:71], v[132:135], a[0:3], 0
    ds_read_b128 v[156:159], v34 offset:6144
    v_mfma_f32_16x16x32_bf16 v[100:103], v[132:135], a[80:83], 0
    v_mfma_f32_16x16x32_bf16 v[92:95], v[136:139], a[0:3], 0
    ds_read_b128 v[160:163], v35 offset:5120
    v_mfma_f32_16x16x32_bf16 v[124:127], v[136:139], a[80:83], 0
    s_mov_b32 m0, s54
    s_nop 0
    buffer_load_dwordx4 v1, s[4:7], s55 offen offset:0 sc1 lds
    s_waitcnt lgkmcnt(3)
    v_mfma_f32_16x16x32_bf16 v[64:67], v[140:143], a[4:7], v[64:67]
    ds_read_b128 v[128:131], v34 offset:7680
    v_mfma_f32_16x16x32_bf16 v[96:99], v[140:143], a[84:87], v[96:99]
    v_mfma_f32_16x16x32_bf16 v[68:71], v[144:147], a[4:7], v[68:71]
    ds_read_b128 v[132:135], v34 offset:8704
    v_mfma_f32_16x16x32_bf16 v[100:103], v[144:147], a[84:87], v[100:103]
    v_mfma_f32_16x16x32_bf16 v[92:95], v[148:151], a[4:7], v[92:95]
    ds_read_b128 v[136:139], v35 offset:7680
    v_mfma_f32_16x16x32_bf16 v[124:127], v[148:151], a[84:87], v[124:127]
    buffer_load_dwordx4 v1, s[4:7], s55 offen offset:1024 sc1 lds
    s_waitcnt lgkmcnt(3)
    v_mfma_f32_16x16x32_bf16 v[64:67], v[152:155], a[8:11], v[64:67]
    ds_read_b128 v[140:143], v34 offset:10240
    v_mfma_f32_16x16x32_bf16 v[96:99], v[152:155], a[88:91], v[96:99]
    v_mfma_f32_16x16x32_bf16 v[68:71], v[156:159], a[8:11], v[68:71]
    ds_read_b128 v[144:147], v34 offset:11264
    v_mfma_f32_16x16x32_bf16 v[100:103], v[156:159], a[88:91], v[100:103]
    v_mfma_f32_16x16x32_bf16 v[92:95], v[160:163], a[8:11], v[92:95]
    ds_read_b128 v[148:151], v35 offset:10240
    v_mfma_f32_16x16x32_bf16 v[124:127], v[160:163], a[88:91], v[124:127]
    buffer_load_dwordx4 v1, s[4:7], s55 offen offset:2048 sc1 lds
    s_waitcnt lgkmcnt(3)
    v_mfma_f32_16x16x32_bf16 v[64:67], v[128:131], a[12:15], v[64:67]
    ds_read_b128 v[152:155], v34 offset:12800
    v_mfma_f32_16x16x32_bf16 v[96:99], v[128:131], a[92:95], v[96:99]
    v_mfma_f32_16x16x32_bf16 v[68:71], v[132:135], a[12:15], v[68:71]
    ds_read_b128 v[156:159], v34 offset:13824
    v_mfma_f32_16x16x32_bf16 v[100:103], v[132:135], a[92:95], v[100:103]
    v_mfma_f32_16x16x32_bf16 v[92:95], v[136:139], a[12:15], v[92:95]
    ds_read_b128 v[160:163], v35 offset:12800
    v_mfma_f32_16x16x32_bf16 v[124:127], v[136:139], a[92:95], v[124:127]
    buffer_load_dwordx4 v1, s[4:7], s55 offen offset:3072 sc1 lds
    s_waitcnt lgkmcnt(3)
    v_mfma_f32_16x16x32_bf16 v[64:67], v[140:143], a[16:19], v[64:67]
    ds_read_b128 v[128:131], v34 offset:15360
    v_mfma_f32_16x16x32_bf16 v[96:99], v[140:143], a[96:99], v[96:99]
    v_mfma_f32_16x16x32_bf16 v[68:71], v[144:147], a[16:19], v[68:71]
    ds_read_b128 v[132:135], v34 offset:16384
    v_mfma_f32_16x16x32_bf16 v[100:103], v[144:147], a[96:99], v[100:103]
    v_mfma_f32_16x16x32_bf16 v[92:95], v[148:151], a[16:19], v[92:95]
    ds_read_b128 v[136:139], v35 offset:15360
    v_mfma_f32_16x16x32_bf16 v[124:127], v[148:151], a[96:99], v[124:127]
    s_add_u32 s54, s54, 4096
    s_add_u32 s55, s55, 4096
    s_mov_b32 m0, s54
    s_nop 0
    buffer_load_dwordx4 v1, s[4:7], s55 offen offset:0 sc1 lds
    s_waitcnt lgkmcnt(3)
    v_mfma_f32_16x16x32_bf16 v[64:67], v[152:155], a[20:23], v[64:67]
    ds_read_b128 v[140:143], v34 offset:17920
    v_mfma_f32_16x16x32_bf16 v[96:99], v[152:155], a[100:103], v[96:99]
    v_mfma_f32_16x16x32_bf16 v[68:71], v[156:159], a[20:23], v[68:71]
    ds_read_b128 v[144:147], v34 offset:18944
    v_mfma_f32_16x16x32_bf16 v[100:103], v[156:159], a[100:103], v[100:103]
    v_mfma_f32_16x16x32_bf16 v[92:95], v[160:163], a[20:23], v[92:95]
    ds_read_b128 v[148:151], v35 offset:17920
    v_mfma_f32_16x16x32_bf16 v[124:127], v[160:163], a[100:103], v[124:127]
    buffer_load_dwordx4 v1, s[4:7], s55 offen offset:1024 sc1 lds
    s_waitcnt lgkmcnt(3)
    v_mfma_f32_16x16x32_bf16 v[64:67], v[128:131], a[24:27], v[64:67]
    ds_read_b128 v[152:155], v34 offset:20480
    v_mfma_f32_16x16x32_bf16 v[96:99], v[128:131], a[104:107], v[96:99]
    v_mfma_f32_16x16x32_bf16 v[68:71], v[132:135], a[24:27], v[68:71]
    ds_read_b128 v[156:159], v34 offset:21504
    v_mfma_f32_16x16x32_bf16 v[100:103], v[132:135], a[104:107], v[100:103]
    v_mfma_f32_16x16x32_bf16 v[92:95], v[136:139], a[24:27], v[92:95]
    ds_read_b128 v[160:163], v35 offset:20480
    v_mfma_f32_16x16x32_bf16 v[124:127], v[136:139], a[104:107], v[124:127]
    buffer_load_dwordx4 v1, s[4:7], s55 offen offset:2048 sc1 lds
    s_waitcnt lgkmcnt(3)
    v_mfma_f32_16x16x32_bf16 v[64:67], v[140:143], a[28:31], v[64:67]
    ds_read_b128 v[128:131], v34 offset:23040
    v_mfma_f32_16x16x32_bf16 v[96:99], v[140:143], a[108:111], v[96:99]
    v_mfma_f32_16x16x32_bf16 v[68:71], v[144:147], a[28:31], v[68:71]
    ds_read_b128 v[132:135], v34 offset:24064
    v_mfma_f32_16x16x32_bf16 v[100:103], v[144:147], a[108:111], v[100:103]
    v_mfma_f32_16x16x32_bf16 v[92:95], v[148:151], a[28:31], v[92:95]
    ds_read_b128 v[136:139], v35 offset:23040
    v_mfma_f32_16x16x32_bf16 v[124:127], v[148:151], a[108:111], v[124:127]
    buffer_load_dwordx4 v1, s[4:7], s55 offen offset:3072 sc1 lds
    s_waitcnt lgkmcnt(3)
    v_mfma_f32_16x16x32_bf16 v[64:67], v[152:155], a[32:35], v[64:67]
    ds_read_b128 v[140:143], v34 offset:25600
    v_mfma_f32_16x16x32_bf16 v[96:99], v[152:155], a[112:115], v[96:99]
    v_mfma_f32_16x16x32_bf16 v[68:71], v[156:159], a[32:35], v[68:71]
    ds_read_b128 v[144:147], v34 offset:26624
    v_mfma_f32_16x16x32_bf16 v[100:103], v[156:159], a[112:115], v[100:103]
    v_mfma_f32_16x16x32_bf16 v[92:95], v[160:163], a[32:35], v[92:95]
    ds_read_b128 v[148:151], v35 offset:25600
    v_mfma_f32_16x16x32_bf16 v[124:127], v[160:163], a[112:115], v[124:127]
    s_cmp_ge_u32 s22, 2
    s_cbranch_scc1 L_p1_s
    s_mov_b64 exec, 1
    s_waitcnt vmcnt(8)
    ds_add_rtn_u32 v6, v36, v37
    s_waitcnt lgkmcnt(0)
    v_readfirstlane_b32 s44, v6
    s_bitcmp1_b32 s44, 0
    s_cbranch_scc0 L_p1_s
    s_mov_b64 exec, 0xffff
    buffer_store_dwordx2 v[4:5], v7, s[88:91], s69 offen sc1
L_p1_s:
    s_mov_b64 exec, -1
    s_add_u32 s54, s54, 4096
    s_add_u32 s55, s55, 4096
    s_mov_b32 m0, s54
    s_nop 0
    buffer_load_dwordx4 v1, s[4:7], s55 offen offset:0 sc1 lds
    s_waitcnt lgkmcnt(3)
    v_mfma_f32_16x16x32_bf16 v[64:67], v[128:131], a[36:39], v[64:67]
    ds_read_b128 v[152:155], v34 offset:28160
    v_mfma_f32_16x16x32_bf16 v[96:99], v[128:131], a[116:119], v[96:99]
    v_mfma_f32_16x16x32_bf16 v[68:71], v[132:135], a[36:39], v[68:71]
    ds_read_b128 v[156:159], v34 offset:29184
    v_mfma_f32_16x16x32_bf16 v[100:103], v[132:135], a[116:119], v[100:103]
    v_mfma_f32_16x16x32_bf16 v[92:95], v[136:139], a[36:39], v[92:95]
    ds_read_b128 v[160:163], v35 offset:28160
    v_mfma_f32_16x16x32_bf16 v[124:127], v[136:139], a[116:119], v[124:127]
    buffer_load_dwordx4 v1, s[4:7], s55 offen offset:1024 sc1 lds
    s_waitcnt lgkmcnt(3)
    v_mfma_f32_16x16x32_bf16 v[64:67], v[140:143], a[40:43], v[64:67]
    ds_read_b128 v[128:131], v34 offset:30720
    v_mfma_f32_16x16x32_bf16 v[96:99], v[140:143], a[120:123], v[96:99]
    v_mfma_f32_16x16x32_bf16 v[68:71], v[144:147], a[40:43], v[68:71]
    ds_read_b128 v[132:135], v34 offset:31744
    v_mfma_f32_16x16x32_bf16 v[100:103], v[144:147], a[120:123], v[100:103]
    v_mfma_f32_16x16x32_bf16 v[92:95], v[148:151], a[40:43], v[92:95]
    ds_read_b128 v[136:139], v35 offset:30720
    v_mfma_f32_16x16x32_bf16 v[124:127], v[148:151], a[120:123], v[124:127]
    buffer_load_dwordx4 v1, s[4:7], s55 offen offset:2048 sc1 lds
    s_waitcnt lgkmcnt(3)
    v_mfma_f32_16x16x32_bf16 v[64:67], v[152:155], a[44:47], v[64:67]
    ds_read_b128 v[140:143], v34 offset:33280
    v_mfma_f32_16x16x32_bf16 v[96:99], v[152:155], a[124:127], v[96:99]
    v_mfma_f32_16x16x32_bf16 v[68:71], v[156:159], a[44:47], v[68:71]
    ds_read_b128 v[144:147], v34 offset:34304
    v_mfma_f32_16x16x32_bf16 v[100:103], v[156:159], a[124:127], v[100:103]
    v_mfma_f32_16x16x32_bf16 v[92:95], v[160:163], a[44:47], v[92:95]
    ds_read_b128 v[148:151], v35 offset:33280
    v_mfma_f32_16x16x32_bf16 v[124:127], v[160:163], a[124:127], v[124:127]
    buffer_load_dwordx4 v1, s[4:7], s55 offen offset:3072 sc1 lds
    s_waitcnt lgkmcnt(3)
    v_mfma_f32_16x16x32_bf16 v[64:67], v[128:131], a[48:51], v[64:67]
    ds_read_b128 v[152:155], v34 offset:35840
    v_mfma_f32_16x16x32_bf16 v[96:99], v[128:131], a[128:131], v[96:99]
    v_mfma_f32_16x16x32_bf16 v[68:71], v[132:135], a[48:51], v[68:71]
    ds_read_b128 v[156:159], v34 offset:36864
    v_mfma_f32_16x16x32_bf16 v[100:103], v[132:135], a[128:131], v[100:103]
    v_mfma_f32_16x16x32_bf16 v[92:95], v[136:139], a[48:51], v[92:95]
    ds_read_b128 v[160:163], v35 offset:35840
    v_mfma_f32_16x16x32_bf16 v[124:127], v[136:139], a[128:131], v[124:127]
    s_add_u32 s54, s54, 4096
    s_add_u32 s55, s55, 4096
    s_mov_b32 m0, s54
    s_nop 0
    buffer_load_dwordx4 v1, s[4:7], s55 offen offset:0 sc1 lds
    s_waitcnt lgkmcnt(3)
    v_mfma_f32_16x16x32_bf16 v[64:67], v[140:143], a[52:55], v[64:67]
    ds_read_b128 v[128:131], v34 offset:38400
    v_mfma_f32_16x16x32_bf16 v[96:99], v[140:143], a[132:135], v[96:99]
    v_mfma_f32_16x16x32_bf16 v[68:71], v[144:147], a[52:55], v[68:71]
    ds_read_b128 v[132:135], v34 offset:39424
    v_mfma_f32_16x16x32_bf16 v[100:103], v[144:147], a[132:135], v[100:103]
    v_mfma_f32_16x16x32_bf16 v[92:95], v[148:151], a[52:55], v[92:95]
    ds_read_b128 v[136:139], v35 offset:38400
    v_mfma_f32_16x16x32_bf16 v[124:127], v[148:151], a[132:135], v[124:127]
    buffer_load_dwordx4 v1, s[4:7], s55 offen offset:1024 sc1 lds
    s_waitcnt lgkmcnt(3)
    v_mfma_f32_16x16x32_bf16 v[64:67], v[152:155], a[56:59], v[64:67]
    ds_read_b128 v[140:143], v34 offset:40960
    v_mfma_f32_16x16x32_bf16 v[96:99], v[152:155], a[136:139], v[96:99]
    v_mfma_f32_16x16x32_bf16 v[68:71], v[156:159], a[56:59], v[68:71]
    ds_read_b128 v[144:147], v34 offset:41984
    v_mfma_f32_16x16x32_bf16 v[100:103], v[156:159], a[136:139], v[100:103]
    v_mfma_f32_16x16x32_bf16 v[92:95], v[160:163], a[56:59], v[92:95]
    ds_read_b128 v[148:151], v35 offset:40960
    v_mfma_f32_16x16x32_bf16 v[124:127], v[160:163], a[136:139], v[124:127]
    buffer_load_dwordx4 v1, s[4:7], s55 offen offset:2048 sc1 lds
    s_waitcnt lgkmcnt(3)
    v_mfma_f32_16x16x32_bf16 v[64:67], v[128:131], a[60:63], v[64:67]
    ds_read_b128 v[152:155], v34 offset:43520
    v_mfma_f32_16x16x32_bf16 v[96:99], v[128:131], a[140:143], v[96:99]
    v_mfma_f32_16x16x32_bf16 v[68:71], v[132:135], a[60:63], v[68:71]
    ds_read_b128 v[156:159], v34 offset:44544
    v_mfma_f32_16x16x32_bf16 v[100:103], v[132:135], a[140:143], v[100:103]
    v_mfma_f32_16x16x32_bf16 v[92:95], v[136:139], a[60:63], v[92:95]
    ds_read_b128 v[160:163], v35 offset:43520
    v_mfma_f32_16x16x32_bf16 v[124:127], v[136:139], a[140:143], v[124:127]
    buffer_load_dwordx4 v1, s[4:7], s55 offen offset:3072 sc1 lds
    s_waitcnt lgkmcnt(3)
    v_mfma_f32_16x16x32_bf16 v[64:67], v[140:143], a[64:67], v[64:67]
    ds_read_b128 v[128:131], v34 offset:46080
    v_mfma_f32_16x16x32_bf16 v[96:99], v[140:143], a[144:147], v[96:99]
    v_mfma_f32_16x16x32_bf16 v[68:71], v[144:147], a[64:67], v[68:71]
    ds_read_b128 v[132:135], v34 offset:47104
    v_mfma_f32_16x16x32_bf16 v[100:103], v[144:147], a[144:147], v[100:103]
    v_mfma_f32_16x16x32_bf16 v[92:95], v[148:151], a[64:67], v[92:95]
    ds_read_b128 v[136:139], v35 offset:46080
    v_mfma_f32_16x16x32_bf16 v[124:127], v[148:151], a[144:147], v[124:127]
    s_add_u32 s54, s54, 4096
    s_add_u32 s55, s55, 4096
    s_mov_b32 m0, s54
    s_nop 0
    buffer_load_dwordx4 v1, s[4:7], s55 offen offset:0 sc1 lds
    s_waitcnt lgkmcnt(3)
    v_mfma_f32_16x16x32_bf16 v[64:67], v[152:155], a[68:71], v[64:67]
    ds_read_b128 v[140:143], v34 offset:48640
    v_mfma_f32_16x16x32_bf16 v[96:99], v[152:155], a[148:151], v[96:99]
    v_mfma_f32_16x16x32_bf16 v[68:71], v[156:159], a[68:71], v[68:71]
    ds_read_b128 v[144:147], v34 offset:49664
    v_mfma_f32_16x16x32_bf16 v[100:103], v[156:159], a[148:151], v[100:103]
    v_mfma_f32_16x16x32_bf16 v[92:95], v[160:163], a[68:71], v[92:95]
    ds_read_b128 v[148:151], v35 offset:48640
    v_mfma_f32_16x16x32_bf16 v[124:127], v[160:163], a[148:151], v[124:127]
    buffer_load_dwordx4 v1, s[4:7], s55 offen offset:1024 sc1 lds
    s_waitcnt lgkmcnt(3)
    v_mfma_f32_16x16x32_bf16 v[64:67], v[128:131], a[72:75], v[64:67]
    v_mfma_f32_16x16x32_bf16 v[96:99], v[128:131], a[152:155], v[96:99]
    v_mfma_f32_16x16x32_bf16 v[68:71], v[132:135], a[72:75], v[68:71]
    v_mfma_f32_16x16x32_bf16 v[100:103], v[132:135], a[152:155], v[100:103]
    v_mfma_f32_16x16x32_bf16 v[92:95], v[136:139], a[72:75], v[92:95]
    v_mfma_f32_16x16x32_bf16 v[124:127], v[136:139], a[152:155], v[124:127]
    s_waitcnt lgkmcnt(0)
    v_mfma_f32_16x16x32_bf16 v[64:67], v[140:143], a[76:79], v[64:67]
    v_mfma_f32_16x16x32_bf16 v[96:99], v[140:143], a[156:159], v[96:99]
    v_mfma_f32_16x16x32_bf16 v[68:71], v[144:147], a[76:79], v[68:71]
    v_mfma_f32_16x16x32_bf16 v[100:103], v[144:147], a[156:159], v[100:103]
    v_mfma_f32_16x16x32_bf16 v[92:95], v[148:151], a[76:79], v[92:95]
    v_mfma_f32_16x16x32_bf16 v[124:127], v[148:151], a[156:159], v[124:127]
    s_cmp_eq_u32 s27, 0
    s_cbranch_scc1 L_p1_c2o
L_p1_c2:
    s_add_u32 s44, s67, 12582912
    s_mul_i32 s40, s26, 28672
    s_add_u32 s40, s40, 65536
    s_cmp_eq_u32 s22, 3
    s_cbranch_scc0 L_p1_l
    s_mov_b64 exec, 0xffff
    s_mov_b32 s36, 0
L_poll_23:
    buffer_load_dwordx2 v[4:5], v32, s[88:91], s44 offen sc1
    s_add_u32 s36, s36, 1
    s_cmp_gt_u32 s36, 2097152
    s_cbranch_scc1 L_abort
    s_waitcnt vmcnt(0)
    v_cmp_ne_u64 vcc, s[20:21], v[4:5]
    s_cbranch_vccnz L_poll_23
    s_mov_b64 exec, -1
L_p1_l:
    s_barrier
    buffer_load_dwordx2 v[128:129], v45, s[88:91], s40 offen offset:0 sc1
    buffer_load_dwordx2 v[130:131], v45, s[88:91], s40 offen offset:1792 sc1
    s_add_u32 s40, s40, 3584
    buffer_load_dwordx2 v[132:133], v45, s[88:91], s40 offen offset:0 sc1
    buffer_load_dwordx2 v[134:135], v45, s[88:91], s40 offen offset:1792 sc1
    s_add_u32 s40, s40, 3584
    buffer_load_dwordx2 v[136:137], v45, s[88:91], s40 offen offset:0 sc1
    v_pk_fma_f32 v[8:9], v[192:193], v[28:29], v[240:241] op_sel:[0,1,0] op_sel_hi:[1,1,0]
    v_pk_fma_f32 v[10:11], v[194:195], v[28:29], v[240:241] op_sel:[0,1,0] op_sel_hi:[1,1,0]
    v_pk_fma_f32 v[64:65], v[64:65], v[28:29], v[8:9] op_sel:[0,0,0] op_sel_hi:[1,0,1]
    v_pk_fma_f32 v[66:67], v[66:67], v[28:29], v[10:11] op_sel:[0,0,0] op_sel_hi:[1,0,1]
    buffer_load_dwordx2 v[138:139], v45, s[88:91], s40 offen offset:1792 sc1
    v_pk_mul_f32 v[12:13], v[64:65], s[32:33]
    v_pk_mul_f32 v[14:15], v[66:67], s[32:33]
    v_exp_f32 v12, v12 clamp
    v_exp_f32 v13, v13 clamp
    v_exp_f32 v14, v14 clamp
    v_exp_f32 v15, v15 clamp
    v_max_f32 v64, v240, v64
    v_max_f32 v65, v240, v65
    v_max_f32 v66, v240, v66
    v_max_f32 v67, v240, v67
    v_pk_add_f32 v[64:65], v[64:65], v[12:13]
    v_pk_add_f32 v[66:67], v[66:67], v[14:15]
    s_add_u32 s40, s40, 3584
    buffer_load_dwordx2 v[140:141], v45, s[88:91], s40 offen offset:0 sc1
    v_pk_fma_f32 v[8:9], v[196:197], v[28:29], v[240:241] op_sel:[0,1,0] op_sel_hi:[1,1,0]
    v_pk_fma_f32 v[10:11], v[198:199], v[28:29], v[240:241] op_sel:[0,1,0] op_sel_hi:[1,1,0]
    v_pk_fma_f32 v[68:69], v[68:69], v[28:29], v[8:9] op_sel:[0,0,0] op_sel_hi:[1,0,1]
    v_pk_fma_f32 v[70:71], v[70:71], v[28:29], v[10:11] op_sel:[0,0,0] op_sel_hi:[1,0,1]
    buffer_load_dwordx2 v[142:143], v45, s[88:91], s40 offen offset:1792 sc1
    v_pk_mul_f32 v[12:13], v[68:69], s[32:33]
    v_pk_mul_f32 v[14:15], v[70:71], s[32:33]
    v_exp_f32 v12, v12 clamp
    v_exp_f32 v13, v13 clamp
    v_exp_f32 v14, v14 clamp
    v_exp_f32 v15, v15 clamp
    v_max_f32 v68, v240, v68
    v_max_f32 v69, v240, v69
    v_max_f32 v70, v240, v70
    v_max_f32 v71, v240, v71
    v_pk_add_f32 v[68:69], v[68:69], v[12:13]
    v_pk_add_f32 v[70:71], v[70:71], v[14:15]
    s_add_u32 s40, s40, 3584
    buffer_load_dwordx2 v[144:145], v45, s[88:91], s40 offen offset:0 sc1
    v_pk_fma_f32 v[8:9], v[220:221], v[28:29], v[240:241] op_sel:[0,1,0] op_sel_hi:[1,1,0]
    v_pk_fma_f32 v[10:11], v[222:223], v[28:29], v[240:241] op_sel:[0,1,0] op_sel_hi:[1,1,0]
    v_pk_fma_f32 v[92:93], v[92:93], v[28:29], v[8:9] op_sel:[0,0,0] op_sel_hi:[1,0,1]
    v_pk_fma_f32 v[94:95], v[94:95], v[28:29], v[10:11] op_sel:[0,0,0] op_sel_hi:[1,0,1]
    buffer_load_dwordx2 v[146:147], v45, s[88:91], s40 offen offset:1792 sc1
    v_pk_mul_f32 v[12:13], v[92:93], s[32:33]
    v_pk_mul_f32 v[14:15], v[94:95], s[32:33]
    v_exp_f32 v12, v12 clamp
    v_exp_f32 v13, v13 clamp
    v_exp_f32 v14, v14 clamp
    v_exp_f32 v15, v15 clamp
    v_max_f32 v92, v240, v92
    v_max_f32 v93, v240, v93
    v_max_f32 v94, v240, v94
    v_max_f32 v95, v240, v95
    v_pk_add_f32 v[92:93], v[92:93], v[12:13]
    v_pk_add_f32 v[94:95], v[94:95], v[14:15]
    s_add_u32 s40, s40, 3584
    buffer_load_dwordx2 v[148:149], v45, s[88:91], s40 offen offset:0 sc1
    v_pk_fma_f32 v[8:9], v[192:193], v[30:31], v[240:241] op_sel:[0,1,0] op_sel_hi:[1,1,0]
    v_pk_fma_f32 v[10:11], v[194:195], v[30:31], v[240:241] op_sel:[0,1,0] op_sel_hi:[1,1,0]
    v_pk_fma_f32 v[96:97], v[96:97], v[30:31], v[8:9] op_sel:[0,0,0] op_sel_hi:[1,0,1]
    v_pk_fma_f32 v[98:99], v[98:99], v[30:31], v[10:11] op_sel:[0,0,0] op_sel_hi:[1,0,1]
    buffer_load_dwordx2 v[150:151], v45, s[88:91], s40 offen offset:1792 sc1
    v_pk_mul_f32 v[12:13], v[96:97], s[32:33]
    v_pk_mul_f32 v[14:15], v[98:99], s[32:33]
    v_exp_f32 v12, v12 clamp
    v_exp_f32 v13, v13 clamp
    v_exp_f32 v14, v14 clamp
    v_exp_f32 v15, v15 clamp
    v_max_f32 v96, v240, v96
    v_max_f32 v97, v240, v97
    v_max_f32 v98, v240, v98
    v_max_f32 v99, v240, v99
    v_pk_add_f32 v[96:97], v[96:97], v[12:13]
    v_pk_add_f32 v[98:99], v[98:99], v[14:15]
    s_add_u32 s40, s40, 3584
    buffer_load_dwordx2 v[152:153], v45, s[88:91], s40 offen offset:0 sc1
    v_pk_fma_f32 v[8:9], v[196:197], v[30:31], v[240:241] op_sel:[0,1,0] op_sel_hi:[1,1,0]
    v_pk_fma_f32 v[10:11], v[198:199], v[30:31], v[240:241] op_sel:[0,1,0] op_sel_hi:[1,1,0]
    v_pk_fma_f32 v[100:101], v[100:101], v[30:31], v[8:9] op_sel:[0,0,0] op_sel_hi:[1,0,1]
    v_pk_fma_f32 v[102:103], v[102:103], v[30:31], v[10:11] op_sel:[0,0,0] op_sel_hi:[1,0,1]
    buffer_load_dwordx2 v[154:155], v45, s[88:91], s40 offen offset:1792 sc1
    v_pk_mul_f32 v[12:13], v[100:101], s[32:33]
    v_pk_mul_f32 v[14:15], v[102:103], s[32:33]
    v_exp_f32 v12, v12 clamp
    v_exp_f32 v13, v13 clamp
    v_exp_f32 v14, v14 clamp
    v_exp_f32 v15, v15 clamp
    v_max_f32 v100, v240, v100
    v_max_f32 v101, v240, v101
    v_max_f32 v102, v240, v102
    v_max_f32 v103, v240, v103
    v_pk_add_f32 v[100:101], v[100:101], v[12:13]
    v_pk_add_f32 v[102:103], v[102:103], v[14:15]
    s_add_u32 s40, s40, 3584
    buffer_load_dwordx2 v[156:157], v45, s[88:91], s40 offen offset:0 sc1
    v_pk_fma_f32 v[8:9], v[220:221], v[30:31], v[240:241] op_sel:[0,1,0] op_sel_hi:[1,1,0]
    v_pk_fma_f32 v[10:11], v[222:223], v[30:31], v[240:241] op_sel:[0,1,0] op_sel_hi:[1,1,0]
    v_pk_fma_f32 v[124:125], v[124:125], v[30:31], v[8:9] op_sel:[0,0,0] op_sel_hi:[1,0,1]
    v_pk_fma_f32 v[126:127], v[126:127], v[30:31], v[10:11] op_sel:[0,0,0] op_sel_hi:[1,0,1]
    buffer_load_dwordx2 v[158:159], v45, s[88:91], s40 offen offset:1792 sc1
    v_pk_mul_f32 v[12:13], v[124:125], s[32:33]
    v_pk_mul_f32 v[14:15], v[126:127], s[32:33]
    v_exp_f32 v12, v12 clamp
    v_exp_f32 v13, v13 clamp
    v_exp_f32 v14, v14 clamp
    v_exp_f32 v15, v15 clamp
    v_max_f32 v124, v240, v124
    v_max_f32 v125, v240, v125
    v_max_f32 v126, v240, v126
    v_max_f32 v127, v240, v127
    v_pk_add_f32 v[124:125], v[124:125], v[12:13]
    v_pk_add_f32 v[126:127], v[126:127], v[14:15]
    s_mul_i32 s54, s22, 7168
    s_add_u32 s54, s54, 73728
    s_add_u32 s55, s77, s54
    s_add_u32 s55, s55, 4194304
    s_lshl_b32 s52, s22, 13
    s_min_u32 s52, s52, 22528
    s_and_b32 s53, s24, 1
    s_lshl_b32 s53, s53, 16
    s_add_u32 s53, s53, s52
    s_add_u32 s53, s53, 7340032
    s_add_u32 s52, s52, 102400
    v_cvt_pk_bf16_f32 v224, v64, v65
    v_cvt_pk_bf16_f32 v225, v66, v67
    v_cvt_pk_bf16_f32 v226, v92, v93
    v_cvt_pk_bf16_f32 v227, v94, v95
    v_cvt_pk_bf16_f32 v228, v68, v69
    v_cvt_pk_bf16_f32 v229, v70, v71
    v_cvt_pk_bf16_f32 v230, v92, v93
    v_cvt_pk_bf16_f32 v231, v94, v95
    v_cvt_pk_bf16_f32 v232, v96, v97
    v_cvt_pk_bf16_f32 v233, v98, v99
    v_cvt_pk_bf16_f32 v234, v124, v125
    v_cvt_pk_bf16_f32 v235, v126, v127
    v_cvt_pk_bf16_f32 v236, v100, v101
    v_cvt_pk_bf16_f32 v237, v102, v103
    v_cvt_pk_bf16_f32 v238, v124, v125
    v_cvt_pk_bf16_f32 v239, v126, v127
    v_mov_b32 v192, 0
    v_mov_b32 v193, 0
    v_mov_b32 v194, 0
    v_mov_b32 v195, 0
    v_mov_b32 v196, 0
    v_mov_b32 v197, 0
    v_mov_b32 v198, 0
    v_mov_b32 v199, 0
    v_mov_b32 v200, 0
    v_mov_b32 v201, 0
    v_mov_b32 v202, 0
    v_mov_b32 v203, 0
    v_mov_b32 v204, 0
    v_mov_b32 v205, 0
    v_mov_b32 v206, 0
    v_mov_b32 v207, 0
    v_mov_b32 v208, 0
    v_mov_b32 v209, 0
    v_mov_b32 v210, 0
    v_mov_b32 v211, 0
    v_mov_b32 v212, 0
    v_mov_b32 v213, 0
    v_mov_b32 v214, 0
    v_mov_b32 v215, 0
    v_mov_b32 v16, 156160
    s_add_u32 s48, s70, 20480
    s_add_u32 s49, s71, 20480
    v_mov_b32 v17, 1680
    v_cmp_gt_u32 s[50:51], v17, v45
    v_mov_b32 v4, s20
    v_mov_b32 v5, s21
    v_accvgpr_read_b32 v7, a245
    s_waitcnt vmcnt(14)
    v_lshlrev_b32 v160, 16, v128
    v_and_b32 v161, 0xffff0000, v128
    v_lshlrev_b32 v162, 16, v129
    v_and_b32 v163, 0xffff0000, v129
    v_lshlrev_b32 v164, 16, v130
    v_and_b32 v165, 0xffff0000, v130
    v_lshlrev_b32 v166, 16, v131
    v_and_b32 v167, 0xffff0000, v131
    v_pk_add_f32 v[160:161], v[160:161], v[164:165]
    v_pk_add_f32 v[162:163], v[162:163], v[166:167]
    s_waitcnt vmcnt(12)
    v_lshlrev_b32 v164, 16, v132
    v_and_b32 v165, 0xffff0000, v132
    v_lshlrev_b32 v166, 16, v133
    v_and_b32 v167, 0xffff0000, v133
    v_pk_add_f32 v[160:161], v[160:161], v[164:165]
    v_pk_add_f32 v[162:163], v[162:163], v[166:167]
    v_lshlrev_b32 v164, 16, v134
    v_and_b32 v165, 0xffff0000, v134
    v_lshlrev_b32 v166, 16, v135
    v_and_b32 v167, 0xffff0000, v135
    v_pk_add_f32 v[160:161], v[160:161], v[164:165]
    v_pk_add_f32 v[162:163], v[162:163], v[166:167]
    s_waitcnt vmcnt(10)
    v_lshlrev_b32 v164, 16, v136
    v_and_b32 v165, 0xffff0000, v136
    v_lshlrev_b32 v166, 16, v137
    v_and_b32 v167, 0xffff0000, v137
    v_pk_add_f32 v[160:161], v[160:161], v[164:165]
    v_pk_add_f32 v[162:163], v[162:163], v[166:167]
    v_lshlrev_b32 v164, 16, v138
    v_and_b32 v165, 0xffff0000, v138
    v_lshlrev_b32 v166, 16, v139
    v_and_b32 v167, 0xffff0000, v139
    v_pk_add_f32 v[160:161], v[160:161], v[164:165]
    v_pk_add_f32 v[162:163], v[162:163], v[166:167]
    s_waitcnt vmcnt(8)
    v_lshlrev_b32 v164, 16, v140
    v_and_b32 v165, 0xffff0000, v140
    v_lshlrev_b32 v166, 16, v141
    v_and_b32 v167, 0xffff0000, v141
    v_pk_add_f32 v[160:161], v[160:161], v[164:165]
    v_pk_add_f32 v[162:163], v[162:163], v[166:167]
    v_lshlrev_b32 v164, 16, v142
    v_and_b32 v165, 0xffff0000, v142
    v_lshlrev_b32 v166, 16, v143
    v_and_b32 v167, 0xffff0000, v143
    v_pk_add_f32 v[160:161], v[160:161], v[164:165]
    v_pk_add_f32 v[162:163], v[162:163], v[166:167]
    s_waitcnt vmcnt(6)
    v_lshlrev_b32 v164, 16, v144
    v_and_b32 v165, 0xffff0000, v144
    v_lshlrev_b32 v166, 16, v145
    v_and_b32 v167, 0xffff0000, v145
    v_pk_add_f32 v[160:161], v[160:161], v[164:165]
    v_pk_add_f32 v[162:163], v[162:163], v[166:167]
    v_lshlrev_b32 v164, 16, v146
    v_and_b32 v165, 0xffff0000, v146
    v_lshlrev_b32 v166, 16, v147
    v_and_b32 v167, 0xffff0000, v147
    v_pk_add_f32 v[160:161], v[160:161], v[164:165]
    v_pk_add_f32 v[162:163], v[162:163], v[166:167]
    s_waitcnt vmcnt(4)
    v_lshlrev_b32 v164, 16, v148
    v_and_b32 v165, 0xffff0000, v148
    v_lshlrev_b32 v166, 16, v149
    v_and_b32 v167, 0xffff0000, v149
    v_pk_add_f32 v[160:161], v[160:161], v[164:165]
    v_pk_add_f32 v[162:163], v[162:163], v[166:167]
    v_lshlrev_b32 v164, 16, v150
    v_and_b32 v165, 0xffff0000, v150
    v_lshlrev_b32 v166, 16, v151
    v_and_b32 v167, 0xffff0000, v151
    v_pk_add_f32 v[160:161], v[160:161], v[164:165]
    v_pk_add_f32 v[162:163], v[162:163], v[166:167]
    s_waitcnt vmcnt(2)
    v_lshlrev_b32 v164, 16, v152
    v_and_b32 v165, 0xffff0000, v152
    v_lshlrev_b32 v166, 16, v153
    v_and_b32 v167, 0xffff0000, v153
    v_pk_add_f32 v[160:161], v[160:161], v[164:165]
    v_pk_add_f32 v[162:163], v[162:163], v[166:167]
    v_lshlrev_b32 v164, 16, v154
    v_and_b32 v165, 0xffff0000, v154
    v_lshlrev_b32 v166, 16, v155
    v_and_b32 v167, 0xffff0000, v155
    v_pk_add_f32 v[160:161], v[160:161], v[164:165]
    v_pk_add_f32 v[162:163], v[162:163], v[166:167]
    s_waitcnt vmcnt(0)
    v_lshlrev_b32 v164, 16, v156
    v_and_b32 v165, 0xffff0000, v156
    v_lshlrev_b32 v166, 16, v157
    v_and_b32 v167, 0xffff0000, v157
    v_pk_add_f32 v[160:161], v[160:161], v[164:165]
    v_pk_add_f32 v[162:163], v[162:163], v[166:167]
    v_lshlrev_b32 v164, 16, v158
    v_and_b32 v165, 0xffff0000, v158
    v_lshlrev_b32 v166, 16, v159
    v_and_b32 v167, 0xffff0000, v159
    v_pk_add_f32 v[160:161], v[160:161], v[164:165]
    v_pk_add_f32 v[162:163], v[162:163], v[166:167]
    v_cvt_pk_bf16_f32 v128, v160, v161
    v_cvt_pk_bf16_f32 v129, v162, v163
    s_mov_b64 exec, s[50:51]
    ds_write_b64 v46, v[128:129]
    s_mov_b64 exec, -1
    s_waitcnt lgkmcnt(0)
    s_barrier
    ds_read_b64 v[192:193], v48 offset:0
    ds_read_b64 v[196:197], v48 offset:840
    s_mov_b32 exec_lo, 0x11111111
    s_mov_b32 exec_hi, 0x11111111
    ds_read_b64 v[208:209], v47 offset:160
    s_mov_b32 exec_lo, 0x22222222
    s_mov_b32 exec_hi, 0x22222222
    ds_read_b64 v[212:213], v47 offset:1000
    s_mov_b32 exec_lo, 0xf000f
    s_mov_b32 exec_hi, 0xf000f
    ds_read_b64 v[200:201], v50 offset:128
    s_mov_b32 exec_lo, 0xf000f0
    s_mov_b32 exec_hi, 0xf000f0
    ds_read_b64 v[204:205], v50 offset:968
    s_mov_b32 exec_lo, 0x1111
    s_mov_b32 exec_hi, 0x0
    ds_read_b64 v[210:211], v16 offset:832
    s_mov_b32 exec_lo, 0x22220000
    ds_read_b64 v[214:215], v16 offset:1672
    s_mov_b32 exec_lo, 0xffff
    ds_read_b64 v[194:195], v49 offset:672
    s_mov_b32 exec_lo, 0xffff0000
    ds_read_b64 v[198:199], v49 offset:1512
    s_mov_b32 exec_lo, 0xf
    ds_read_b64 v[202:203], v51 offset:800
    s_mov_b32 exec_lo, 0xf00000
    ds_read_b64 v[206:207], v51 offset:1640
    s_mov_b64 exec, -1
    s_waitcnt lgkmcnt(0)
    v_mfma_f32_16x16x32_bf16 v[76:79], v[208:211], v[224:227], 0
    v_mfma_f32_16x16x32_bf16 v[76:79], v[212:215], v[228:231], v[76:79]
    v_mfma_f32_16x16x32_bf16 v[92:95], v[208:211], v[232:235], 0
    v_mfma_f32_16x16x32_bf16 v[92:95], v[212:215], v[236:239], v[92:95]
    v_mfma_f32_16x16x32_bf16 v[64:67], v[192:195], v[224:227], 0
    v_mfma_f32_16x16x32_bf16 v[68:71], v[196:199], v[228:231], 0
    v_mfma_f32_16x16x32_bf16 v[72:75], v[200:203], v[224:227], 0
    v_mfma_f32_16x16x32_bf16 v[72:75], v[204:207], v[228:231], v[72:75]
    v_mfma_f32_16x16x32_bf16 v[80:83], v[192:195], v[232:235], 0
    v_mfma_f32_16x16x32_bf16 v[84:87], v[196:199], v[236:239], 0
    v_mfma_f32_16x16x32_bf16 v[88:91], v[200:203], v[232:235], 0
    v_mfma_f32_16x16x32_bf16 v[88:91], v[204:207], v[236:239], v[88:91]
    v_pk_add_f32 v[76:77], v[76:77], v[240:241] op_sel:[0,0] op_sel_hi:[1,0]
    v_rcp_f32 v76, v76
    v_rcp_f32 v77, v77
    v_pk_add_f32 v[92:93], v[92:93], v[240:241] op_sel:[0,0] op_sel_hi:[1,0]
    v_rcp_f32 v92, v92
    v_rcp_f32 v93, v93
    v_cndmask_b32 v78, v77, v76, s[34:35]
    v_pk_mul_f32 v[64:65], v[64:65], v[76:77] op_sel:[0,0] op_sel_hi:[1,0]
    v_pk_mul_f32 v[66:67], v[66:67], v[76:77] op_sel:[0,0] op_sel_hi:[1,0]
    v_pk_mul_f32 v[68:69], v[68:69], v[76:77] op_sel:[0,1] op_sel_hi:[1,1]
    v_pk_mul_f32 v[70:71], v[70:71], v[76:77] op_sel:[0,1] op_sel_hi:[1,1]
    v_cvt_pk_bf16_f32 v100, v64, v65
    v_cvt_pk_bf16_f32 v101, v66, v67
    v_cvt_pk_bf16_f32 v102, v68, v69
    v_cvt_pk_bf16_f32 v103, v70, v71
    buffer_store_dwordx4 v[100:103], v1, s[88:91], s70 offen sc1
    v_pk_mul_f32 v[72:73], v[72:73], v[78:79] op_sel:[0,0] op_sel_hi:[1,0]
    v_pk_mul_f32 v[74:75], v[74:75], v[78:79] op_sel:[0,0] op_sel_hi:[1,0]
    v_cvt_pk_bf16_f32 v104, v72, v73
    v_cvt_pk_bf16_f32 v105, v74, v75
    v_cndmask_b32 v94, v93, v92, s[34:35]
    v_pk_mul_f32 v[80:81], v[80:81], v[92:93] op_sel:[0,0] op_sel_hi:[1,0]
    v_pk_mul_f32 v[82:83], v[82:83], v[92:93] op_sel:[0,0] op_sel_hi:[1,0]
    v_pk_mul_f32 v[84:85], v[84:85], v[92:93] op_sel:[0,1] op_sel_hi:[1,1]
    v_pk_mul_f32 v[86:87], v[86:87], v[92:93] op_sel:[0,1] op_sel_hi:[1,1]
    v_cvt_pk_bf16_f32 v108, v80, v81
    v_cvt_pk_bf16_f32 v109, v82, v83
    v_cvt_pk_bf16_f32 v110, v84, v85
    v_cvt_pk_bf16_f32 v111, v86, v87
    buffer_store_dwordx4 v[108:111], v1, s[88:91], s48 offen sc1
    v_pk_mul_f32 v[88:89], v[88:89], v[94:95] op_sel:[0,0] op_sel_hi:[1,0]
    v_pk_mul_f32 v[90:91], v[90:91], v[94:95] op_sel:[0,0] op_sel_hi:[1,0]
    v_cvt_pk_bf16_f32 v112, v88, v89
    v_cvt_pk_bf16_f32 v113, v90, v91
    v_mov_b32 v106, v104
    v_mov_b32 v107, v105
    s_nop 0
    v_permlane16_swap_b32 v104, v106
    v_permlane16_swap_b32 v105, v107
    v_mov_b32 v114, v112
    v_mov_b32 v115, v113
    s_nop 0
    v_permlane16_swap_b32 v112, v114
    v_permlane16_swap_b32 v113, v115
    s_mov_b64 exec, 0xffff
    buffer_store_dwordx4 v[104:107], v52, s[88:91], s71 offen sc1
    buffer_store_dwordx4 v[112:115], v52, s[88:91], s49 offen sc1
    s_mov_b64 exec, -1
    s_mov_b32 m0, s54
    s_nop 0
    buffer_load_dwordx4 v1, s[4:7], s55 offen offset:0 sc1 lds
    buffer_load_dwordx4 v1, s[4:7], s55 offen offset:1024 sc1 lds
    buffer_load_dwordx4 v1, s[4:7], s55 offen offset:2048 sc1 lds
    buffer_load_dwordx4 v1, s[4:7], s55 offen offset:3072 sc1 lds
    s_add_u32 s54, s54, 4096
    s_add_u32 s55, s55, 4096
    s_mov_b32 m0, s54
    s_nop 0
    buffer_load_dwordx4 v1, s[4:7], s55 offen offset:0 sc1 lds
    buffer_load_dwordx4 v1, s[4:7], s55 offen offset:1024 sc1 lds
    buffer_load_dwordx4 v1, s[4:7], s55 offen offset:2048 sc1 lds
    s_mov_b32 m0, s52
    s_nop 0
    buffer_load_dwordx4 v1, s[4:7], s53 offen offset:0 sc1 lds
    buffer_load_dwordx4 v1, s[4:7], s53 offen offset:1024 sc1 lds
    buffer_load_dwordx4 v1, s[4:7], s53 offen offset:2048 sc1 lds
    buffer_load_dwordx4 v1, s[4:7], s53 offen offset:3072 sc1 lds
    s_add_u32 s52, s52, 4096
    s_add_u32 s53, s53, 4096
    s_mov_b32 m0, s52
    s_nop 0
    buffer_load_dwordx4 v1, s[4:7], s53 offen offset:0 sc1 lds
    buffer_load_dwordx4 v1, s[4:7], s53 offen offset:1024 sc1 lds
    buffer_load_dwordx4 v1, s[4:7], s53 offen offset:2048 sc1 lds
    buffer_load_dwordx4 v1, s[4:7], s53 offen offset:3072 sc1 lds
    s_add_u32 s44, s67, 12648448
    s_add_u32 s40, s66, 1048576
    s_cmp_eq_u32 s27, 0
    s_cbranch_scc1 L_p2_r0
    v_accvgpr_read_b32 v64, a224
    v_accvgpr_read_b32 v65, a225
    v_accvgpr_read_b32 v66, a226
    v_accvgpr_read_b32 v67, a227
    v_accvgpr_read_b32 v68, a228
    v_accvgpr_read_b32 v69, a229
    v_accvgpr_read_b32 v70, a230
    v_accvgpr_read_b32 v71, a231
    v_accvgpr_read_b32 v72, a232
    v_accvgpr_read_b32 v73, a233
    v_accvgpr_read_b32 v74, a234
    v_accvgpr_read_b32 v75, a235
    v_accvgpr_read_b32 v76, a236
    v_accvgpr_read_b32 v77, a237
    v_accvgpr_read_b32 v78, a238
    v_accvgpr_read_b32 v79, a239
    v_accvgpr_read_b32 v80, a240
    v_accvgpr_read_b32 v81, a241
    v_accvgpr_read_b32 v82, a242
    v_accvgpr_read_b32 v83, a243
    s_branch L_p2_r1
L_p2_r0:
    v_accvgpr_read_b32 v65, a224
    v_lshlrev_b32 v64, 16, v65
    v_and_b32 v65, 0xffff0000, v65
    v_accvgpr_read_b32 v67, a225
    v_lshlrev_b32 v66, 16, v67
    v_and_b32 v67, 0xffff0000, v67
    v_accvgpr_read_b32 v69, a226
    v_lshlrev_b32 v68, 16, v69
    v_and_b32 v69, 0xffff0000, v69
    v_accvgpr_read_b32 v71, a227
    v_lshlrev_b32 v70, 16, v71
    v_and_b32 v71, 0xffff0000, v71
    v_accvgpr_read_b32 v73, a228
    v_lshlrev_b32 v72, 16, v73
    v_and_b32 v73, 0xffff0000, v73
    v_accvgpr_read_b32 v75, a229
    v_lshlrev_b32 v74, 16, v75
    v_and_b32 v75, 0xffff0000, v75
    v_accvgpr_read_b32 v77, a230
    v_lshlrev_b32 v76, 16, v77
    v_and_b32 v77, 0xffff0000, v77
    v_accvgpr_read_b32 v79, a231
    v_lshlrev_b32 v78, 16, v79
    v_and_b32 v79, 0xffff0000, v79
    v_accvgpr_read_b32 v81, a232
    v_lshlrev_b32 v80, 16, v81
    v_and_b32 v81, 0xffff0000, v81
    v_accvgpr_read_b32 v83, a233
    v_lshlrev_b32 v82, 16, v83
    v_and_b32 v83, 0xffff0000, v83
L_p2_r1:
    s_cmp_eq_u32 s22, 3
    s_waitcnt vmcnt(15)
    s_barrier
    s_cbranch_scc1 L_h_24
    s_branch L_h_25
L_h_24:
    s_mov_b64 exec, 0xffff
    buffer_store_dwordx2 v[4:5], v7, s[88:91], s72 offen sc1
    s_mov_b64 exec, -1
L_h_25:
    s_cmp_eq_u32 s22, 3
    s_cbranch_scc0 L_h_26
    s_mov_b64 exec, 0xffff
    s_mov_b32 s36, 0
L_poll_27:
    buffer_load_dwordx2 v[4:5], v32, s[88:91], s44 offen sc1
    s_add_u32 s36, s36, 1
    s_cmp_gt_u32 s36, 2097152
    s_cbranch_scc1 L_abort
    s_waitcnt vmcnt(0)
    v_cmp_ne_u64 vcc, s[20:21], v[4:5]
    s_cbranch_vccnz L_poll_27
    s_mov_b64 exec, -1
L_h_26:
    s_barrier
    buffer_load_dwordx4 a[0:3], v1, s[88:91], s40 offen offset:0 sc1
    buffer_load_dwordx4 a[4:7], v1, s[88:91], s40 offen offset:1024 sc1
    buffer_load_dwordx4 a[8:11], v1, s[88:91], s40 offen offset:2048 sc1
    buffer_load_dwordx4 a[12:15], v1, s[88:91], s40 offen offset:3072 sc1
    s_add_u32 s40, s40, 4096
    buffer_load_dwordx4 a[16:19], v1, s[88:91], s40 offen offset:0 sc1
    buffer_load_dwordx4 a[20:23], v1, s[88:91], s40 offen offset:1024 sc1
    buffer_load_dwordx4 a[24:27], v1, s[88:91], s40 offen offset:2048 sc1
    buffer_load_dwordx4 a[28:31], v1, s[88:91], s40 offen offset:3072 sc1
    s_add_u32 s40, s40, 4096
    buffer_load_dwordx4 a[32:35], v1, s[88:91], s40 offen offset:0 sc1
    buffer_load_dwordx4 a[36:39], v1, s[88:91], s40 offen offset:1024 sc1
    s_add_u32 s45, s64, 3670016
    s_add_u32 s46, s65, 3670016
    s_add_u32 s48, s76, 12320768
    v_mov_b32 v4, s20
    v_mov_b32 v5, s21
    v_accvgpr_read_b32 v7, a246
    s_add_u32 s52, s67, 12713984
    s_lshl_b32 s53, s24, 3
    s_add_u32 s53, s53, 12713984
    s_mul_i32 s54, s22, 13312
    s_min_u32 s54, s54, 37888
    s_add_u32 s55, s77, s54
    s_add_u32 s55, s55, 5242880
    ds_read_b128 v[128:131], v1 offset:0
    ds_read_b128 v[132:135], v1 offset:1024
    ds_read_b128 v[136:139], v1 offset:2048
    ds_read_b128 v[140:143], v1 offset:3072
    ds_read_b128 v[144:147], v1 offset:4096
    ds_read_b128 v[148:151], v1 offset:5120
    ds_read_b128 v[152:155], v1 offset:6144
    ds_read_b128 v[156:159], v1 offset:7168
    ds_read_b128 v[160:163], v1 offset:8192
    ds_read_b128 v[164:167], v1 offset:9216
    s_waitcnt vmcnt(9) lgkmcnt(5)
    v_mfma_f32_16x16x32_bf16 v[64:67], v[128:131], a[0:3], v[64:67]
    ds_read_b128 v[168:171], v1 offset:10240
    v_mfma_f32_16x16x32_bf16 v[68:71], v[132:135], a[0:3], v[68:71]
    ds_read_b128 v[172:175], v1 offset:11264
    buffer_load_dwordx4 a[40:43], v1, s[88:91], s40 offen offset:2048 sc1
    v_mfma_f32_16x16x32_bf16 v[72:75], v[136:139], a[0:3], v[72:75]
    ds_read_b128 v[176:179], v1 offset:12288
    v_mfma_f32_16x16x32_bf16 v[76:79], v[140:143], a[0:3], v[76:79]
    ds_read_b128 v[180:183], v1 offset:13312
    v_mfma_f32_16x16x32_bf16 v[80:83], v[144:147], a[0:3], v[80:83]
    ds_read_b128 v[184:187], v1 offset:14336
    s_waitcnt vmcnt(9) lgkmcnt(5)
    v_mfma_f32_16x16x32_bf16 v[64:67], v[148:151], a[4:7], v[64:67]
    ds_read_b128 v[128:131], v1 offset:15360
    v_mfma_f32_16x16x32_bf16 v[68:71], v[152:155], a[4:7], v[68:71]
    ds_read_b128 v[132:135], v1 offset:16384
    buffer_load_dwordx4 a[44:47], v1, s[88:91], s40 offen offset:3072 sc1
    v_mfma_f32_16x16x32_bf16 v[72:75], v[156:159], a[4:7], v[72:75]
    ds_read_b128 v[136:139], v1 offset:17408
    v_mfma_f32_16x16x32_bf16 v[76:79], v[160:163], a[4:7], v[76:79]
    ds_read_b128 v[140:143], v1 offset:18432
    v_mfma_f32_16x16x32_bf16 v[80:83], v[164:167], a[4:7], v[80:83]
    ds_read_b128 v[144:147], v1 offset:19456
    s_waitcnt vmcnt(9) lgkmcnt(5)
    v_mfma_f32_16x16x32_bf16 v[64:67], v[168:171], a[8:11], v[64:67]
    ds_read_b128 v[148:151], v1 offset:20480
    v_mfma_f32_16x16x32_bf16 v[68:71], v[172:175], a[8:11], v[68:71]
    ds_read_b128 v[152:155], v1 offset:21504
    s_add_u32 s40, s40, 4096
    buffer_load_dwordx4 a[48:51], v1, s[88:91], s40 offen offset:0 sc1
    v_mfma_f32_16x16x32_bf16 v[72:75], v[176:179], a[8:11], v[72:75]
    ds_read_b128 v[156:159], v1 offset:22528
    v_mfma_f32_16x16x32_bf16 v[76:79], v[180:183], a[8:11], v[76:79]
    ds_read_b128 v[160:163], v1 offset:23552
    v_mfma_f32_16x16x32_bf16 v[80:83], v[184:187], a[8:11], v[80:83]
    ds_read_b128 v[164:167], v1 offset:24576
    s_waitcnt vmcnt(9) lgkmcnt(5)
    v_mfma_f32_16x16x32_bf16 v[64:67], v[128:131], a[12:15], v[64:67]
    ds_read_b128 v[168:171], v1 offset:25600
    v_mfma_f32_16x16x32_bf16 v[68:71], v[132:135], a[12:15], v[68:71]
    ds_read_b128 v[172:175], v1 offset:26624
    buffer_load_dwordx4 a[52:55], v1, s[88:91], s40 offen offset:1024 sc1
    v_mfma_f32_16x16x32_bf16 v[72:75], v[136:139], a[12:15], v[72:75]
    ds_read_b128 v[176:179], v1 offset:27648
    v_mfma_f32_16x16x32_bf16 v[76:79], v[140:143], a[12:15], v[76:79]
    ds_read_b128 v[180:183], v1 offset:28672
    v_mfma_f32_16x16x32_bf16 v[80:83], v[144:147], a[12:15], v[80:83]
    ds_read_b128 v[184:187], v1 offset:29696
    s_waitcnt vmcnt(9) lgkmcnt(5)
    v_mfma_f32_16x16x32_bf16 v[64:67], v[148:151], a[16:19], v[64:67]
    ds_read_b128 v[128:131], v1 offset:30720
    v_mfma_f32_16x16x32_bf16 v[68:71], v[152:155], a[16:19], v[68:71]
    ds_read_b128 v[132:135], v1 offset:31744
    buffer_load_dwordx4 a[56:59], v1, s[88:91], s40 offen offset:2048 sc1
    v_mfma_f32_16x16x32_bf16 v[72:75], v[156:159], a[16:19], v[72:75]
    ds_read_b128 v[136:139], v1 offset:32768
    v_mfma_f32_16x16x32_bf16 v[76:79], v[160:163], a[16:19], v[76:79]
    ds_read_b128 v[140:143], v1 offset:33792
    v_mfma_f32_16x16x32_bf16 v[80:83], v[164:167], a[16:19], v[80:83]
    ds_read_b128 v[144:147], v1 offset:34816
    s_waitcnt vmcnt(9) lgkmcnt(5)
    v_mfma_f32_16x16x32_bf16 v[64:67], v[168:171], a[20:23], v[64:67]
    ds_read_b128 v[148:151], v1 offset:35840
    v_mfma_f32_16x16x32_bf16 v[68:71], v[172:175], a[20:23], v[68:71]
    ds_read_b128 v[152:155], v1 offset:36864
    buffer_load_dwordx4 a[60:63], v1, s[88:91], s40 offen offset:3072 sc1
    v_mfma_f32_16x16x32_bf16 v[72:75], v[176:179], a[20:23], v[72:75]
    ds_read_b128 v[156:159], v1 offset:37888
    v_mfma_f32_16x16x32_bf16 v[76:79], v[180:183], a[20:23], v[76:79]
    ds_read_b128 v[160:163], v1 offset:38912
    v_mfma_f32_16x16x32_bf16 v[80:83], v[184:187], a[20:23], v[80:83]
    ds_read_b128 v[164:167], v1 offset:39936
    s_waitcnt vmcnt(9) lgkmcnt(5)
    v_mfma_f32_16x16x32_bf16 v[64:67], v[128:131], a[24:27], v[64:67]
    ds_read_b128 v[168:171], v1 offset:40960
    v_mfma_f32_16x16x32_bf16 v[68:71], v[132:135], a[24:27], v[68:71]
    ds_read_b128 v[172:175], v1 offset:41984
    s_add_u32 s40, s40, 4096
    buffer_load_dwordx4 a[64:67], v1, s[88:91], s40 offen offset:0 sc1
    v_mfma_f32_16x16x32_bf16 v[72:75], v[136:139], a[24:27], v[72:75]
    ds_read_b128 v[176:179], v1 offset:43008
    v_mfma_f32_16x16x32_bf16 v[76:79], v[140:143], a[24:27], v[76:79]
    ds_read_b128 v[180:183], v1 offset:44032
    v_mfma_f32_16x16x32_bf16 v[80:83], v[144:147], a[24:27], v[80:83]
    ds_read_b128 v[184:187], v1 offset:45056
    s_waitcnt vmcnt(9) lgkmcnt(5)
    v_mfma_f32_16x16x32_bf16 v[64:67], v[148:151], a[28:31], v[64:67]
    ds_read_b128 v[128:131], v1 offset:46080
    v_mfma_f32_16x16x32_bf16 v[68:71], v[152:155], a[28:31], v[68:71]
    ds_read_b128 v[132:135], v1 offset:47104
    buffer_load_dwordx4 a[68:71], v1, s[88:91], s40 offen offset:1024 sc1
    v_mfma_f32_16x16x32_bf16 v[72:75], v[156:159], a[28:31], v[72:75]
    ds_read_b128 v[136:139], v1 offset:48128
    v_mfma_f32_16x16x32_bf16 v[76:79], v[160:163], a[28:31], v[76:79]
    ds_read_b128 v[140:143], v1 offset:49152
    v_mfma_f32_16x16x32_bf16 v[80:83], v[164:167], a[28:31], v[80:83]
    ds_read_b128 v[144:147], v1 offset:50176
    s_waitcnt vmcnt(9) lgkmcnt(5)
    v_mfma_f32_16x16x32_bf16 v[64:67], v[168:171], a[32:35], v[64:67]
    ds_read_b128 v[148:151], v38 offset:0
    v_mfma_f32_16x16x32_bf16 v[68:71], v[172:175], a[32:35], v[68:71]
    ds_read_b128 v[152:155], v38 offset:1024
    buffer_load_dwordx4 a[72:75], v1, s[88:91], s40 offen offset:2048 sc1
    v_mfma_f32_16x16x32_bf16 v[72:75], v[176:179], a[32:35], v[72:75]
    ds_read_b128 v[156:159], v38 offset:2048
    v_mfma_f32_16x16x32_bf16 v[76:79], v[180:183], a[32:35], v[76:79]
    ds_read_b128 v[160:163], v38 offset:3072
    v_mfma_f32_16x16x32_bf16 v[80:83], v[184:187], a[32:35], v[80:83]
    ds_read_b128 v[164:167], v38 offset:4096
    s_waitcnt vmcnt(9) lgkmcnt(5)
    v_mfma_f32_16x16x32_bf16 v[64:67], v[128:131], a[36:39], v[64:67]
    ds_read_b128 v[168:171], v38 offset:5120
    v_mfma_f32_16x16x32_bf16 v[68:71], v[132:135], a[36:39], v[68:71]
    ds_read_b128 v[172:175], v38 offset:6144
    buffer_load_dwordx4 a[76:79], v1, s[88:91], s40 offen offset:3072 sc1
    v_mfma_f32_16x16x32_bf16 v[72:75], v[136:139], a[36:39], v[72:75]
    ds_read_b128 v[176:179], v38 offset:7168
    v_mfma_f32_16x16x32_bf16 v[76:79], v[140:143], a[36:39], v[76:79]
    ds_read_b128 v[180:183], v38 offset:8192
    v_mfma_f32_16x16x32_bf16 v[80:83], v[144:147], a[36:39], v[80:83]
    ds_read_b128 v[184:187], v38 offset:9216
    s_waitcnt vmcnt(9) lgkmcnt(5)
    v_mfma_f32_16x16x32_bf16 v[64:67], v[148:151], a[40:43], v[64:67]
    ds_read_b128 v[128:131], v38 offset:10240
    v_mfma_f32_16x16x32_bf16 v[68:71], v[152:155], a[40:43], v[68:71]
    ds_read_b128 v[132:135], v38 offset:11264
    v_mfma_f32_16x16x32_bf16 v[72:75], v[156:159], a[40:43], v[72:75]
    ds_read_b128 v[136:139], v38 offset:12288
    v_mfma_f32_16x16x32_bf16 v[76:79], v[160:163], a[40:43], v[76:79]
    ds_read_b128 v[140:143], v38 offset:13312
    v_mfma_f32_16x16x32_bf16 v[80:83], v[164:167], a[40:43], v[80:83]
    ds_read_b128 v[144:147], v38 offset:14336
    s_barrier
    s_mov_b32 m0, s54
    s_nop 0
    buffer_load_dwordx4 v1, s[4:7], s55 offen offset:0 sc1 lds
    buffer_load_dwordx4 v1, s[4:7], s55 offen offset:1024 sc1 lds
    s_waitcnt vmcnt(10) lgkmcnt(5)
    v_mfma_f32_16x16x32_bf16 v[64:67], v[168:171], a[44:47], v[64:67]
    ds_read_b128 v[148:151], v38 offset:15360
    v_mfma_f32_16x16x32_bf16 v[68:71], v[172:175], a[44:47], v[68:71]
    ds_read_b128 v[152:155], v38 offset:16384
    v_mfma_f32_16x16x32_bf16 v[72:75], v[176:179], a[44:47], v[72:75]
    ds_read_b128 v[156:159], v38 offset:17408
    v_mfma_f32_16x16x32_bf16 v[76:79], v[180:183], a[44:47], v[76:79]
    ds_read_b128 v[160:163], v38 offset:18432
    v_mfma_f32_16x16x32_bf16 v[80:83], v[184:187], a[44:47], v[80:83]
    ds_read_b128 v[164:167], v38 offset:19456
    buffer_load_dwordx4 v1, s[4:7], s55 offen offset:2048 sc1 lds
    s_waitcnt vmcnt(10) lgkmcnt(5)
    v_mfma_f32_16x16x32_bf16 v[64:67], v[128:131], a[48:51], v[64:67]
    ds_read_b128 v[168:171], v38 offset:20480
    v_mfma_f32_16x16x32_bf16 v[68:71], v[132:135], a[48:51], v[68:71]
    ds_read_b128 v[172:175], v38 offset:21504
    v_mfma_f32_16x16x32_bf16 v[72:75], v[136:139], a[48:51], v[72:75]
    ds_read_b128 v[176:179], v38 offset:22528
    v_mfma_f32_16x16x32_bf16 v[76:79], v[140:143], a[48:51], v[76:79]
    ds_read_b128 v[180:183], v38 offset:23552
    v_mfma_f32_16x16x32_bf16 v[80:83], v[144:147], a[48:51], v[80:83]
    ds_read_b128 v[184:187], v38 offset:24576
    buffer_load_dwordx4 v1, s[4:7], s55 offen offset:3072 sc1 lds
    s_waitcnt vmcnt(10) lgkmcnt(5)
    v_mfma_f32_16x16x32_bf16 v[64:67], v[148:151], a[52:55], v[64:67]
    ds_read_b128 v[128:131], v38 offset:25600
    v_mfma_f32_16x16x32_bf16 v[68:71], v[152:155], a[52:55], v[68:71]
    ds_read_b128 v[132:135], v38 offset:26624
    v_mfma_f32_16x16x32_bf16 v[72:75], v[156:159], a[52:55], v[72:75]
    ds_read_b128 v[136:139], v38 offset:27648
    v_mfma_f32_16x16x32_bf16 v[76:79], v[160:163], a[52:55], v[76:79]
    ds_read_b128 v[140:143], v38 offset:28672
    v_mfma_f32_16x16x32_bf16 v[80:83], v[164:167], a[52:55], v[80:83]
    ds_read_b128 v[144:147], v38 offset:29696
    s_add_u32 s54, s54, 4096
    s_add_u32 s55, s55, 4096
    s_mov_b32 m0, s54
    s_nop 0
    buffer_load_dwordx4 v1, s[4:7], s55 offen offset:0 sc1 lds
    buffer_load_dwordx4 v1, s[4:7], s55 offen offset:1024 sc1 lds
    s_waitcnt vmcnt(11) lgkmcnt(5)
    v_mfma_f32_16x16x32_bf16 v[64:67], v[168:171], a[56:59], v[64:67]
    ds_read_b128 v[148:151], v38 offset:30720
    v_mfma_f32_16x16x32_bf16 v[68:71], v[172:175], a[56:59], v[68:71]
    ds_read_b128 v[152:155], v38 offset:31744
    v_mfma_f32_16x16x32_bf16 v[72:75], v[176:179], a[56:59], v[72:75]
    ds_read_b128 v[156:159], v38 offset:32768
    v_mfma_f32_16x16x32_bf16 v[76:79], v[180:183], a[56:59], v[76:79]
    ds_read_b128 v[160:163], v38 offset:33792
    v_mfma_f32_16x16x32_bf16 v[80:83], v[184:187], a[56:59], v[80:83]
    ds_read_b128 v[164:167], v38 offset:34816
    buffer_load_dwordx4 v1, s[4:7], s55 offen offset:2048 sc1 lds
    s_waitcnt vmcnt(11) lgkmcnt(5)
    v_mfma_f32_16x16x32_bf16 v[64:67], v[128:131], a[60:63], v[64:67]
    ds_read_b128 v[168:171], v38 offset:35840
    v_mfma_f32_16x16x32_bf16 v[68:71], v[132:135], a[60:63], v[68:71]
    ds_read_b128 v[172:175], v38 offset:36864
    v_mfma_f32_16x16x32_bf16 v[72:75], v[136:139], a[60:63], v[72:75]
    ds_read_b128 v[176:179], v38 offset:37888
    v_mfma_f32_16x16x32_bf16 v[76:79], v[140:143], a[60:63], v[76:79]
    ds_read_b128 v[180:183], v38 offset:38912
    v_mfma_f32_16x16x32_bf16 v[80:83], v[144:147], a[60:63], v[80:83]
    ds_read_b128 v[184:187], v38 offset:39936
    buffer_load_dwordx4 v1, s[4:7], s55 offen offset:3072 sc1 lds
    s_waitcnt vmcnt(11) lgkmcnt(5)
    v_mfma_f32_16x16x32_bf16 v[64:67], v[148:151], a[64:67], v[64:67]
    ds_read_b128 v[128:131], v38 offset:40960
    v_mfma_f32_16x16x32_bf16 v[68:71], v[152:155], a[64:67], v[68:71]
    ds_read_b128 v[132:135], v38 offset:41984
    v_mfma_f32_16x16x32_bf16 v[72:75], v[156:159], a[64:67], v[72:75]
    ds_read_b128 v[136:139], v38 offset:43008
    v_mfma_f32_16x16x32_bf16 v[76:79], v[160:163], a[64:67], v[76:79]
    ds_read_b128 v[140:143], v38 offset:44032
    v_mfma_f32_16x16x32_bf16 v[80:83], v[164:167], a[64:67], v[80:83]
    ds_read_b128 v[144:147], v38 offset:45056
    s_add_u32 s54, s54, 4096
    s_add_u32 s55, s55, 4096
    s_mov_b32 m0, s54
    s_nop 0
    buffer_load_dwordx4 v1, s[4:7], s55 offen offset:0 sc1 lds
    buffer_load_dwordx4 v1, s[4:7], s55 offen offset:1024 sc1 lds
    s_waitcnt vmcnt(12) lgkmcnt(5)
    v_mfma_f32_16x16x32_bf16 v[64:67], v[168:171], a[68:71], v[64:67]
    ds_read_b128 v[148:151], v38 offset:46080
    v_mfma_f32_16x16x32_bf16 v[68:71], v[172:175], a[68:71], v[68:71]
    ds_read_b128 v[152:155], v38 offset:47104
    v_mfma_f32_16x16x32_bf16 v[72:75], v[176:179], a[68:71], v[72:75]
    ds_read_b128 v[156:159], v38 offset:48128
    v_mfma_f32_16x16x32_bf16 v[76:79], v[180:183], a[68:71], v[76:79]
    ds_read_b128 v[160:163], v38 offset:49152
    v_mfma_f32_16x16x32_bf16 v[80:83], v[184:187], a[68:71], v[80:83]
    ds_read_b128 v[164:167], v38 offset:50176
    buffer_load_dwordx4 v1, s[4:7], s55 offen offset:2048 sc1 lds
    s_waitcnt vmcnt(12) lgkmcnt(5)
    v_mfma_f32_16x16x32_bf16 v[64:67], v[128:131], a[72:75], v[64:67]
    v_mfma_f32_16x16x32_bf16 v[68:71], v[132:135], a[72:75], v[68:71]
    v_mfma_f32_16x16x32_bf16 v[72:75], v[136:139], a[72:75], v[72:75]
    v_mfma_f32_16x16x32_bf16 v[76:79], v[140:143], a[72:75], v[76:79]
    v_mfma_f32_16x16x32_bf16 v[80:83], v[144:147], a[72:75], v[80:83]
    buffer_load_dwordx4 v1, s[4:7], s55 offen offset:3072 sc1 lds
    s_waitcnt vmcnt(12) lgkmcnt(0)
    v_mfma_f32_16x16x32_bf16 v[64:67], v[148:151], a[76:79], v[64:67]
    v_mfma_f32_16x16x32_bf16 v[68:71], v[152:155], a[76:79], v[68:71]
    v_mfma_f32_16x16x32_bf16 v[72:75], v[156:159], a[76:79], v[72:75]
    v_mfma_f32_16x16x32_bf16 v[76:79], v[160:163], a[76:79], v[76:79]
    v_mfma_f32_16x16x32_bf16 v[80:83], v[164:167], a[76:79], v[80:83]
    s_add_u32 s54, s54, 4096
    s_add_u32 s55, s55, 4096
    s_mov_b32 m0, s54
    s_nop 0
    buffer_load_dwordx4 v1, s[4:7], s55 offen offset:0 sc1 lds
    v_cvt_pk_bf16_f32 v100, v64, v65
    v_cvt_pk_bf16_f32 v101, v66, v67
    v_cvt_pk_bf16_f32 v102, v68, v69
    v_cvt_pk_bf16_f32 v103, v70, v71
    buffer_store_dwordx4 v[100:103], v1, s[88:91], s45 offen sc1
    v_cvt_pk_bf16_f32 v104, v72, v73
    v_cvt_pk_bf16_f32 v105, v74, v75
    v_cvt_pk_bf16_f32 v106, v76, v77
    v_cvt_pk_bf16_f32 v107, v78, v79
    buffer_store_dwordx4 v[104:107], v1, s[88:91], s45 offen offset:1024 sc1
    v_cvt_pk_bf16_f32 v108, v80, v81
    v_cvt_pk_bf16_f32 v109, v82, v83
    v_mov_b32 v112, v108
    v_mov_b32 v113, v109
    v_mov_b32 v114, v112
    v_mov_b32 v115, v113
    s_nop 0
    v_permlane16_swap_b32 v112, v114
    v_permlane16_swap_b32 v113, v115
    s_mov_b32 exec_lo, 0xffff
    s_mov_b32 exec_hi, 0xffff
    buffer_store_dwordx4 v[112:115], v53, s[88:91], s46 offen sc1
    s_mov_b64 exec, -1
    v_pk_add_f32 v[8:9], v[64:65], v[66:67]
    v_pk_mul_f32 v[10:11], v[64:65], v[64:65]
    v_pk_fma_f32 v[10:11], v[66:67], v[66:67], v[10:11]
    v_pk_add_f32 v[8:9], v[8:9], v[68:69]
    v_pk_fma_f32 v[10:11], v[68:69], v[68:69], v[10:11]
    v_pk_add_f32 v[8:9], v[8:9], v[70:71]
    v_pk_fma_f32 v[10:11], v[70:71], v[70:71], v[10:11]
    v_pk_add_f32 v[8:9], v[8:9], v[72:73]
    v_pk_fma_f32 v[10:11], v[72:73], v[72:73], v[10:11]
    v_pk_add_f32 v[8:9], v[8:9], v[74:75]
    v_pk_fma_f32 v[10:11], v[74:75], v[74:75], v[10:11]
    v_pk_add_f32 v[8:9], v[8:9], v[76:77]
    v_pk_fma_f32 v[10:11], v[76:77], v[76:77], v[10:11]
    v_pk_add_f32 v[8:9], v[8:9], v[78:79]
    v_pk_fma_f32 v[10:11], v[78:79], v[78:79], v[10:11]
    v_pk_add_f32 v[8:9], v[8:9], v[80:81]
    v_pk_fma_f32 v[10:11], v[80:81], v[80:81], v[10:11]
    v_pk_add_f32 v[8:9], v[8:9], v[82:83]
    v_pk_fma_f32 v[10:11], v[82:83], v[82:83], v[10:11]
    v_add_f32 v8, v8, v9
    v_add_f32 v9, v10, v11
    v_mov_b32 v10, v8
    v_mov_b32 v11, v9
    s_nop 0
    v_permlane32_swap_b32 v8, v10
    v_permlane32_swap_b32 v9, v11
    v_pk_add_f32 v[8:9], v[8:9], v[10:11]
    v_mov_b32 v10, v8
    v_mov_b32 v11, v9
    s_nop 0
    v_permlane16_swap_b32 v8, v10
    v_permlane16_swap_b32 v9, v11
    v_pk_add_f32 v[12:13], v[8:9], v[10:11]
    s_mov_b64 exec, 0xffff
    buffer_store_dwordx4 v[12:15], v52, s[88:91], s48 offen sc1
    s_mov_b64 exec, -1
    v_lshlrev_b32 v8, 16, v100
    v_and_b32 v9, 0xffff0000, v100
    v_accvgpr_write_b32 a224, v8
    v_accvgpr_write_b32 a225, v9
    v_lshlrev_b32 v8, 16, v101
    v_and_b32 v9, 0xffff0000, v101
    v_accvgpr_write_b32 a226, v8
    v_accvgpr_write_b32 a227, v9
    v_lshlrev_b32 v8, 16, v102
    v_and_b32 v9, 0xffff0000, v102
    v_accvgpr_write_b32 a228, v8
    v_accvgpr_write_b32 a229, v9
    v_lshlrev_b32 v8, 16, v103
    v_and_b32 v9, 0xffff0000, v103
    v_accvgpr_write_b32 a230, v8
    v_accvgpr_write_b32 a231, v9
    v_lshlrev_b32 v8, 16, v104
    v_and_b32 v9, 0xffff0000, v104
    v_accvgpr_write_b32 a232, v8
    v_accvgpr_write_b32 a233, v9
    v_lshlrev_b32 v8, 16, v105
    v_and_b32 v9, 0xffff0000, v105
    v_accvgpr_write_b32 a234, v8
    v_accvgpr_write_b32 a235, v9
    v_lshlrev_b32 v8, 16, v106
    v_and_b32 v9, 0xffff0000, v106
    v_accvgpr_write_b32 a236, v8
    v_accvgpr_write_b32 a237, v9
    v_lshlrev_b32 v8, 16, v107
    v_and_b32 v9, 0xffff0000, v107
    v_accvgpr_write_b32 a238, v8
    v_accvgpr_write_b32 a239, v9
    v_lshlrev_b32 v8, 16, v108
    v_and_b32 v9, 0xffff0000, v108
    v_accvgpr_write_b32 a240, v8
    v_accvgpr_write_b32 a241, v9
    v_lshlrev_b32 v8, 16, v109
    v_and_b32 v9, 0xffff0000, v109
    v_accvgpr_write_b32 a242, v8
    v_accvgpr_write_b32 a243, v9
    s_cmp_eq_u32 s22, 3
    s_waitcnt vmcnt(0)
    s_barrier
    s_cbranch_scc1 L_h_28
    s_mul_i32 s54, s22, 17408
    s_min_u32 s54, s54, 33792
    s_add_u32 s55, s77, 5294080
    s_add_u32 s55, s55, s54
    s_add_u32 s54, s54, 51200
    s_mov_b32 m0, s54
    s_nop 0
    buffer_load_dwordx4 v1, s[4:7], s55 offen offset:0 sc1 lds
    buffer_load_dwordx4 v1, s[4:7], s55 offen offset:1024 sc1 lds
    buffer_load_dwordx4 v1, s[4:7], s55 offen offset:2048 sc1 lds
    buffer_load_dwordx4 v1, s[4:7], s55 offen offset:3072 sc1 lds
    s_add_u32 s54, s54, 4096
    s_add_u32 s55, s55, 4096
    s_mov_b32 m0, s54
    s_nop 0
    buffer_load_dwordx4 v1, s[4:7], s55 offen offset:0 sc1 lds
    buffer_load_dwordx4 v1, s[4:7], s55 offen offset:1024 sc1 lds
    buffer_load_dwordx4 v1, s[4:7], s55 offen offset:2048 sc1 lds
    buffer_load_dwordx4 v1, s[4:7], s55 offen offset:3072 sc1 lds
    s_add_u32 s54, s54, 4096
    s_add_u32 s55, s55, 4096
    s_mov_b32 m0, s54
    s_nop 0
    buffer_load_dwordx4 v1, s[4:7], s55 offen offset:0 sc1 lds
    buffer_load_dwordx4 v1, s[4:7], s55 offen offset:1024 sc1 lds
    buffer_load_dwordx4 v1, s[4:7], s55 offen offset:2048 sc1 lds
    buffer_load_dwordx4 v1, s[4:7], s55 offen offset:3072 sc1 lds
    s_add_u32 s54, s54, 4096
    s_add_u32 s55, s55, 4096
    s_mov_b32 m0, s54
    s_nop 0
    buffer_load_dwordx4 v1, s[4:7], s55 offen offset:0 sc1 lds
    buffer_load_dwordx4 v1, s[4:7], s55 offen offset:1024 sc1 lds
    buffer_load_dwordx4 v1, s[4:7], s55 offen offset:2048 sc1 lds
    buffer_load_dwordx4 v1, s[4:7], s55 offen offset:3072 sc1 lds
    s_add_u32 s54, s54, 4096
    s_add_u32 s55, s55, 4096
    s_mov_b32 m0, s54
    s_nop 0
    buffer_load_dwordx4 v1, s[4:7], s55 offen offset:0 sc1 lds
    s_branch L_h_29
L_h_28:
    s_mov_b64 exec, 0xff
    buffer_store_dwordx2 v[4:5], v7, s[88:91], s53 offen sc1
    s_mov_b64 exec, -1
L_h_29:
    s_add_u32 s40, s66, 3670016
    s_lshl_b32 s41, s29, 11
    s_add_u32 s41, s41, 12320768
    s_waitcnt lgkmcnt(0)
    s_cmp_eq_u32 s22, 3
    s_cbranch_scc0 L_h_30
    s_mov_b64 exec, 0xff
    s_mov_b32 s36, 0
L_poll_31:
    buffer_load_dwordx2 v[4:5], v32, s[88:91], s52 offen sc1
    s_add_u32 s36, s36, 1
    s_cmp_gt_u32 s36, 2097152
    s_cbranch_scc1 L_abort
    s_waitcnt vmcnt(0)
    v_cmp_ne_u64 vcc, s[20:21], v[4:5]
    s_cbranch_vccnz L_poll_31
    s_mov_b64 exec, -1
L_h_30:
    s_barrier
    buffer_load_dwordx4 a[0:3], v1, s[88:91], s40 offen offset:0 sc1
    buffer_load_dwordx4 a[4:7], v1, s[88:91], s40 offen offset:1024 sc1
    buffer_load_dwordx4 a[8:11], v1, s[88:91], s40 offen offset:2048 sc1
    buffer_load_dwordx2 v[20:21], v246, s[88:91], s41 offen sc1
    buffer_load_dwordx2 v[22:23], v246, s[88:91], s41 offen offset:256 sc1
    buffer_load_dwordx4 a[12:15], v1, s[88:91], s40 offen offset:3072 sc1
    s_add_u32 s40, s40, 4096
    buffer_load_dwordx4 a[16:19], v1, s[88:91], s40 offen offset:0 sc1
    buffer_load_dwordx4 a[20:23], v1, s[88:91], s40 offen offset:1024 sc1
    buffer_load_dwordx4 a[24:27], v1, s[88:91], s40 offen offset:2048 sc1
    buffer_load_dwordx4 a[28:31], v1, s[88:91], s40 offen offset:3072 sc1
    s_add_u32 s40, s40, 4096
    buffer_load_dwordx4 a[32:35], v1, s[88:91], s40 offen offset:0 sc1
    buffer_load_dwordx4 a[36:39], v1, s[88:91], s40 offen offset:1024 sc1
    buffer_load_dwordx4 a[40:43], v1, s[88:91], s40 offen offset:2048 sc1
    buffer_load_dwordx4 a[44:47], v1, s[88:91], s40 offen offset:3072 sc1
    s_add_u32 s40, s40, 4096
    buffer_load_dwordx4 a[48:51], v1, s[88:91], s40 offen offset:0 sc1
    buffer_load_dwordx4 a[52:55], v1, s[88:91], s40 offen offset:1024 sc1
    buffer_load_dwordx4 a[56:59], v1, s[88:91], s40 offen offset:2048 sc1
    buffer_load_dwordx4 a[60:63], v1, s[88:91], s40 offen offset:3072 sc1
    s_add_u32 s40, s40, 4096
    buffer_load_dwordx4 a[64:67], v1, s[88:91], s40 offen offset:0 sc1
    buffer_load_dwordx4 a[68:71], v1, s[88:91], s40 offen offset:1024 sc1
    buffer_load_dwordx4 a[72:75], v1, s[88:91], s40 offen offset:2048 sc1
    buffer_load_dwordx4 a[76:79], v1, s[88:91], s40 offen offset:3072 sc1
    ds_read_b128 v[192:195], v252 offset:512
    ds_read_b128 v[196:199], v252 offset:576
    ds_read_b128 v[200:203], v252 offset:640
    ds_read_b128 v[204:207], v252 offset:704
    ds_read_b128 v[208:211], v252 offset:768
    ds_read_b128 v[92:95], v252 offset:1024
    ds_read_b128 v[96:99], v252 offset:1088
    v_lshlrev_b32 v7, 10, v0
    v_mov_b32 v4, s20
    v_mov_b32 v5, s21
    s_cmp_ge_u32 s24, 2
    s_cbranch_scc1 L_p4_q
    ds_read_b128 v[128:131], v58 offset:0
    ds_read_b128 v[132:135], v57 offset:0
    ds_read_b128 v[136:139], v58 offset:1536
    ds_read_b128 v[140:143], v57 offset:1536
    ds_read_b128 v[144:147], v58 offset:3072
    ds_read_b128 v[148:151], v57 offset:3072
    s_waitcnt vmcnt(17) lgkmcnt(6)
    v_add_f32 v20, v20, v22
    v_add_f32 v21, v21, v23
    v_mov_b32 v22, v20
    v_mov_b32 v23, v21
    s_nop 0
    v_permlane32_swap_b32 v20, v22
    v_permlane32_swap_b32 v21, v23
    v_add_f32 v20, v20, v22
    v_add_f32 v21, v21, v23
    v_mov_b32 v22, v20
    v_mov_b32 v23, v21
    s_nop 0
    v_permlane16_swap_b32 v20, v22
    v_permlane16_swap_b32 v21, v23
    v_add_f32 v20, v20, v22
    v_add_f32 v21, v21, v23
    v_mul_f32 v20, 0x3acccccd, v20
    v_mul_f32 v22, v20, v20
    v_mov_b32 v23, 0x3727c5ac
    v_sub_f32 v22, v23, v22
    v_fmac_f32 v22, 0x3acccccd, v21
    v_max_f32 v22, v22, v23
    v_rsq_f32 v28, v22
    s_nop 0
    v_mul_f32 v29, v20, v28
    v_sub_f32 v29, 0, v29
    s_cmp_eq_u32 s24, 0
    s_cbranch_scc0 L_p4_k1
    v_pk_mul_f32 v[92:93], v[92:93], v[28:29] op_sel:[0,1] op_sel_hi:[1,1]
    v_pk_mul_f32 v[94:95], v[94:95], v[28:29] op_sel:[0,1] op_sel_hi:[1,1]
    v_pk_mul_f32 v[96:97], v[96:97], v[28:29] op_sel:[0,1] op_sel_hi:[1,1]
    v_pk_mul_f32 v[98:99], v[98:99], v[28:29] op_sel:[0,1] op_sel_hi:[1,1]
    s_waitcnt vmcnt(19) lgkmcnt(4)
    v_mfma_f32_16x16x32_bf16 v[84:87], v[128:131], a[0:3], 0
    ds_read_b128 v[152:155], v58 offset:4608
    v_mfma_f32_16x16x32_bf16 v[88:91], v[132:135], a[0:3], 0
    ds_read_b128 v[156:159], v57 offset:4608
    s_waitcnt vmcnt(18) lgkmcnt(4)
    v_mfma_f32_16x16x32_bf16 v[84:87], v[136:139], a[4:7], v[84:87]
    ds_read_b128 v[128:131], v58 offset:6144
    v_mfma_f32_16x16x32_bf16 v[88:91], v[140:143], a[4:7], v[88:91]
    ds_read_b128 v[132:135], v57 offset:6144
    s_waitcnt vmcnt(17) lgkmcnt(4)
    v_mfma_f32_16x16x32_bf16 v[84:87], v[144:147], a[8:11], v[84:87]
    ds_read_b128 v[136:139], v58 offset:7680
    v_mfma_f32_16x16x32_bf16 v[88:91], v[148:151], a[8:11], v[88:91]
    ds_read_b128 v[140:143], v57 offset:7680
    s_waitcnt vmcnt(16) lgkmcnt(4)
    v_mfma_f32_16x16x32_bf16 v[84:87], v[152:155], a[12:15], v[84:87]
    ds_read_b128 v[144:147], v58 offset:9216
    v_mfma_f32_16x16x32_bf16 v[88:91], v[156:159], a[12:15], v[88:91]
    ds_read_b128 v[148:151], v57 offset:9216
    s_waitcnt vmcnt(15) lgkmcnt(4)
    v_mfma_f32_16x16x32_bf16 v[84:87], v[128:131], a[16:19], v[84:87]
    ds_read_b128 v[152:155], v58 offset:10752
    v_mfma_f32_16x16x32_bf16 v[88:91], v[132:135], a[16:19], v[88:91]
    ds_read_b128 v[156:159], v57 offset:10752
    s_waitcnt vmcnt(14) lgkmcnt(4)
    v_mfma_f32_16x16x32_bf16 v[84:87], v[136:139], a[20:23], v[84:87]
    ds_read_b128 v[128:131], v58 offset:12288
    v_mfma_f32_16x16x32_bf16 v[88:91], v[140:143], a[20:23], v[88:91]
    ds_read_b128 v[132:135], v57 offset:12288
    s_waitcnt vmcnt(13) lgkmcnt(4)
    v_mfma_f32_16x16x32_bf16 v[84:87], v[144:147], a[24:27], v[84:87]
    ds_read_b128 v[136:139], v58 offset:13824
    v_mfma_f32_16x16x32_bf16 v[88:91], v[148:151], a[24:27], v[88:91]
    ds_read_b128 v[140:143], v57 offset:13824
    s_waitcnt vmcnt(12) lgkmcnt(4)
    v_mfma_f32_16x16x32_bf16 v[84:87], v[152:155], a[28:31], v[84:87]
    ds_read_b128 v[144:147], v58 offset:15360
    v_mfma_f32_16x16x32_bf16 v[88:91], v[156:159], a[28:31], v[88:91]
    ds_read_b128 v[148:151], v57 offset:15360
    s_waitcnt vmcnt(11) lgkmcnt(4)
    v_mfma_f32_16x16x32_bf16 v[84:87], v[128:131], a[32:35], v[84:87]
    ds_read_b128 v[152:155], v58 offset:16896
    v_mfma_f32_16x16x32_bf16 v[88:91], v[132:135], a[32:35], v[88:91]
    ds_read_b128 v[156:159], v57 offset:16896
    s_waitcnt vmcnt(10) lgkmcnt(4)
    v_mfma_f32_16x16x32_bf16 v[84:87], v[136:139], a[36:39], v[84:87]
    ds_read_b128 v[128:131], v58 offset:18432
    v_mfma_f32_16x16x32_bf16 v[88:91], v[140:143], a[36:39], v[88:91]
    ds_read_b128 v[132:135], v57 offset:18432
    s_waitcnt vmcnt(9) lgkmcnt(4)
    v_mfma_f32_16x16x32_bf16 v[84:87], v[144:147], a[40:43], v[84:87]
    ds_read_b128 v[136:139], v58 offset:19968
    v_mfma_f32_16x16x32_bf16 v[88:91], v[148:151], a[40:43], v[88:91]
    ds_read_b128 v[140:143], v57 offset:19968
    s_waitcnt vmcnt(8) lgkmcnt(4)
    v_mfma_f32_16x16x32_bf16 v[84:87], v[152:155], a[44:47], v[84:87]
    ds_read_b128 v[144:147], v58 offset:21504
    v_mfma_f32_16x16x32_bf16 v[88:91], v[156:159], a[44:47], v[88:91]
    ds_read_b128 v[148:151], v57 offset:21504
    s_waitcnt vmcnt(7) lgkmcnt(4)
    v_mfma_f32_16x16x32_bf16 v[84:87], v[128:131], a[48:51], v[84:87]
    ds_read_b128 v[152:155], v58 offset:23040
    v_mfma_f32_16x16x32_bf16 v[88:91], v[132:135], a[48:51], v[88:91]
    ds_read_b128 v[156:159], v57 offset:23040
    s_waitcnt vmcnt(6) lgkmcnt(4)
    v_mfma_f32_16x16x32_bf16 v[84:87], v[136:139], a[52:55], v[84:87]
    ds_read_b128 v[128:131], v58 offset:24576
    v_mfma_f32_16x16x32_bf16 v[88:91], v[140:143], a[52:55], v[88:91]
    ds_read_b128 v[132:135], v57 offset:24576
    s_waitcnt vmcnt(5) lgkmcnt(4)
    v_mfma_f32_16x16x32_bf16 v[84:87], v[144:147], a[56:59], v[84:87]
    ds_read_b128 v[136:139], v58 offset:26112
    v_mfma_f32_16x16x32_bf16 v[88:91], v[148:151], a[56:59], v[88:91]
    ds_read_b128 v[140:143], v57 offset:26112
    s_waitcnt vmcnt(4) lgkmcnt(4)
    v_mfma_f32_16x16x32_bf16 v[84:87], v[152:155], a[60:63], v[84:87]
    ds_read_b128 v[144:147], v58 offset:27648
    v_mfma_f32_16x16x32_bf16 v[88:91], v[156:159], a[60:63], v[88:91]
    ds_read_b128 v[148:151], v57 offset:27648
    s_waitcnt vmcnt(3) lgkmcnt(4)
    v_mfma_f32_16x16x32_bf16 v[84:87], v[128:131], a[64:67], v[84:87]
    ds_read_b128 v[152:155], v58 offset:29184
    v_mfma_f32_16x16x32_bf16 v[88:91], v[132:135], a[64:67], v[88:91]
    ds_read_b128 v[156:159], v57 offset:29184
    s_waitcnt vmcnt(2) lgkmcnt(4)
    v_mfma_f32_16x16x32_bf16 v[84:87], v[136:139], a[68:71], v[84:87]
    v_mfma_f32_16x16x32_bf16 v[88:91], v[140:143], a[68:71], v[88:91]
    s_waitcnt vmcnt(1) lgkmcnt(2)
    v_mfma_f32_16x16x32_bf16 v[84:87], v[144:147], a[72:75], v[84:87]
    v_mfma_f32_16x16x32_bf16 v[88:91], v[148:151], a[72:75], v[88:91]
    s_waitcnt vmcnt(0) lgkmcnt(0)
    v_mfma_f32_16x16x32_bf16 v[84:87], v[152:155], a[76:79], v[84:87]
    v_mfma_f32_16x16x32_bf16 v[88:91], v[156:159], a[76:79], v[88:91]
    s_nop 6
    v_pk_fma_f32 v[84:85], v[84:85], v[28:29], v[92:93] op_sel:[0,0,0] op_sel_hi:[1,0,1]
    v_cvt_pk_bf16_f32 v100, v84, v85
    v_pk_fma_f32 v[86:87], v[86:87], v[28:29], v[94:95] op_sel:[0,0,0] op_sel_hi:[1,0,1]
    v_cvt_pk_bf16_f32 v101, v86, v87
    v_mov_b32 v102, v100
    v_mov_b32 v103, v101
    s_nop 0
    v_permlane16_swap_b32 v100, v102
    v_permlane16_swap_b32 v101, v103
    s_mov_b32 exec_lo, 0xffff
    s_mov_b32 exec_hi, 0xffff
    buffer_store_dwordx4 v[100:103], v244, s[88:91], s73 offen sc1
    s_mov_b64 exec, -1
    v_pk_fma_f32 v[88:89], v[88:89], v[28:29], v[96:97] op_sel:[0,0,0] op_sel_hi:[1,0,1]
    v_cvt_pk_bf16_f32 v104, v88, v89
    v_pk_fma_f32 v[90:91], v[90:91], v[28:29], v[98:99] op_sel:[0,0,0] op_sel_hi:[1,0,1]
    v_cvt_pk_bf16_f32 v105, v90, v91
    s_mov_b32 exec_lo, 0xffff0000
    s_mov_b32 exec_hi, 0x0
    v_mov_b32 v104, 0x3f803f80
    v_mov_b32 v105, 0
    s_mov_b64 exec, -1
    v_mov_b32_dpp v106, v104 row_ror:8 row_mask:0xf bank_mask:0xf
    v_mov_b32_dpp v107, v105 row_ror:8 row_mask:0xf bank_mask:0xf
    s_mov_b64 exec, 0xff00ff
    buffer_store_dwordx4 v[104:107], v245, s[88:91], s74 offen sc1
    s_branch L_p4_k3
L_p4_k1:
    ds_write_b64 v247, v[28:29]
    ds_read_b128 v[8:11], v248
    ds_read_b128 v[12:15], v248 offset:16
    ds_read_b32 v16, v245
    ds_read_b32 v17, v245 offset:64
    v_cmp_eq_u32 vcc, 4, v2
    v_mov_b32 v18, 0x3f803f80
    s_nop 0
    v_cndmask_b32 v18, 0, v18, vcc
    s_waitcnt lgkmcnt(0)
    v_mul_f32 v92, v9, v16
    v_mul_f32 v93, v11, v16
    v_mul_f32 v94, v13, v16
    v_mul_f32 v95, v15, v16
    v_mul_f32 v96, v9, v17
    v_mul_f32 v97, v11, v17
    v_mul_f32 v98, v13, v17
    v_mul_f32 v99, v15, v17
    s_waitcnt vmcnt(19) lgkmcnt(4)
    v_mfma_f32_16x16x32_bf16 v[84:87], a[0:3], v[128:131], 0
    ds_read_b128 v[152:155], v58 offset:4608
    v_mfma_f32_16x16x32_bf16 v[88:91], a[0:3], v[132:135], 0
    ds_read_b128 v[156:159], v57 offset:4608
    s_waitcnt vmcnt(18) lgkmcnt(4)
    v_mfma_f32_16x16x32_bf16 v[84:87], a[4:7], v[136:139], v[84:87]
    ds_read_b128 v[128:131], v58 offset:6144
    v_mfma_f32_16x16x32_bf16 v[88:91], a[4:7], v[140:143], v[88:91]
    ds_read_b128 v[132:135], v57 offset:6144
    s_waitcnt vmcnt(17) lgkmcnt(4)
    v_mfma_f32_16x16x32_bf16 v[84:87], a[8:11], v[144:147], v[84:87]
    ds_read_b128 v[136:139], v58 offset:7680
    v_mfma_f32_16x16x32_bf16 v[88:91], a[8:11], v[148:151], v[88:91]
    ds_read_b128 v[140:143], v57 offset:7680
    s_waitcnt vmcnt(16) lgkmcnt(4)
    v_mfma_f32_16x16x32_bf16 v[84:87], a[12:15], v[152:155], v[84:87]
    ds_read_b128 v[144:147], v58 offset:9216
    v_mfma_f32_16x16x32_bf16 v[88:91], a[12:15], v[156:159], v[88:91]
    ds_read_b128 v[148:151], v57 offset:9216
    s_waitcnt vmcnt(15) lgkmcnt(4)
    v_mfma_f32_16x16x32_bf16 v[84:87], a[16:19], v[128:131], v[84:87]
    ds_read_b128 v[152:155], v58 offset:10752
    v_mfma_f32_16x16x32_bf16 v[88:91], a[16:19], v[132:135], v[88:91]
    ds_read_b128 v[156:159], v57 offset:10752
    s_waitcnt vmcnt(14) lgkmcnt(4)
    v_mfma_f32_16x16x32_bf16 v[84:87], a[20:23], v[136:139], v[84:87]
    ds_read_b128 v[128:131], v58 offset:12288
    v_mfma_f32_16x16x32_bf16 v[88:91], a[20:23], v[140:143], v[88:91]
    ds_read_b128 v[132:135], v57 offset:12288
    s_waitcnt vmcnt(13) lgkmcnt(4)
    v_mfma_f32_16x16x32_bf16 v[84:87], a[24:27], v[144:147], v[84:87]
    ds_read_b128 v[136:139], v58 offset:13824
    v_mfma_f32_16x16x32_bf16 v[88:91], a[24:27], v[148:151], v[88:91]
    ds_read_b128 v[140:143], v57 offset:13824
    s_waitcnt vmcnt(12) lgkmcnt(4)
    v_mfma_f32_16x16x32_bf16 v[84:87], a[28:31], v[152:155], v[84:87]
    ds_read_b128 v[144:147], v58 offset:15360
    v_mfma_f32_16x16x32_bf16 v[88:91], a[28:31], v[156:159], v[88:91]
    ds_read_b128 v[148:151], v57 offset:15360
    s_waitcnt vmcnt(11) lgkmcnt(4)
    v_mfma_f32_16x16x32_bf16 v[84:87], a[32:35], v[128:131], v[84:87]
    ds_read_b128 v[152:155], v58 offset:16896
    v_mfma_f32_16x16x32_bf16 v[88:91], a[32:35], v[132:135], v[88:91]
    ds_read_b128 v[156:159], v57 offset:16896
    s_waitcnt vmcnt(10) lgkmcnt(4)
    v_mfma_f32_16x16x32_bf16 v[84:87], a[36:39], v[136:139], v[84:87]
    ds_read_b128 v[128:131], v58 offset:18432
    v_mfma_f32_16x16x32_bf16 v[88:91], a[36:39], v[140:143], v[88:91]
    ds_read_b128 v[132:135], v57 offset:18432
    s_waitcnt vmcnt(9) lgkmcnt(4)
    v_mfma_f32_16x16x32_bf16 v[84:87], a[40:43], v[144:147], v[84:87]
    ds_read_b128 v[136:139], v58 offset:19968
    v_mfma_f32_16x16x32_bf16 v[88:91], a[40:43], v[148:151], v[88:91]
    ds_read_b128 v[140:143], v57 offset:19968
    s_waitcnt vmcnt(8) lgkmcnt(4)
    v_mfma_f32_16x16x32_bf16 v[84:87], a[44:47], v[152:155], v[84:87]
    ds_read_b128 v[144:147], v58 offset:21504
    v_mfma_f32_16x16x32_bf16 v[88:91], a[44:47], v[156:159], v[88:91]
    ds_read_b128 v[148:151], v57 offset:21504
    s_waitcnt vmcnt(7) lgkmcnt(4)
    v_mfma_f32_16x16x32_bf16 v[84:87], a[48:51], v[128:131], v[84:87]
    ds_read_b128 v[152:155], v58 offset:23040
    v_mfma_f32_16x16x32_bf16 v[88:91], a[48:51], v[132:135], v[88:91]
    ds_read_b128 v[156:159], v57 offset:23040
    s_waitcnt vmcnt(6) lgkmcnt(4)
    v_mfma_f32_16x16x32_bf16 v[84:87], a[52:55], v[136:139], v[84:87]
    ds_read_b128 v[128:131], v58 offset:24576
    v_mfma_f32_16x16x32_bf16 v[88:91], a[52:55], v[140:143], v[88:91]
    ds_read_b128 v[132:135], v57 offset:24576
    s_waitcnt vmcnt(5) lgkmcnt(4)
    v_mfma_f32_16x16x32_bf16 v[84:87], a[56:59], v[144:147], v[84:87]
    ds_read_b128 v[136:139], v58 offset:26112
    v_mfma_f32_16x16x32_bf16 v[88:91], a[56:59], v[148:151], v[88:91]
    ds_read_b128 v[140:143], v57 offset:26112
    s_waitcnt vmcnt(4) lgkmcnt(4)
    v_mfma_f32_16x16x32_bf16 v[84:87], a[60:63], v[152:155], v[84:87]
    ds_read_b128 v[144:147], v58 offset:27648
    v_mfma_f32_16x16x32_bf16 v[88:91], a[60:63], v[156:159], v[88:91]
    ds_read_b128 v[148:151], v57 offset:27648
    s_waitcnt vmcnt(3) lgkmcnt(4)
    v_mfma_f32_16x16x32_bf16 v[84:87], a[64:67], v[128:131], v[84:87]
    ds_read_b128 v[152:155], v58 offset:29184
    v_mfma_f32_16x16x32_bf16 v[88:91], a[64:67], v[132:135], v[88:91]
    ds_read_b128 v[156:159], v57 offset:29184
    s_waitcnt vmcnt(2) lgkmcnt(4)
    v_mfma_f32_16x16x32_bf16 v[84:87], a[68:71], v[136:139], v[84:87]
    v_mfma_f32_16x16x32_bf16 v[88:91], a[68:71], v[140:143], v[88:91]
    s_waitcnt vmcnt(1) lgkmcnt(2)
    v_mfma_f32_16x16x32_bf16 v[84:87], a[72:75], v[144:147], v[84:87]
    v_mfma_f32_16x16x32_bf16 v[88:91], a[72:75], v[148:151], v[88:91]
    s_waitcnt vmcnt(0) lgkmcnt(0)
    v_mfma_f32_16x16x32_bf16 v[84:87], a[76:79], v[152:155], v[84:87]
    v_mfma_f32_16x16x32_bf16 v[88:91], a[76:79], v[156:159], v[88:91]
    s_nop 6
    v_fma_f32 v84, v84, v8, v92
    v_fma_f32 v85, v85, v10, v93
    v_fma_f32 v86, v86, v12, v94
    v_fma_f32 v87, v87, v14, v95
    v_cvt_pk_bf16_f32 v100, v84, v85
    v_cvt_pk_bf16_f32 v101, v86, v87
    v_mov_b32 v102, v100
    v_mov_b32 v103, v101
    s_nop 0
    v_permlane16_swap_b32 v100, v102
    v_permlane16_swap_b32 v101, v103
    s_mov_b32 exec_lo, 0xffff
    s_mov_b32 exec_hi, 0xffff
    buffer_store_dwordx4 v[100:103], v244, s[88:91], s73 offen offset:0 sc1
    s_mov_b64 exec, -1
    v_fma_f32 v88, v88, v8, v96
    v_fma_f32 v89, v89, v10, v97
    v_fma_f32 v90, v90, v12, v98
    v_fma_f32 v91, v91, v14, v99
    v_cvt_pk_bf16_f32 v104, v88, v89
    v_cvt_pk_bf16_f32 v105, v90, v91
    s_mov_b32 exec_lo, 0xfff0fff0
    s_mov_b32 exec_hi, 0xfff0fff0
    v_mov_b32 v104, v18
    v_mov_b32 v105, v18
    s_mov_b64 exec, -1
    v_mov_b32 v106, v104
    v_mov_b32 v107, v105
    s_nop 0
    v_permlane16_swap_b32 v104, v106
    v_permlane16_swap_b32 v105, v107
    s_mov_b32 exec_lo, 0xffff
    s_mov_b32 exec_hi, 0xffff
    buffer_store_dwordx4 v[104:107], v244, s[88:91], s73 offen offset:256 sc1
L_p4_k3:
    s_mov_b64 exec, -1
    s_cmp_eq_u32 s22, 3
    s_waitcnt vmcnt(0)
    s_barrier
    s_cbranch_scc0 L_p4_k2
    s_mov_b64 exec, 0xffffffff
    buffer_store_dwordx2 v[4:5], v7, s[88:91], s75 offen sc1
    s_mov_b64 exec, -1
    s_branch L_p4_k2
L_p4_q:
    s_waitcnt vmcnt(17)
    v_add_f32 v20, v20, v22
    v_add_f32 v21, v21, v23
    v_mov_b32 v22, v20
    v_mov_b32 v23, v21
    s_nop 0
    v_permlane32_swap_b32 v20, v22
    v_permlane32_swap_b32 v21, v23
    v_add_f32 v20, v20, v22
    v_add_f32 v21, v21, v23
    v_mov_b32 v22, v20
    v_mov_b32 v23, v21
    s_nop 0
    v_permlane16_swap_b32 v20, v22
    v_permlane16_swap_b32 v21, v23
    v_add_f32 v20, v20, v22
    v_add_f32 v21, v21, v23
    v_mul_f32 v20, 0x3acccccd, v20
    v_mul_f32 v22, v20, v20
    v_mov_b32 v23, 0x3727c5ac
    v_sub_f32 v22, v23, v22
    v_fmac_f32 v22, 0x3acccccd, v21
    v_max_f32 v22, v22, v23
    v_rsq_f32 v28, v22
    s_nop 0
    v_mul_f32 v29, v20, v28
    v_sub_f32 v29, 0, v29
    s_barrier
L_p4_k2:
    v_mul_f32 v28, 0x3ea52b5c, v28
    v_mul_f32 v29, 0x3ea52b5c, v29
    s_waitcnt lgkmcnt(0)
    ds_read_b128 v[128:131], v1 offset:0
    ds_read_b128 v[132:135], v1 offset:1024
    ds_read_b128 v[136:139], v1 offset:2048
    ds_read_b128 v[140:143], v1 offset:3072
    ds_read_b128 v[144:147], v1 offset:4096
    ds_read_b128 v[148:151], v1 offset:5120
    ds_read_b128 v[152:155], v1 offset:6144
    ds_read_b128 v[156:159], v1 offset:7168
    ds_read_b128 v[160:163], v1 offset:8192
    ds_read_b128 v[164:167], v1 offset:9216
    v_pk_mul_f32 v[192:193], v[192:193], v[28:29] op_sel:[0,1] op_sel_hi:[1,1]
    v_pk_mul_f32 v[194:195], v[194:195], v[28:29] op_sel:[0,1] op_sel_hi:[1,1]
    v_pk_mul_f32 v[196:197], v[196:197], v[28:29] op_sel:[0,1] op_sel_hi:[1,1]
    v_pk_mul_f32 v[198:199], v[198:199], v[28:29] op_sel:[0,1] op_sel_hi:[1,1]
    v_pk_mul_f32 v[200:201], v[200:201], v[28:29] op_sel:[0,1] op_sel_hi:[1,1]
    v_pk_mul_f32 v[202:203], v[202:203], v[28:29] op_sel:[0,1] op_sel_hi:[1,1]
    v_pk_mul_f32 v[204:205], v[204:205], v[28:29] op_sel:[0,1] op_sel_hi:[1,1]
    v_pk_mul_f32 v[206:207], v[206:207], v[28:29] op_sel:[0,1] op_sel_hi:[1,1]
    v_pk_mul_f32 v[208:209], v[208:209], v[28:29] op_sel:[0,1] op_sel_hi:[1,1]
    v_pk_mul_f32 v[210:211], v[210:211], v[28:29] op_sel:[0,1] op_sel_hi:[1,1]
    s_waitcnt vmcnt(19) lgkmcnt(5)
    v_mfma_f32_16x16x32_bf16 v[64:67], v[128:131], a[0:3], 0
    ds_read_b128 v[168:171], v1 offset:10240
    v_mfma_f32_16x16x32_bf16 v[68:71], v[132:135], a[0:3], 0
    ds_read_b128 v[172:175], v1 offset:11264
    v_mfma_f32_16x16x32_bf16 v[72:75], v[136:139], a[0:3], 0
    ds_read_b128 v[176:179], v1 offset:12288
    v_mfma_f32_16x16x32_bf16 v[76:79], v[140:143], a[0:3], 0
    ds_read_b128 v[180:183], v1 offset:13312
    v_mfma_f32_16x16x32_bf16 v[80:83], v[144:147], a[0:3], 0
    ds_read_b128 v[184:187], v1 offset:14336
    s_waitcnt vmcnt(18) lgkmcnt(5)
    v_mfma_f32_16x16x32_bf16 v[64:67], v[148:151], a[4:7], v[64:67]
    ds_read_b128 v[128:131], v1 offset:15360
    v_mfma_f32_16x16x32_bf16 v[68:71], v[152:155], a[4:7], v[68:71]
    ds_read_b128 v[132:135], v1 offset:16384
    v_mfma_f32_16x16x32_bf16 v[72:75], v[156:159], a[4:7], v[72:75]
    ds_read_b128 v[136:139], v1 offset:17408
    v_mfma_f32_16x16x32_bf16 v[76:79], v[160:163], a[4:7], v[76:79]
    ds_read_b128 v[140:143], v1 offset:18432
    v_mfma_f32_16x16x32_bf16 v[80:83], v[164:167], a[4:7], v[80:83]
    ds_read_b128 v[144:147], v1 offset:19456
    s_waitcnt vmcnt(17) lgkmcnt(5)
    v_mfma_f32_16x16x32_bf16 v[64:67], v[168:171], a[8:11], v[64:67]
    ds_read_b128 v[148:151], v1 offset:20480
    v_mfma_f32_16x16x32_bf16 v[68:71], v[172:175], a[8:11], v[68:71]
    ds_read_b128 v[152:155], v1 offset:21504
    v_mfma_f32_16x16x32_bf16 v[72:75], v[176:179], a[8:11], v[72:75]
    ds_read_b128 v[156:159], v1 offset:22528
    v_mfma_f32_16x16x32_bf16 v[76:79], v[180:183], a[8:11], v[76:79]
    ds_read_b128 v[160:163], v1 offset:23552
    v_mfma_f32_16x16x32_bf16 v[80:83], v[184:187], a[8:11], v[80:83]
    ds_read_b128 v[164:167], v1 offset:24576
    s_waitcnt vmcnt(16) lgkmcnt(5)
    v_mfma_f32_16x16x32_bf16 v[64:67], v[128:131], a[12:15], v[64:67]
    ds_read_b128 v[168:171], v1 offset:25600
    v_mfma_f32_16x16x32_bf16 v[68:71], v[132:135], a[12:15], v[68:71]
    ds_read_b128 v[172:175], v1 offset:26624
    v_mfma_f32_16x16x32_bf16 v[72:75], v[136:139], a[12:15], v[72:75]
    ds_read_b128 v[176:179], v1 offset:27648
    v_mfma_f32_16x16x32_bf16 v[76:79], v[140:143], a[12:15], v[76:79]
    ds_read_b128 v[180:183], v1 offset:28672
    v_mfma_f32_16x16x32_bf16 v[80:83], v[144:147], a[12:15], v[80:83]
    ds_read_b128 v[184:187], v1 offset:29696
    s_waitcnt vmcnt(15) lgkmcnt(5)
    v_mfma_f32_16x16x32_bf16 v[64:67], v[148:151], a[16:19], v[64:67]
    ds_read_b128 v[128:131], v1 offset:30720
    v_mfma_f32_16x16x32_bf16 v[68:71], v[152:155], a[16:19], v[68:71]
    ds_read_b128 v[132:135], v1 offset:31744
    v_mfma_f32_16x16x32_bf16 v[72:75], v[156:159], a[16:19], v[72:75]
    ds_read_b128 v[136:139], v1 offset:32768
    v_mfma_f32_16x16x32_bf16 v[76:79], v[160:163], a[16:19], v[76:79]
    ds_read_b128 v[140:143], v1 offset:33792
    v_mfma_f32_16x16x32_bf16 v[80:83], v[164:167], a[16:19], v[80:83]
    ds_read_b128 v[144:147], v1 offset:34816
    s_waitcnt vmcnt(14) lgkmcnt(5)
    v_mfma_f32_16x16x32_bf16 v[64:67], v[168:171], a[20:23], v[64:67]
    ds_read_b128 v[148:151], v1 offset:35840
    v_mfma_f32_16x16x32_bf16 v[68:71], v[172:175], a[20:23], v[68:71]
    ds_read_b128 v[152:155], v1 offset:36864
    v_mfma_f32_16x16x32_bf16 v[72:75], v[176:179], a[20:23], v[72:75]
    ds_read_b128 v[156:159], v1 offset:37888
    v_mfma_f32_16x16x32_bf16 v[76:79], v[180:183], a[20:23], v[76:79]
    ds_read_b128 v[160:163], v1 offset:38912
    v_mfma_f32_16x16x32_bf16 v[80:83], v[184:187], a[20:23], v[80:83]
    ds_read_b128 v[164:167], v1 offset:39936
    s_waitcnt vmcnt(13) lgkmcnt(5)
    v_mfma_f32_16x16x32_bf16 v[64:67], v[128:131], a[24:27], v[64:67]
    ds_read_b128 v[168:171], v1 offset:40960
    v_mfma_f32_16x16x32_bf16 v[68:71], v[132:135], a[24:27], v[68:71]
    ds_read_b128 v[172:175], v1 offset:41984
    v_mfma_f32_16x16x32_bf16 v[72:75], v[136:139], a[24:27], v[72:75]
    ds_read_b128 v[176:179], v1 offset:43008
    v_mfma_f32_16x16x32_bf16 v[76:79], v[140:143], a[24:27], v[76:79]
    ds_read_b128 v[180:183], v1 offset:44032
    v_mfma_f32_16x16x32_bf16 v[80:83], v[144:147], a[24:27], v[80:83]
    ds_read_b128 v[184:187], v1 offset:45056
    s_waitcnt vmcnt(12) lgkmcnt(5)
    v_mfma_f32_16x16x32_bf16 v[64:67], v[148:151], a[28:31], v[64:67]
    ds_read_b128 v[128:131], v1 offset:46080
    v_mfma_f32_16x16x32_bf16 v[68:71], v[152:155], a[28:31], v[68:71]
    ds_read_b128 v[132:135], v1 offset:47104
    v_mfma_f32_16x16x32_bf16 v[72:75], v[156:159], a[28:31], v[72:75]
    ds_read_b128 v[136:139], v1 offset:48128
    v_mfma_f32_16x16x32_bf16 v[76:79], v[160:163], a[28:31], v[76:79]
    ds_read_b128 v[140:143], v1 offset:49152
    v_mfma_f32_16x16x32_bf16 v[80:83], v[164:167], a[28:31], v[80:83]
    ds_read_b128 v[144:147], v1 offset:50176
    s_waitcnt vmcnt(11) lgkmcnt(5)
    v_mfma_f32_16x16x32_bf16 v[64:67], v[168:171], a[32:35], v[64:67]
    ds_read_b128 v[148:151], v38 offset:0
    v_mfma_f32_16x16x32_bf16 v[68:71], v[172:175], a[32:35], v[68:71]
    ds_read_b128 v[152:155], v38 offset:1024
    v_mfma_f32_16x16x32_bf16 v[72:75], v[176:179], a[32:35], v[72:75]
    ds_read_b128 v[156:159], v38 offset:2048
    v_mfma_f32_16x16x32_bf16 v[76:79], v[180:183], a[32:35], v[76:79]
    ds_read_b128 v[160:163], v38 offset:3072
    v_mfma_f32_16x16x32_bf16 v[80:83], v[184:187], a[32:35], v[80:83]
    ds_read_b128 v[164:167], v38 offset:4096
    s_waitcnt vmcnt(10) lgkmcnt(5)
    v_mfma_f32_16x16x32_bf16 v[64:67], v[128:131], a[36:39], v[64:67]
    ds_read_b128 v[168:171], v38 offset:5120
    v_mfma_f32_16x16x32_bf16 v[68:71], v[132:135], a[36:39], v[68:71]
    ds_read_b128 v[172:175], v38 offset:6144
    v_mfma_f32_16x16x32_bf16 v[72:75], v[136:139], a[36:39], v[72:75]
    ds_read_b128 v[176:179], v38 offset:7168
    v_mfma_f32_16x16x32_bf16 v[76:79], v[140:143], a[36:39], v[76:79]
    ds_read_b128 v[180:183], v38 offset:8192
    v_mfma_f32_16x16x32_bf16 v[80:83], v[144:147], a[36:39], v[80:83]
    ds_read_b128 v[184:187], v38 offset:9216
    s_waitcnt vmcnt(9) lgkmcnt(5)
    v_mfma_f32_16x16x32_bf16 v[64:67], v[148:151], a[40:43], v[64:67]
    ds_read_b128 v[128:131], v38 offset:10240
    v_mfma_f32_16x16x32_bf16 v[68:71], v[152:155], a[40:43], v[68:71]
    ds_read_b128 v[132:135], v38 offset:11264
    v_mfma_f32_16x16x32_bf16 v[72:75], v[156:159], a[40:43], v[72:75]
    ds_read_b128 v[136:139], v38 offset:12288
    v_mfma_f32_16x16x32_bf16 v[76:79], v[160:163], a[40:43], v[76:79]
    ds_read_b128 v[140:143], v38 offset:13312
    v_mfma_f32_16x16x32_bf16 v[80:83], v[164:167], a[40:43], v[80:83]
    ds_read_b128 v[144:147], v38 offset:14336
    s_waitcnt vmcnt(8) lgkmcnt(5)
    v_mfma_f32_16x16x32_bf16 v[64:67], v[168:171], a[44:47], v[64:67]
    ds_read_b128 v[148:151], v38 offset:15360
    v_mfma_f32_16x16x32_bf16 v[68:71], v[172:175], a[44:47], v[68:71]
    ds_read_b128 v[152:155], v38 offset:16384
    v_mfma_f32_16x16x32_bf16 v[72:75], v[176:179], a[44:47], v[72:75]
    ds_read_b128 v[156:159], v38 offset:17408
    v_mfma_f32_16x16x32_bf16 v[76:79], v[180:183], a[44:47], v[76:79]
    ds_read_b128 v[160:163], v38 offset:18432
    v_mfma_f32_16x16x32_bf16 v[80:83], v[184:187], a[44:47], v[80:83]
    ds_read_b128 v[164:167], v38 offset:19456
    s_waitcnt vmcnt(7) lgkmcnt(5)
    v_mfma_f32_16x16x32_bf16 v[64:67], v[128:131], a[48:51], v[64:67]
    ds_read_b128 v[168:171], v38 offset:20480
    v_mfma_f32_16x16x32_bf16 v[68:71], v[132:135], a[48:51], v[68:71]
    ds_read_b128 v[172:175], v38 offset:21504
    v_mfma_f32_16x16x32_bf16 v[72:75], v[136:139], a[48:51], v[72:75]
    ds_read_b128 v[176:179], v38 offset:22528
    v_mfma_f32_16x16x32_bf16 v[76:79], v[140:143], a[48:51], v[76:79]
    ds_read_b128 v[180:183], v38 offset:23552
    v_mfma_f32_16x16x32_bf16 v[80:83], v[144:147], a[48:51], v[80:83]
    ds_read_b128 v[184:187], v38 offset:24576
    s_waitcnt vmcnt(6) lgkmcnt(5)
    v_mfma_f32_16x16x32_bf16 v[64:67], v[148:151], a[52:55], v[64:67]
    ds_read_b128 v[128:131], v38 offset:25600
    v_mfma_f32_16x16x32_bf16 v[68:71], v[152:155], a[52:55], v[68:71]
    ds_read_b128 v[132:135], v38 offset:26624
    v_mfma_f32_16x16x32_bf16 v[72:75], v[156:159], a[52:55], v[72:75]
    ds_read_b128 v[136:139], v38 offset:27648
    v_mfma_f32_16x16x32_bf16 v[76:79], v[160:163], a[52:55], v[76:79]
    ds_read_b128 v[140:143], v38 offset:28672
    v_mfma_f32_16x16x32_bf16 v[80:83], v[164:167], a[52:55], v[80:83]
    ds_read_b128 v[144:147], v38 offset:29696
    s_waitcnt vmcnt(5) lgkmcnt(5)
    v_mfma_f32_16x16x32_bf16 v[64:67], v[168:171], a[56:59], v[64:67]
    ds_read_b128 v[148:151], v38 offset:30720
    v_mfma_f32_16x16x32_bf16 v[68:71], v[172:175], a[56:59], v[68:71]
    ds_read_b128 v[152:155], v38 offset:31744
    v_mfma_f32_16x16x32_bf16 v[72:75], v[176:179], a[56:59], v[72:75]
    ds_read_b128 v[156:159], v38 offset:32768
    v_mfma_f32_16x16x32_bf16 v[76:79], v[180:183], a[56:59], v[76:79]
    ds_read_b128 v[160:163], v38 offset:33792
    v_mfma_f32_16x16x32_bf16 v[80:83], v[184:187], a[56:59], v[80:83]
    ds_read_b128 v[164:167], v38 offset:34816
    s_waitcnt vmcnt(4) lgkmcnt(5)
    v_mfma_f32_16x16x32_bf16 v[64:67], v[128:131], a[60:63], v[64:67]
    ds_read_b128 v[168:171], v38 offset:35840
    v_mfma_f32_16x16x32_bf16 v[68:71], v[132:135], a[60:63], v[68:71]
    ds_read_b128 v[172:175], v38 offset:36864
    v_mfma_f32_16x16x32_bf16 v[72:75], v[136:139], a[60:63], v[72:75]
    ds_read_b128 v[176:179], v38 offset:37888
    v_mfma_f32_16x16x32_bf16 v[76:79], v[140:143], a[60:63], v[76:79]
    ds_read_b128 v[180:183], v38 offset:38912
    v_mfma_f32_16x16x32_bf16 v[80:83], v[144:147], a[60:63], v[80:83]
    ds_read_b128 v[184:187], v38 offset:39936
    s_waitcnt vmcnt(3) lgkmcnt(5)
    v_mfma_f32_16x16x32_bf16 v[64:67], v[148:151], a[64:67], v[64:67]
    ds_read_b128 v[128:131], v38 offset:40960
    v_mfma_f32_16x16x32_bf16 v[68:71], v[152:155], a[64:67], v[68:71]
    ds_read_b128 v[132:135], v38 offset:41984
    v_mfma_f32_16x16x32_bf16 v[72:75], v[156:159], a[64:67], v[72:75]
    ds_read_b128 v[136:139], v38 offset:43008
    v_mfma_f32_16x16x32_bf16 v[76:79], v[160:163], a[64:67], v[76:79]
    ds_read_b128 v[140:143], v38 offset:44032
    v_mfma_f32_16x16x32_bf16 v[80:83], v[164:167], a[64:67], v[80:83]
    ds_read_b128 v[144:147], v38 offset:45056
    s_waitcnt vmcnt(2) lgkmcnt(5)
    v_mfma_f32_16x16x32_bf16 v[64:67], v[168:171], a[68:71], v[64:67]
    ds_read_b128 v[148:151], v38 offset:46080
    v_mfma_f32_16x16x32_bf16 v[68:71], v[172:175], a[68:71], v[68:71]
    ds_read_b128 v[152:155], v38 offset:47104
    v_mfma_f32_16x16x32_bf16 v[72:75], v[176:179], a[68:71], v[72:75]
    ds_read_b128 v[156:159], v38 offset:48128
    v_mfma_f32_16x16x32_bf16 v[76:79], v[180:183], a[68:71], v[76:79]
    ds_read_b128 v[160:163], v38 offset:49152
    v_mfma_f32_16x16x32_bf16 v[80:83], v[184:187], a[68:71], v[80:83]
    ds_read_b128 v[164:167], v38 offset:50176
    s_waitcnt vmcnt(1) lgkmcnt(5)
    v_mfma_f32_16x16x32_bf16 v[64:67], v[128:131], a[72:75], v[64:67]
    v_mfma_f32_16x16x32_bf16 v[68:71], v[132:135], a[72:75], v[68:71]
    v_mfma_f32_16x16x32_bf16 v[72:75], v[136:139], a[72:75], v[72:75]
    v_mfma_f32_16x16x32_bf16 v[76:79], v[140:143], a[72:75], v[76:79]
    v_mfma_f32_16x16x32_bf16 v[80:83], v[144:147], a[72:75], v[80:83]
    s_waitcnt vmcnt(0) lgkmcnt(0)
    v_mfma_f32_16x16x32_bf16 v[64:67], v[148:151], a[76:79], v[64:67]
    v_mfma_f32_16x16x32_bf16 v[68:71], v[152:155], a[76:79], v[68:71]
    v_mfma_f32_16x16x32_bf16 v[72:75], v[156:159], a[76:79], v[72:75]
    v_mfma_f32_16x16x32_bf16 v[76:79], v[160:163], a[76:79], v[76:79]
    v_mfma_f32_16x16x32_bf16 v[80:83], v[164:167], a[76:79], v[80:83]
    s_mov_b32 exec_lo, 0
    v_mov_b32 v8, 0
    v_mov_b32 v9, 0
    ds_write_b64 v250, v[8:9] offset:1024
    ds_write_b64 v250, v[8:9] offset:2560
    s_mov_b32 exec_lo, -1
    v_pk_fma_f32 v[64:65], v[64:65], v[28:29], v[192:193] op_sel:[0,0,0] op_sel_hi:[1,0,1]
    v_cvt_pk_bf16_f32 v100, v64, v65
    v_pk_fma_f32 v[66:67], v[66:67], v[28:29], v[194:195] op_sel:[0,0,0] op_sel_hi:[1,0,1]
    v_cvt_pk_bf16_f32 v101, v66, v67
    ds_write_b64 v59, v[100:101]
    v_pk_fma_f32 v[68:69], v[68:69], v[28:29], v[196:197] op_sel:[0,0,0] op_sel_hi:[1,0,1]
    v_cvt_pk_bf16_f32 v102, v68, v69
    v_pk_fma_f32 v[70:71], v[70:71], v[28:29], v[198:199] op_sel:[0,0,0] op_sel_hi:[1,0,1]
    v_cvt_pk_bf16_f32 v103, v70, v71
    ds_write_b64 v60, v[102:103]
    v_pk_fma_f32 v[72:73], v[72:73], v[28:29], v[200:201] op_sel:[0,0,0] op_sel_hi:[1,0,1]
    v_cvt_pk_bf16_f32 v104, v72, v73
    v_pk_fma_f32 v[74:75], v[74:75], v[28:29], v[202:203] op_sel:[0,0,0] op_sel_hi:[1,0,1]
    v_cvt_pk_bf16_f32 v105, v74, v75
    ds_write_b64 v61, v[104:105]
    v_pk_fma_f32 v[76:77], v[76:77], v[28:29], v[204:205] op_sel:[0,0,0] op_sel_hi:[1,0,1]
    v_cvt_pk_bf16_f32 v106, v76, v77
    v_pk_fma_f32 v[78:79], v[78:79], v[28:29], v[206:207] op_sel:[0,0,0] op_sel_hi:[1,0,1]
    v_cvt_pk_bf16_f32 v107, v78, v79
    ds_write_b64 v62, v[106:107]
    v_pk_fma_f32 v[80:81], v[80:81], v[28:29], v[208:209] op_sel:[0,0,0] op_sel_hi:[1,0,1]
    v_cvt_pk_bf16_f32 v108, v80, v81
    v_pk_fma_f32 v[82:83], v[82:83], v[28:29], v[210:211] op_sel:[0,0,0] op_sel_hi:[1,0,1]
    v_cvt_pk_bf16_f32 v109, v82, v83
    ds_write_b64 v63, v[108:109]
    s_and_b32 s44, s30, 31
    s_lshl_b32 s44, s44, 10
    s_add_u32 s44, s44, 12779520
    s_lshl_b32 s40, s22, 14
    s_add_u32 s40, s40, 6422528
    s_lshl_b32 s41, s22, 13
    s_add_u32 s41, s41, 6488064
    s_lshl_b32 s42, s22, 15
    s_add_u32 s42, s42, 6553600
    s_mov_b32 s45, s22
    s_mul_i32 s47, s45, 6144
    s_add_u32 s47, s47, 102400
    v_add_u32 v30, s47, v1
    s_mul_i32 s47, s45, 3072
    s_add_u32 s47, s47, 133120
    v_add_u32 v27, s47, v1
    v_add_u32 v28, s47, v32
    s_mul_i32 s54, s22, 12288
    s_min_u32 s54, s54, 35840
    s_add_u32 s53, s77, s54
    s_add_u32 s53, s53, 6291456
    s_add_u32 s52, s54, 51200
    s_add_u32 s43, s78, 1048576
    s_add_u32 s47, s77, 6291456
    s_cmp_eq_u32 s27, 0
    s_cselect_b32 s43, s43, s47
    s_add_u32 s43, s43, s52
    s_lshr_b32 s46, s30, 5
    s_and_b32 s47, s30, 1
    s_lshl_b32 s47, s47, 3
    s_add_u32 s46, s46, s47
    s_mul_i32 s46, s46, 153600
    s_bfe_u32 s47, s30, 0x20003
    s_lshl_b32 s47, s47, 2
    s_add_u32 s47, s47, s22
    s_mul_i32 s47, s47, 3200
    s_add_u32 s46, s46, s47
    s_add_u32 s46, s46, 1048576
    v_lshlrev_b32 v26, 7, v0
    s_mov_b32 s49, 33554432
    ds_read_b128 v[160:163], v249
    ds_read_b64 v[164:165], v250 offset:1024
    ds_read_b128 v[168:171], v249 offset:1536
    ds_read_b64 v[172:173], v250 offset:2560
    s_cmp_eq_u32 s22, 3
    s_cbranch_scc0 L_p5_a
    s_mov_b64 exec, -1
    s_mov_b32 s36, 0
L_poll_32:
    buffer_load_dwordx2 v[4:5], v253, s[88:91], s44 offen sc1
    s_add_u32 s36, s36, 1
    s_cmp_gt_u32 s36, 2097152
    s_cbranch_scc1 L_abort
    s_waitcnt vmcnt(0)
    v_cmp_ne_u64 vcc, s[20:21], v[4:5]
    s_cbranch_vccnz L_poll_32
    s_mov_b64 exec, -1
L_p5_a:
    s_mov_b32 s59, 0
    s_mov_b32 s44, 0
    s_barrier
    buffer_load_dwordx4 a[0:3], v1, s[88:91], s40 offen sc1
    buffer_load_dwordx4 a[64:67], v1, s[88:91], s41 offen sc1
    buffer_load_dwordx4 a[4:7], v1, s[88:91], s40 offen offset:1024 sc1
    s_add_u32 s40, s40, 2048
    s_add_u32 s41, s41, 1024
    buffer_load_dwordx4 a[96:99], v1, s[88:91], s42 offen offset:0 sc1
    buffer_load_dwordx4 a[100:103], v1, s[88:91], s42 offen offset:1024 sc1
    buffer_load_dwordx4 a[104:107], v1, s[88:91], s42 offen offset:2048 sc1
    buffer_load_dwordx4 a[108:111], v1, s[88:91], s42 offen offset:3072 sc1
    s_add_u32 s42, s42, 4096
    buffer_load_dwordx4 a[8:11], v1, s[88:91], s40 offen sc1
    buffer_load_dwordx4 a[68:71], v1, s[88:91], s41 offen sc1
    buffer_load_dwordx4 a[12:15], v1, s[88:91], s40 offen offset:1024 sc1
    s_add_u32 s40, s40, 2048
    s_add_u32 s41, s41, 1024
    s_waitcnt vmcnt(8) lgkmcnt(0)
    v_mfma_f32_32x32x16_bf16 v[64:79], a[0:3], v[160:163], 0
    v_mfma_f32_32x32x8_bf16 v[64:79], a[64:65], v[164:165], v[64:79]
    v_mfma_f32_32x32x16_bf16 v[80:95], a[0:3], v[168:171], 0
    v_mfma_f32_32x32x8_bf16 v[80:95], a[64:65], v[172:173], v[80:95]
    buffer_load_dwordx4 a[112:115], v1, s[88:91], s42 offen offset:0 sc1
    buffer_load_dwordx4 a[116:119], v1, s[88:91], s42 offen offset:1024 sc1
    buffer_load_dwordx4 a[120:123], v1, s[88:91], s42 offen offset:2048 sc1
    buffer_load_dwordx4 a[124:127], v1, s[88:91], s42 offen offset:3072 sc1
    s_add_u32 s42, s42, 4096
    s_nop 4
    v_max3_f32 v8, v64, v65, v66
    v_max3_f32 v8, v8, v67, v68
    v_max3_f32 v8, v8, v69, v70
    v_max3_f32 v8, v8, v71, v72
    v_max3_f32 v8, v8, v73, v74
    v_max3_f32 v8, v8, v75, v76
    v_max3_f32 v8, v8, v77, v78
    v_max_f32 v8, v8, v79
    v_max3_f32 v9, v80, v81, v82
    v_max3_f32 v9, v9, v83, v84
    v_max3_f32 v9, v9, v85, v86
    v_max3_f32 v9, v9, v87, v88
    v_max3_f32 v9, v9, v89, v90
    v_max3_f32 v9, v9, v91, v92
    v_max3_f32 v9, v9, v93, v94
    v_max_f32 v9, v9, v95
    v_mov_b32 v10, v8
    v_mov_b32 v11, v9
    s_nop 0
    v_permlane32_swap_b32 v8, v10
    v_permlane32_swap_b32 v9, v11
    v_max_f32 v8, v8, v10
    v_max_f32 v9, v9, v11
    v_sub_f32 v8, 0xc1f00000, v8
    v_sub_f32 v9, 0xc1f00000, v9
    v_and_b32 v10, 0xffff0000, v8
    v_and_b32 v11, 0xffff0000, v9
    v_sub_f32 v8, v8, v10
    v_sub_f32 v9, v9, v11
    v_cvt_pk_bf16_f32 v8, v10, v8
    v_cvt_pk_bf16_f32 v9, v11, v9
    s_mov_b32 exec_lo, 0
    v_mov_b32 v164, v8
    v_mov_b32 v172, v9
    ds_write_b32 v250, v8 offset:1024
    ds_write_b32 v250, v9 offset:2560
    s_mov_b32 exec_lo, -1
L_att_start:
    v_mfma_f32_32x32x16_bf16 v[64:79], a[0:3], v[160:163], 0
    v_mfma_f32_32x32x8_bf16 v[64:79], a[64:65], v[164:165], v[64:79]
    v_mfma_f32_32x32x16_bf16 v[80:95], a[0:3], v[168:171], 0
    s_nop 10
    v_exp_f32 v96, v64
    v_exp_f32 v97, v65
    v_exp_f32 v98, v66
    v_exp_f32 v99, v67
    buffer_load_dwordx4 a[16:19], v1, s[88:91], s40 offen sc1
    v_mfma_f32_32x32x8_bf16 v[80:95], a[64:65], v[172:173], v[80:95]
    v_exp_f32 v100, v68
    v_cvt_pk_bf16_f32 v112, v96, v97
    v_exp_f32 v101, v69
    v_cvt_pk_bf16_f32 v113, v98, v99
    v_exp_f32 v102, v70
    v_exp_f32 v103, v71
    v_exp_f32 v104, v72
    v_cvt_pk_bf16_f32 v114, v100, v101
    v_exp_f32 v105, v73
    v_cvt_pk_bf16_f32 v115, v102, v103
    v_exp_f32 v106, v74
    v_exp_f32 v107, v75
    buffer_load_dwordx4 a[72:75], v1, s[88:91], s41 offen sc1
    s_waitcnt vmcnt(9)
    v_mfma_f32_32x32x16_bf16 v[128:143], a[96:99], v[112:115], 0
    v_exp_f32 v108, v76
    v_cvt_pk_bf16_f32 v116, v104, v105
    v_exp_f32 v109, v77
    v_cvt_pk_bf16_f32 v117, v106, v107
    v_exp_f32 v110, v78
    v_exp_f32 v111, v79
    v_mfma_f32_32x32x16_bf16 v[64:79], a[4:7], v[160:163], 0
    v_exp_f32 v96, v80
    v_cvt_pk_bf16_f32 v118, v108, v109
    v_exp_f32 v97, v81
    v_cvt_pk_bf16_f32 v119, v110, v111
    v_exp_f32 v98, v82
    v_exp_f32 v99, v83
    buffer_load_dwordx4 a[20:23], v1, s[88:91], s40 offen offset:1024 sc1
    s_add_u32 s40, s40, 2048
    s_add_u32 s41, s41, 1024
    v_mfma_f32_32x32x8_bf16 v[64:79], a[66:67], v[164:165], v[64:79]
    v_exp_f32 v100, v84
    v_cvt_pk_bf16_f32 v112, v96, v97
    v_exp_f32 v101, v85
    v_cvt_pk_bf16_f32 v113, v98, v99
    v_exp_f32 v102, v86
    v_exp_f32 v103, v87
    v_mfma_f32_32x32x16_bf16 v[128:143], a[100:103], v[116:119], v[128:143]
    v_exp_f32 v104, v88
    v_cvt_pk_bf16_f32 v114, v100, v101
    v_exp_f32 v105, v89
    v_cvt_pk_bf16_f32 v115, v102, v103
    v_exp_f32 v106, v90
    v_exp_f32 v107, v91
    buffer_load_dwordx4 a[128:131], v1, s[88:91], s42 offen offset:0 sc1
    v_mfma_f32_32x32x16_bf16 v[144:159], a[96:99], v[112:115], 0
    v_exp_f32 v108, v92
    v_cvt_pk_bf16_f32 v116, v104, v105
    v_exp_f32 v109, v93
    v_cvt_pk_bf16_f32 v117, v106, v107
    v_exp_f32 v110, v94
    v_exp_f32 v111, v95
    v_mfma_f32_32x32x16_bf16 v[80:95], a[4:7], v[168:171], 0
    v_exp_f32 v96, v64
    v_cvt_pk_bf16_f32 v118, v108, v109
    v_exp_f32 v97, v65
    v_cvt_pk_bf16_f32 v119, v110, v111
    v_exp_f32 v98, v66
    v_exp_f32 v99, v67
    buffer_load_dwordx4 a[132:135], v1, s[88:91], s42 offen offset:1024 sc1
    v_mfma_f32_32x32x8_bf16 v[80:95], a[66:67], v[172:173], v[80:95]
    v_exp_f32 v100, v68
    v_cvt_pk_bf16_f32 v112, v96, v97
    v_exp_f32 v101, v69
    v_cvt_pk_bf16_f32 v113, v98, v99
    v_exp_f32 v102, v70
    v_exp_f32 v103, v71
    v_mfma_f32_32x32x16_bf16 v[144:159], a[100:103], v[116:119], v[144:159]
    v_exp_f32 v104, v72
    v_cvt_pk_bf16_f32 v114, v100, v101
    v_exp_f32 v105, v73
    v_cvt_pk_bf16_f32 v115, v102, v103
    v_exp_f32 v106, v74
    v_exp_f32 v107, v75
    buffer_load_dwordx4 a[136:139], v1, s[88:91], s42 offen offset:2048 sc1
    v_mfma_f32_32x32x16_bf16 v[128:143], a[104:107], v[112:115], v[128:143]
    v_exp_f32 v108, v76
    v_cvt_pk_bf16_f32 v116, v104, v105
    v_exp_f32 v109, v77
    v_cvt_pk_bf16_f32 v117, v106, v107
    v_exp_f32 v110, v78
    v_exp_f32 v111, v79
    s_waitcnt vmcnt(10)
    v_mfma_f32_32x32x16_bf16 v[64:79], a[8:11], v[160:163], 0
    v_exp_f32 v96, v80
    v_cvt_pk_bf16_f32 v118, v108, v109
    v_exp_f32 v97, v81
    v_cvt_pk_bf16_f32 v119, v110, v111
    v_exp_f32 v98, v82
    v_exp_f32 v99, v83
    buffer_load_dwordx4 a[140:143], v1, s[88:91], s42 offen offset:3072 sc1
    s_add_u32 s42, s42, 4096
    v_mfma_f32_32x32x8_bf16 v[64:79], a[68:69], v[164:165], v[64:79]
    v_exp_f32 v100, v84
    v_cvt_pk_bf16_f32 v112, v96, v97
    v_exp_f32 v101, v85
    v_cvt_pk_bf16_f32 v113, v98, v99
    v_exp_f32 v102, v86
    v_exp_f32 v103, v87
    v_mfma_f32_32x32x16_bf16 v[128:143], a[108:111], v[116:119], v[128:143]
    v_exp_f32 v104, v88
    v_cvt_pk_bf16_f32 v114, v100, v101
    v_exp_f32 v105, v89
    v_cvt_pk_bf16_f32 v115, v102, v103
    v_exp_f32 v106, v90
    v_exp_f32 v107, v91
    v_mfma_f32_32x32x16_bf16 v[144:159], a[104:107], v[112:115], v[144:159]
    v_exp_f32 v108, v92
    v_cvt_pk_bf16_f32 v116, v104, v105
    v_exp_f32 v109, v93
    v_cvt_pk_bf16_f32 v117, v106, v107
    v_exp_f32 v110, v94
    v_exp_f32 v111, v95
    v_mfma_f32_32x32x16_bf16 v[80:95], a[8:11], v[168:171], 0
    v_exp_f32 v96, v64
    v_cvt_pk_bf16_f32 v118, v108, v109
    v_exp_f32 v97, v65
    v_cvt_pk_bf16_f32 v119, v110, v111
    v_exp_f32 v98, v66
    v_exp_f32 v99, v67
    v_mov_b32 v29, v30
    s_add_u32 s45, s45, 1
    s_and_b32 s45, s45, 3
    buffer_load_dwordx4 a[24:27], v1, s[88:91], s40 offen sc1
    v_mfma_f32_32x32x8_bf16 v[80:95], a[68:69], v[172:173], v[80:95]
    v_exp_f32 v100, v68
    v_cvt_pk_bf16_f32 v112, v96, v97
    v_exp_f32 v101, v69
    v_cvt_pk_bf16_f32 v113, v98, v99
    v_exp_f32 v102, v70
    v_exp_f32 v103, v71
    s_mul_i32 s47, s45, 6144
    s_add_u32 s47, s47, 102400
    v_add_u32 v30, s47, v1
    v_mfma_f32_32x32x16_bf16 v[144:159], a[108:111], v[116:119], v[144:159]
    v_exp_f32 v104, v72
    v_cvt_pk_bf16_f32 v114, v100, v101
    v_exp_f32 v105, v73
    v_cvt_pk_bf16_f32 v115, v102, v103
    v_exp_f32 v106, v74
    v_exp_f32 v107, v75
    s_mul_i32 s47, s45, 3072
    s_add_u32 s47, s47, 133120
    v_add_u32 v27, s47, v1
    v_add_u32 v28, s47, v32
    buffer_load_dwordx4 a[76:79], v1, s[88:91], s41 offen sc1
    s_waitcnt vmcnt(9)
    v_mfma_f32_32x32x16_bf16 v[128:143], a[112:115], v[112:115], v[128:143]
    v_exp_f32 v108, v76
    v_cvt_pk_bf16_f32 v116, v104, v105
    v_exp_f32 v109, v77
    v_cvt_pk_bf16_f32 v117, v106, v107
    v_exp_f32 v110, v78
    v_exp_f32 v111, v79
    v_mfma_f32_32x32x16_bf16 v[64:79], a[12:15], v[160:163], 0
    v_exp_f32 v96, v80
    v_cvt_pk_bf16_f32 v118, v108, v109
    v_exp_f32 v97, v81
    v_cvt_pk_bf16_f32 v119, v110, v111
    v_exp_f32 v98, v82
    v_exp_f32 v99, v83
    buffer_load_dwordx4 a[28:31], v1, s[88:91], s40 offen offset:1024 sc1
    s_add_u32 s40, s40, 2048
    s_add_u32 s41, s41, 1024
    v_mfma_f32_32x32x8_bf16 v[64:79], a[70:71], v[164:165], v[64:79]
    v_exp_f32 v100, v84
    v_cvt_pk_bf16_f32 v112, v96, v97
    v_exp_f32 v101, v85
    v_cvt_pk_bf16_f32 v113, v98, v99
    v_exp_f32 v102, v86
    v_exp_f32 v103, v87
    v_mfma_f32_32x32x16_bf16 v[128:143], a[116:119], v[116:119], v[128:143]
    v_exp_f32 v104, v88
    v_cvt_pk_bf16_f32 v114, v100, v101
    v_exp_f32 v105, v89
    v_cvt_pk_bf16_f32 v115, v102, v103
    v_exp_f32 v106, v90
    v_exp_f32 v107, v91
    buffer_load_dwordx4 a[144:147], v1, s[88:91], s42 offen offset:0 sc1
    v_mfma_f32_32x32x16_bf16 v[144:159], a[112:115], v[112:115], v[144:159]
    v_exp_f32 v108, v92
    v_cvt_pk_bf16_f32 v116, v104, v105
    v_exp_f32 v109, v93
    v_cvt_pk_bf16_f32 v117, v106, v107
    v_exp_f32 v110, v94
    v_exp_f32 v111, v95
    v_mfma_f32_32x32x16_bf16 v[80:95], a[12:15], v[168:171], 0
    v_exp_f32 v96, v64
    v_cvt_pk_bf16_f32 v118, v108, v109
    v_exp_f32 v97, v65
    v_cvt_pk_bf16_f32 v119, v110, v111
    v_exp_f32 v98, v66
    v_exp_f32 v99, v67
    buffer_load_dwordx4 a[148:151], v1, s[88:91], s42 offen offset:1024 sc1
    v_mfma_f32_32x32x8_bf16 v[80:95], a[70:71], v[172:173], v[80:95]
    v_exp_f32 v100, v68
    v_cvt_pk_bf16_f32 v112, v96, v97
    v_exp_f32 v101, v69
    v_cvt_pk_bf16_f32 v113, v98, v99
    v_exp_f32 v102, v70
    v_exp_f32 v103, v71
    v_mfma_f32_32x32x16_bf16 v[144:159], a[116:119], v[116:119], v[144:159]
    v_exp_f32 v104, v72
    v_cvt_pk_bf16_f32 v114, v100, v101
    v_exp_f32 v105, v73
    v_cvt_pk_bf16_f32 v115, v102, v103
    v_exp_f32 v106, v74
    v_exp_f32 v107, v75
    buffer_load_dwordx4 a[152:155], v1, s[88:91], s42 offen offset:2048 sc1
    v_mfma_f32_32x32x16_bf16 v[128:143], a[120:123], v[112:115], v[128:143]
    v_exp_f32 v108, v76
    v_cvt_pk_bf16_f32 v116, v104, v105
    v_exp_f32 v109, v77
    v_cvt_pk_bf16_f32 v117, v106, v107
    v_exp_f32 v110, v78
    v_exp_f32 v111, v79
    s_waitcnt vmcnt(10)
    v_mfma_f32_32x32x16_bf16 v[64:79], a[16:19], v[160:163], 0
    v_exp_f32 v96, v80
    v_cvt_pk_bf16_f32 v118, v108, v109
    v_exp_f32 v97, v81
    v_cvt_pk_bf16_f32 v119, v110, v111
    v_exp_f32 v98, v82
    v_exp_f32 v99, v83
    buffer_load_dwordx4 a[156:159], v1, s[88:91], s42 offen offset:3072 sc1
    s_add_u32 s42, s42, 4096
    v_mfma_f32_32x32x8_bf16 v[64:79], a[72:73], v[164:165], v[64:79]
    v_exp_f32 v100, v84
    v_cvt_pk_bf16_f32 v112, v96, v97
    v_exp_f32 v101, v85
    v_cvt_pk_bf16_f32 v113, v98, v99
    v_exp_f32 v102, v86
    v_exp_f32 v103, v87
    v_mfma_f32_32x32x16_bf16 v[128:143], a[124:127], v[116:119], v[128:143]
    v_exp_f32 v104, v88
    v_cvt_pk_bf16_f32 v114, v100, v101
    v_exp_f32 v105, v89
    v_cvt_pk_bf16_f32 v115, v102, v103
    v_exp_f32 v106, v90
    v_exp_f32 v107, v91
    v_mfma_f32_32x32x16_bf16 v[144:159], a[120:123], v[112:115], v[144:159]
    v_exp_f32 v108, v92
    v_cvt_pk_bf16_f32 v116, v104, v105
    v_exp_f32 v109, v93
    v_cvt_pk_bf16_f32 v117, v106, v107
    v_exp_f32 v110, v94
    v_exp_f32 v111, v95
    v_mfma_f32_32x32x16_bf16 v[80:95], a[16:19], v[168:171], 0
    v_exp_f32 v96, v64
    v_cvt_pk_bf16_f32 v118, v108, v109
    v_exp_f32 v97, v65
    v_cvt_pk_bf16_f32 v119, v110, v111
    v_exp_f32 v98, v66
    v_exp_f32 v99, v67
    buffer_load_dwordx4 a[32:35], v1, s[88:91], s40 offen sc1
    v_mfma_f32_32x32x8_bf16 v[80:95], a[72:73], v[172:173], v[80:95]
    v_exp_f32 v100, v68
    v_cvt_pk_bf16_f32 v112, v96, v97
    v_exp_f32 v101, v69
    v_cvt_pk_bf16_f32 v113, v98, v99
    v_exp_f32 v102, v70
    v_exp_f32 v103, v71
    v_mfma_f32_32x32x16_bf16 v[144:159], a[124:127], v[116:119], v[144:159]
    v_exp_f32 v104, v72
    v_cvt_pk_bf16_f32 v114, v100, v101
    v_exp_f32 v105, v73
    v_cvt_pk_bf16_f32 v115, v102, v103
    v_exp_f32 v106, v74
    v_exp_f32 v107, v75
    buffer_load_dwordx4 a[80:83], v1, s[88:91], s41 offen sc1
    s_waitcnt vmcnt(9)
    v_mfma_f32_32x32x16_bf16 v[128:143], a[128:131], v[112:115], v[128:143]
    v_exp_f32 v108, v76
    v_cvt_pk_bf16_f32 v116, v104, v105
    v_exp_f32 v109, v77
    v_cvt_pk_bf16_f32 v117, v106, v107
    v_exp_f32 v110, v78
    v_exp_f32 v111, v79
    v_mfma_f32_32x32x16_bf16 v[64:79], a[20:23], v[160:163], 0
    v_exp_f32 v96, v80
    v_cvt_pk_bf16_f32 v118, v108, v109
    v_exp_f32 v97, v81
    v_cvt_pk_bf16_f32 v119, v110, v111
    v_exp_f32 v98, v82
    v_exp_f32 v99, v83
    buffer_load_dwordx4 a[36:39], v1, s[88:91], s40 offen offset:1024 sc1
    s_add_u32 s40, s40, 2048
    s_add_u32 s41, s41, 1024
    v_mfma_f32_32x32x8_bf16 v[64:79], a[74:75], v[164:165], v[64:79]
    v_exp_f32 v100, v84
    v_cvt_pk_bf16_f32 v112, v96, v97
    v_exp_f32 v101, v85
    v_cvt_pk_bf16_f32 v113, v98, v99
    v_exp_f32 v102, v86
    v_exp_f32 v103, v87
    v_mfma_f32_32x32x16_bf16 v[128:143], a[132:135], v[116:119], v[128:143]
    v_exp_f32 v104, v88
    v_cvt_pk_bf16_f32 v114, v100, v101
    v_exp_f32 v105, v89
    v_cvt_pk_bf16_f32 v115, v102, v103
    v_exp_f32 v106, v90
    v_exp_f32 v107, v91
    buffer_load_dwordx4 a[160:163], v1, s[88:91], s42 offen offset:0 sc1
    v_mfma_f32_32x32x16_bf16 v[144:159], a[128:131], v[112:115], v[144:159]
    v_exp_f32 v108, v92
    v_cvt_pk_bf16_f32 v116, v104, v105
    v_exp_f32 v109, v93
    v_cvt_pk_bf16_f32 v117, v106, v107
    v_exp_f32 v110, v94
    v_exp_f32 v111, v95
    v_mfma_f32_32x32x16_bf16 v[80:95], a[20:23], v[168:171], 0
    v_exp_f32 v96, v64
    v_cvt_pk_bf16_f32 v118, v108, v109
    v_exp_f32 v97, v65
    v_cvt_pk_bf16_f32 v119, v110, v111
    v_exp_f32 v98, v66
    v_exp_f32 v99, v67
    buffer_load_dwordx4 a[164:167], v1, s[88:91], s42 offen offset:1024 sc1
    v_mfma_f32_32x32x8_bf16 v[80:95], a[74:75], v[172:173], v[80:95]
    v_exp_f32 v100, v68
    v_cvt_pk_bf16_f32 v112, v96, v97
    v_exp_f32 v101, v69
    v_cvt_pk_bf16_f32 v113, v98, v99
    v_exp_f32 v102, v70
    v_exp_f32 v103, v71
    v_mfma_f32_32x32x16_bf16 v[144:159], a[132:135], v[116:119], v[144:159]
    v_exp_f32 v104, v72
    v_cvt_pk_bf16_f32 v114, v100, v101
    v_exp_f32 v105, v73
    v_cvt_pk_bf16_f32 v115, v102, v103
    v_exp_f32 v106, v74
    v_exp_f32 v107, v75
    buffer_load_dwordx4 a[168:171], v1, s[88:91], s42 offen offset:2048 sc1
    v_mfma_f32_32x32x16_bf16 v[128:143], a[136:139], v[112:115], v[128:143]
    v_exp_f32 v108, v76
    v_cvt_pk_bf16_f32 v116, v104, v105
    v_exp_f32 v109, v77
    v_cvt_pk_bf16_f32 v117, v106, v107
    v_exp_f32 v110, v78
    v_exp_f32 v111, v79
    s_waitcnt vmcnt(10)
    v_mfma_f32_32x32x16_bf16 v[64:79], a[24:27], v[160:163], 0
    v_exp_f32 v96, v80
    v_cvt_pk_bf16_f32 v118, v108, v109
    v_exp_f32 v97, v81
    v_cvt_pk_bf16_f32 v119, v110, v111
    v_exp_f32 v98, v82
    v_exp_f32 v99, v83
    buffer_load_dwordx4 a[172:175], v1, s[88:91], s42 offen offset:3072 sc1
    s_add_u32 s42, s42, 4096
    v_mfma_f32_32x32x8_bf16 v[64:79], a[76:77], v[164:165], v[64:79]
    v_exp_f32 v100, v84
    v_cvt_pk_bf16_f32 v112, v96, v97
    v_exp_f32 v101, v85
    v_cvt_pk_bf16_f32 v113, v98, v99
    v_exp_f32 v102, v86
    v_exp_f32 v103, v87
    v_mfma_f32_32x32x16_bf16 v[128:143], a[140:143], v[116:119], v[128:143]
    v_exp_f32 v104, v88
    v_cvt_pk_bf16_f32 v114, v100, v101
    v_exp_f32 v105, v89
    v_cvt_pk_bf16_f32 v115, v102, v103
    v_exp_f32 v106, v90
    v_exp_f32 v107, v91
    v_mfma_f32_32x32x16_bf16 v[144:159], a[136:139], v[112:115], v[144:159]
    v_exp_f32 v108, v92
    v_cvt_pk_bf16_f32 v116, v104, v105
    v_exp_f32 v109, v93
    v_cvt_pk_bf16_f32 v117, v106, v107
    v_exp_f32 v110, v94
    v_exp_f32 v111, v95
    v_mfma_f32_32x32x16_bf16 v[80:95], a[24:27], v[168:171], 0
    v_exp_f32 v96, v64
    v_cvt_pk_bf16_f32 v118, v108, v109
    v_exp_f32 v97, v65
    v_cvt_pk_bf16_f32 v119, v110, v111
    v_exp_f32 v98, v66
    v_exp_f32 v99, v67
    buffer_load_dwordx4 a[40:43], v1, s[88:91], s40 offen sc1
    v_mfma_f32_32x32x8_bf16 v[80:95], a[76:77], v[172:173], v[80:95]
    v_exp_f32 v100, v68
    v_cvt_pk_bf16_f32 v112, v96, v97
    v_exp_f32 v101, v69
    v_cvt_pk_bf16_f32 v113, v98, v99
    v_exp_f32 v102, v70
    v_exp_f32 v103, v71
    v_mfma_f32_32x32x16_bf16 v[144:159], a[140:143], v[116:119], v[144:159]
    v_exp_f32 v104, v72
    v_cvt_pk_bf16_f32 v114, v100, v101
    v_exp_f32 v105, v73
    v_cvt_pk_bf16_f32 v115, v102, v103
    v_exp_f32 v106, v74
    v_exp_f32 v107, v75
    buffer_load_dwordx4 a[84:87], v1, s[88:91], s41 offen sc1
    s_waitcnt vmcnt(9)
    v_mfma_f32_32x32x16_bf16 v[128:143], a[144:147], v[112:115], v[128:143]
    v_exp_f32 v108, v76
    v_cvt_pk_bf16_f32 v116, v104, v105
    v_exp_f32 v109, v77
    v_cvt_pk_bf16_f32 v117, v106, v107
    v_exp_f32 v110, v78
    v_exp_f32 v111, v79
    s_waitcnt lgkmcnt(0)
    s_barrier
    v_mfma_f32_32x32x16_bf16 v[64:79], a[28:31], v[160:163], 0
    v_exp_f32 v96, v80
    v_cvt_pk_bf16_f32 v118, v108, v109
    v_exp_f32 v97, v81
    v_cvt_pk_bf16_f32 v119, v110, v111
    v_exp_f32 v98, v82
    v_exp_f32 v99, v83
    buffer_load_dwordx4 a[44:47], v1, s[88:91], s40 offen offset:1024 sc1
    s_add_u32 s40, s40, 2048
    s_add_u32 s41, s41, 1024
    v_mfma_f32_32x32x8_bf16 v[64:79], a[78:79], v[164:165], v[64:79]
    v_exp_f32 v100, v84
    v_cvt_pk_bf16_f32 v112, v96, v97
    v_exp_f32 v101, v85
    v_cvt_pk_bf16_f32 v113, v98, v99
    v_exp_f32 v102, v86
    v_exp_f32 v103, v87
    v_mfma_f32_32x32x16_bf16 v[128:143], a[148:151], v[116:119], v[128:143]
    v_exp_f32 v104, v88
    v_cvt_pk_bf16_f32 v114, v100, v101
    v_exp_f32 v105, v89
    v_cvt_pk_bf16_f32 v115, v102, v103
    v_exp_f32 v106, v90
    v_exp_f32 v107, v91
    buffer_load_dwordx4 a[176:179], v1, s[88:91], s42 offen offset:0 sc1
    v_mfma_f32_32x32x16_bf16 v[144:159], a[144:147], v[112:115], v[144:159]
    v_exp_f32 v108, v92
    v_cvt_pk_bf16_f32 v116, v104, v105
    v_exp_f32 v109, v93
    v_cvt_pk_bf16_f32 v117, v106, v107
    v_exp_f32 v110, v94
    v_exp_f32 v111, v95
    v_mfma_f32_32x32x16_bf16 v[80:95], a[28:31], v[168:171], 0
    v_exp_f32 v96, v64
    v_cvt_pk_bf16_f32 v118, v108, v109
    v_exp_f32 v97, v65
    v_cvt_pk_bf16_f32 v119, v110, v111
    v_exp_f32 v98, v66
    v_exp_f32 v99, v67
    buffer_load_dwordx4 a[180:183], v1, s[88:91], s42 offen offset:1024 sc1
    v_mfma_f32_32x32x8_bf16 v[80:95], a[78:79], v[172:173], v[80:95]
    v_exp_f32 v100, v68
    v_cvt_pk_bf16_f32 v112, v96, v97
    v_exp_f32 v101, v69
    v_cvt_pk_bf16_f32 v113, v98, v99
    v_exp_f32 v102, v70
    v_exp_f32 v103, v71
    v_mfma_f32_32x32x16_bf16 v[144:159], a[148:151], v[116:119], v[144:159]
    v_exp_f32 v104, v72
    v_cvt_pk_bf16_f32 v114, v100, v101
    v_exp_f32 v105, v73
    v_cvt_pk_bf16_f32 v115, v102, v103
    v_exp_f32 v106, v74
    v_exp_f32 v107, v75
    buffer_load_dwordx4 a[184:187], v1, s[88:91], s42 offen offset:2048 sc1
    v_mfma_f32_32x32x16_bf16 v[128:143], a[152:155], v[112:115], v[128:143]
    v_exp_f32 v108, v76
    v_cvt_pk_bf16_f32 v116, v104, v105
    v_exp_f32 v109, v77
    v_cvt_pk_bf16_f32 v117, v106, v107
    v_exp_f32 v110, v78
    v_exp_f32 v111, v79
    s_waitcnt vmcnt(10)
    v_mfma_f32_32x32x16_bf16 v[64:79], a[32:35], v[160:163], 0
    v_exp_f32 v96, v80
    v_cvt_pk_bf16_f32 v118, v108, v109
    v_exp_f32 v97, v81
    v_cvt_pk_bf16_f32 v119, v110, v111
    v_exp_f32 v98, v82
    v_exp_f32 v99, v83
    buffer_load_dwordx4 a[188:191], v1, s[88:91], s42 offen offset:3072 sc1
    s_add_u32 s42, s42, 4096
    v_mfma_f32_32x32x8_bf16 v[64:79], a[80:81], v[164:165], v[64:79]
    v_exp_f32 v100, v84
    v_cvt_pk_bf16_f32 v112, v96, v97
    v_exp_f32 v101, v85
    v_cvt_pk_bf16_f32 v113, v98, v99
    v_exp_f32 v102, v86
    v_exp_f32 v103, v87
    v_mfma_f32_32x32x16_bf16 v[128:143], a[156:159], v[116:119], v[128:143]
    v_exp_f32 v104, v88
    v_cvt_pk_bf16_f32 v114, v100, v101
    v_exp_f32 v105, v89
    v_cvt_pk_bf16_f32 v115, v102, v103
    v_exp_f32 v106, v90
    v_exp_f32 v107, v91
    v_mfma_f32_32x32x16_bf16 v[144:159], a[152:155], v[112:115], v[144:159]
    v_exp_f32 v108, v92
    v_cvt_pk_bf16_f32 v116, v104, v105
    v_exp_f32 v109, v93
    v_cvt_pk_bf16_f32 v117, v106, v107
    v_exp_f32 v110, v94
    v_exp_f32 v111, v95
    v_mfma_f32_32x32x16_bf16 v[80:95], a[32:35], v[168:171], 0
    v_exp_f32 v96, v64
    v_cvt_pk_bf16_f32 v118, v108, v109
    v_exp_f32 v97, v65
    v_cvt_pk_bf16_f32 v119, v110, v111
    v_exp_f32 v98, v66
    v_exp_f32 v99, v67
    buffer_load_dwordx4 a[48:51], v1, s[88:91], s40 offen sc1
    v_mfma_f32_32x32x8_bf16 v[80:95], a[80:81], v[172:173], v[80:95]
    v_exp_f32 v100, v68
    v_cvt_pk_bf16_f32 v112, v96, v97
    v_exp_f32 v101, v69
    v_cvt_pk_bf16_f32 v113, v98, v99
    v_exp_f32 v102, v70
    v_exp_f32 v103, v71
    v_mfma_f32_32x32x16_bf16 v[144:159], a[156:159], v[116:119], v[144:159]
    v_exp_f32 v104, v72
    v_cvt_pk_bf16_f32 v114, v100, v101
    v_exp_f32 v105, v73
    v_cvt_pk_bf16_f32 v115, v102, v103
    v_exp_f32 v106, v74
    v_exp_f32 v107, v75
    buffer_load_dwordx4 a[88:91], v1, s[88:91], s41 offen sc1
    s_waitcnt vmcnt(9)
    v_mfma_f32_32x32x16_bf16 v[128:143], a[160:163], v[112:115], v[128:143]
    v_exp_f32 v108, v76
    v_cvt_pk_bf16_f32 v116, v104, v105
    v_exp_f32 v109, v77
    v_cvt_pk_bf16_f32 v117, v106, v107
    v_exp_f32 v110, v78
    v_exp_f32 v111, v79
    v_mfma_f32_32x32x16_bf16 v[64:79], a[36:39], v[160:163], 0
    v_exp_f32 v96, v80
    v_cvt_pk_bf16_f32 v118, v108, v109
    v_exp_f32 v97, v81
    v_cvt_pk_bf16_f32 v119, v110, v111
    v_exp_f32 v98, v82
    v_exp_f32 v99, v83
    buffer_load_dwordx4 a[52:55], v1, s[88:91], s40 offen offset:1024 sc1
    s_add_u32 s40, s40, 2048
    s_add_u32 s41, s41, 1024
    v_mfma_f32_32x32x8_bf16 v[64:79], a[82:83], v[164:165], v[64:79]
    v_exp_f32 v100, v84
    v_cvt_pk_bf16_f32 v112, v96, v97
    v_exp_f32 v101, v85
    v_cvt_pk_bf16_f32 v113, v98, v99
    v_exp_f32 v102, v86
    v_exp_f32 v103, v87
    v_mfma_f32_32x32x16_bf16 v[128:143], a[164:167], v[116:119], v[128:143]
    v_exp_f32 v104, v88
    v_cvt_pk_bf16_f32 v114, v100, v101
    v_exp_f32 v105, v89
    v_cvt_pk_bf16_f32 v115, v102, v103
    v_exp_f32 v106, v90
    v_exp_f32 v107, v91
    buffer_load_dwordx4 a[192:195], v1, s[88:91], s42 offen offset:0 sc1
    v_mfma_f32_32x32x16_bf16 v[144:159], a[160:163], v[112:115], v[144:159]
    v_exp_f32 v108, v92
    v_cvt_pk_bf16_f32 v116, v104, v105
    v_exp_f32 v109, v93
    v_cvt_pk_bf16_f32 v117, v106, v107
    v_exp_f32 v110, v94
    v_exp_f32 v111, v95
    v_mfma_f32_32x32x16_bf16 v[80:95], a[36:39], v[168:171], 0
    v_exp_f32 v96, v64
    v_cvt_pk_bf16_f32 v118, v108, v109
    v_exp_f32 v97, v65
    v_cvt_pk_bf16_f32 v119, v110, v111
    v_exp_f32 v98, v66
    v_exp_f32 v99, v67
    buffer_load_dwordx4 a[196:199], v1, s[88:91], s42 offen offset:1024 sc1
    v_mfma_f32_32x32x8_bf16 v[80:95], a[82:83], v[172:173], v[80:95]
    v_exp_f32 v100, v68
    v_cvt_pk_bf16_f32 v112, v96, v97
    v_exp_f32 v101, v69
    v_cvt_pk_bf16_f32 v113, v98, v99
    v_exp_f32 v102, v70
    v_exp_f32 v103, v71
    v_mfma_f32_32x32x16_bf16 v[144:159], a[164:167], v[116:119], v[144:159]
    v_exp_f32 v104, v72
    v_cvt_pk_bf16_f32 v114, v100, v101
    v_exp_f32 v105, v73
    v_cvt_pk_bf16_f32 v115, v102, v103
    v_exp_f32 v106, v74
    v_exp_f32 v107, v75
    buffer_load_dwordx4 a[200:203], v1, s[88:91], s42 offen offset:2048 sc1
    v_mfma_f32_32x32x16_bf16 v[128:143], a[168:171], v[112:115], v[128:143]
    v_exp_f32 v108, v76
    v_cvt_pk_bf16_f32 v116, v104, v105
    v_exp_f32 v109, v77
    v_cvt_pk_bf16_f32 v117, v106, v107
    v_exp_f32 v110, v78
    v_exp_f32 v111, v79
    s_waitcnt vmcnt(10)
    v_mfma_f32_32x32x16_bf16 v[64:79], a[40:43], v[160:163], 0
    v_exp_f32 v96, v80
    v_cvt_pk_bf16_f32 v118, v108, v109
    v_exp_f32 v97, v81
    v_cvt_pk_bf16_f32 v119, v110, v111
    v_exp_f32 v98, v82
    v_exp_f32 v99, v83
    buffer_load_dwordx4 a[204:207], v1, s[88:91], s42 offen offset:3072 sc1
    s_add_u32 s42, s42, 4096
    v_mfma_f32_32x32x8_bf16 v[64:79], a[84:85], v[164:165], v[64:79]
    v_exp_f32 v100, v84
    v_cvt_pk_bf16_f32 v112, v96, v97
    v_exp_f32 v101, v85
    v_cvt_pk_bf16_f32 v113, v98, v99
    v_exp_f32 v102, v86
    v_exp_f32 v103, v87
    v_mfma_f32_32x32x16_bf16 v[128:143], a[172:175], v[116:119], v[128:143]
    v_exp_f32 v104, v88
    v_cvt_pk_bf16_f32 v114, v100, v101
    v_exp_f32 v105, v89
    v_cvt_pk_bf16_f32 v115, v102, v103
    v_exp_f32 v106, v90
    v_exp_f32 v107, v91
    v_mfma_f32_32x32x16_bf16 v[144:159], a[168:171], v[112:115], v[144:159]
    v_exp_f32 v108, v92
    v_cvt_pk_bf16_f32 v116, v104, v105
    v_exp_f32 v109, v93
    v_cvt_pk_bf16_f32 v117, v106, v107
    v_exp_f32 v110, v94
    v_exp_f32 v111, v95
    v_mfma_f32_32x32x16_bf16 v[80:95], a[40:43], v[168:171], 0
    v_exp_f32 v96, v64
    v_cvt_pk_bf16_f32 v118, v108, v109
    v_exp_f32 v97, v65
    v_cvt_pk_bf16_f32 v119, v110, v111
    v_exp_f32 v98, v66
    v_exp_f32 v99, v67
    buffer_load_dwordx4 a[56:59], v1, s[88:91], s40 offen sc1
    v_mfma_f32_32x32x8_bf16 v[80:95], a[84:85], v[172:173], v[80:95]
    v_exp_f32 v100, v68
    v_cvt_pk_bf16_f32 v112, v96, v97
    v_exp_f32 v101, v69
    v_cvt_pk_bf16_f32 v113, v98, v99
    v_exp_f32 v102, v70
    v_exp_f32 v103, v71
    v_mfma_f32_32x32x16_bf16 v[144:159], a[172:175], v[116:119], v[144:159]
    v_exp_f32 v104, v72
    v_cvt_pk_bf16_f32 v114, v100, v101
    v_exp_f32 v105, v73
    v_cvt_pk_bf16_f32 v115, v102, v103
    v_exp_f32 v106, v74
    v_exp_f32 v107, v75
    buffer_load_dwordx4 a[92:95], v1, s[88:91], s41 offen sc1
    s_waitcnt vmcnt(9)
    v_mfma_f32_32x32x16_bf16 v[128:143], a[176:179], v[112:115], v[128:143]
    v_exp_f32 v108, v76
    v_cvt_pk_bf16_f32 v116, v104, v105
    v_exp_f32 v109, v77
    v_cvt_pk_bf16_f32 v117, v106, v107
    v_exp_f32 v110, v78
    v_exp_f32 v111, v79
    v_mfma_f32_32x32x16_bf16 v[64:79], a[44:47], v[160:163], 0
    v_exp_f32 v96, v80
    v_cvt_pk_bf16_f32 v118, v108, v109
    v_exp_f32 v97, v81
    v_cvt_pk_bf16_f32 v119, v110, v111
    v_exp_f32 v98, v82
    v_exp_f32 v99, v83
    buffer_load_dwordx4 a[60:63], v1, s[88:91], s40 offen offset:1024 sc1
    s_add_u32 s40, s40, 2048
    s_add_u32 s41, s41, 1024
    v_mfma_f32_32x32x8_bf16 v[64:79], a[86:87], v[164:165], v[64:79]
    v_exp_f32 v100, v84
    v_cvt_pk_bf16_f32 v112, v96, v97
    v_exp_f32 v101, v85
    v_cvt_pk_bf16_f32 v113, v98, v99
    v_exp_f32 v102, v86
    v_exp_f32 v103, v87
    v_mfma_f32_32x32x16_bf16 v[128:143], a[180:183], v[116:119], v[128:143]
    v_exp_f32 v104, v88
    v_cvt_pk_bf16_f32 v114, v100, v101
    v_exp_f32 v105, v89
    v_cvt_pk_bf16_f32 v115, v102, v103
    v_exp_f32 v106, v90
    v_exp_f32 v107, v91
    buffer_load_dwordx4 a[208:211], v1, s[88:91], s42 offen offset:0 sc1
    v_mfma_f32_32x32x16_bf16 v[144:159], a[176:179], v[112:115], v[144:159]
    v_exp_f32 v108, v92
    v_cvt_pk_bf16_f32 v116, v104, v105
    v_exp_f32 v109, v93
    v_cvt_pk_bf16_f32 v117, v106, v107
    v_exp_f32 v110, v94
    v_exp_f32 v111, v95
    v_mfma_f32_32x32x16_bf16 v[80:95], a[44:47], v[168:171], 0
    v_exp_f32 v96, v64
    v_cvt_pk_bf16_f32 v118, v108, v109
    v_exp_f32 v97, v65
    v_cvt_pk_bf16_f32 v119, v110, v111
    v_exp_f32 v98, v66
    v_exp_f32 v99, v67
    buffer_load_dwordx4 a[212:215], v1, s[88:91], s42 offen offset:1024 sc1
    v_mfma_f32_32x32x8_bf16 v[80:95], a[86:87], v[172:173], v[80:95]
    v_exp_f32 v100, v68
    v_cvt_pk_bf16_f32 v112, v96, v97
    v_exp_f32 v101, v69
    v_cvt_pk_bf16_f32 v113, v98, v99
    v_exp_f32 v102, v70
    v_exp_f32 v103, v71
    v_mfma_f32_32x32x16_bf16 v[144:159], a[180:183], v[116:119], v[144:159]
    v_exp_f32 v104, v72
    v_cvt_pk_bf16_f32 v114, v100, v101
    v_exp_f32 v105, v73
    v_cvt_pk_bf16_f32 v115, v102, v103
    v_exp_f32 v106, v74
    v_exp_f32 v107, v75
    buffer_load_dwordx4 a[216:219], v1, s[88:91], s42 offen offset:2048 sc1
    v_mfma_f32_32x32x16_bf16 v[128:143], a[184:187], v[112:115], v[128:143]
    v_exp_f32 v108, v76
    v_cvt_pk_bf16_f32 v116, v104, v105
    v_exp_f32 v109, v77
    v_cvt_pk_bf16_f32 v117, v106, v107
    v_exp_f32 v110, v78
    v_exp_f32 v111, v79
    s_waitcnt vmcnt(10)
    v_mfma_f32_32x32x16_bf16 v[64:79], a[48:51], v[160:163], 0
    v_exp_f32 v96, v80
    v_cvt_pk_bf16_f32 v118, v108, v109
    v_exp_f32 v97, v81
    v_cvt_pk_bf16_f32 v119, v110, v111
    v_exp_f32 v98, v82
    v_exp_f32 v99, v83
    buffer_load_dwordx4 a[220:223], v1, s[88:91], s42 offen offset:3072 sc1
    s_add_u32 s42, s42, 4096
    v_mfma_f32_32x32x8_bf16 v[64:79], a[88:89], v[164:165], v[64:79]
    v_exp_f32 v100, v84
    v_cvt_pk_bf16_f32 v112, v96, v97
    v_exp_f32 v101, v85
    v_cvt_pk_bf16_f32 v113, v98, v99
    v_exp_f32 v102, v86
    v_exp_f32 v103, v87
    v_mfma_f32_32x32x16_bf16 v[128:143], a[188:191], v[116:119], v[128:143]
    v_exp_f32 v104, v88
    v_cvt_pk_bf16_f32 v114, v100, v101
    v_exp_f32 v105, v89
    v_cvt_pk_bf16_f32 v115, v102, v103
    v_exp_f32 v106, v90
    v_exp_f32 v107, v91
    v_mfma_f32_32x32x16_bf16 v[144:159], a[184:187], v[112:115], v[144:159]
    v_exp_f32 v108, v92
    v_cvt_pk_bf16_f32 v116, v104, v105
    v_exp_f32 v109, v93
    v_cvt_pk_bf16_f32 v117, v106, v107
    v_exp_f32 v110, v94
    v_exp_f32 v111, v95
    v_mfma_f32_32x32x16_bf16 v[80:95], a[48:51], v[168:171], 0
    v_exp_f32 v96, v64
    v_cvt_pk_bf16_f32 v118, v108, v109
    v_exp_f32 v97, v65
    v_cvt_pk_bf16_f32 v119, v110, v111
    v_exp_f32 v98, v66
    v_exp_f32 v99, v67
    v_mfma_f32_32x32x8_bf16 v[80:95], a[88:89], v[172:173], v[80:95]
    v_exp_f32 v100, v68
    v_cvt_pk_bf16_f32 v112, v96, v97
    v_exp_f32 v101, v69
    v_cvt_pk_bf16_f32 v113, v98, v99
    v_exp_f32 v102, v70
    v_exp_f32 v103, v71
    v_mfma_f32_32x32x16_bf16 v[144:159], a[188:191], v[116:119], v[144:159]
    v_exp_f32 v104, v72
    v_cvt_pk_bf16_f32 v114, v100, v101
    v_exp_f32 v105, v73
    v_cvt_pk_bf16_f32 v115, v102, v103
    v_exp_f32 v106, v74
    v_exp_f32 v107, v75
    s_waitcnt vmcnt(7)
    v_mfma_f32_32x32x16_bf16 v[128:143], a[192:195], v[112:115], v[128:143]
    v_exp_f32 v108, v76
    v_cvt_pk_bf16_f32 v116, v104, v105
    v_exp_f32 v109, v77
    v_cvt_pk_bf16_f32 v117, v106, v107
    v_exp_f32 v110, v78
    v_exp_f32 v111, v79
    v_mfma_f32_32x32x16_bf16 v[64:79], a[52:55], v[160:163], 0
    v_exp_f32 v96, v80
    v_cvt_pk_bf16_f32 v118, v108, v109
    v_exp_f32 v97, v81
    v_cvt_pk_bf16_f32 v119, v110, v111
    v_exp_f32 v98, v82
    v_exp_f32 v99, v83
    v_mfma_f32_32x32x8_bf16 v[64:79], a[90:91], v[164:165], v[64:79]
    v_exp_f32 v100, v84
    v_cvt_pk_bf16_f32 v112, v96, v97
    v_exp_f32 v101, v85
    v_cvt_pk_bf16_f32 v113, v98, v99
    v_exp_f32 v102, v86
    v_exp_f32 v103, v87
    v_mfma_f32_32x32x16_bf16 v[128:143], a[196:199], v[116:119], v[128:143]
    v_exp_f32 v104, v88
    v_cvt_pk_bf16_f32 v114, v100, v101
    v_exp_f32 v105, v89
    v_cvt_pk_bf16_f32 v115, v102, v103
    v_exp_f32 v106, v90
    v_exp_f32 v107, v91
    v_mfma_f32_32x32x16_bf16 v[144:159], a[192:195], v[112:115], v[144:159]
    v_exp_f32 v108, v92
    v_cvt_pk_bf16_f32 v116, v104, v105
    v_exp_f32 v109, v93
    v_cvt_pk_bf16_f32 v117, v106, v107
    v_exp_f32 v110, v94
    v_exp_f32 v111, v95
    v_mfma_f32_32x32x16_bf16 v[80:95], a[52:55], v[168:171], 0
    v_exp_f32 v96, v64
    v_cvt_pk_bf16_f32 v118, v108, v109
    v_exp_f32 v97, v65
    v_cvt_pk_bf16_f32 v119, v110, v111
    v_exp_f32 v98, v66
    v_exp_f32 v99, v67
    v_mfma_f32_32x32x8_bf16 v[80:95], a[90:91], v[172:173], v[80:95]
    v_exp_f32 v100, v68
    v_cvt_pk_bf16_f32 v112, v96, v97
    v_exp_f32 v101, v69
    v_cvt_pk_bf16_f32 v113, v98, v99
    v_exp_f32 v102, v70
    v_exp_f32 v103, v71
    v_mfma_f32_32x32x16_bf16 v[144:159], a[196:199], v[116:119], v[144:159]
    v_exp_f32 v104, v72
    v_cvt_pk_bf16_f32 v114, v100, v101
    v_exp_f32 v105, v73
    v_cvt_pk_bf16_f32 v115, v102, v103
    v_exp_f32 v106, v74
    v_exp_f32 v107, v75
    v_mfma_f32_32x32x16_bf16 v[128:143], a[200:203], v[112:115], v[128:143]
    v_exp_f32 v108, v76
    v_cvt_pk_bf16_f32 v116, v104, v105
    v_exp_f32 v109, v77
    v_cvt_pk_bf16_f32 v117, v106, v107
    v_exp_f32 v110, v78
    v_exp_f32 v111, v79
    s_waitcnt vmcnt(4)
    v_mfma_f32_32x32x16_bf16 v[64:79], a[56:59], v[160:163], 0
    v_exp_f32 v96, v80
    v_cvt_pk_bf16_f32 v118, v108, v109
    v_exp_f32 v97, v81
    v_cvt_pk_bf16_f32 v119, v110, v111
    v_exp_f32 v98, v82
    v_exp_f32 v99, v83
    v_mfma_f32_32x32x8_bf16 v[64:79], a[92:93], v[164:165], v[64:79]
    v_exp_f32 v100, v84
    v_cvt_pk_bf16_f32 v112, v96, v97
    v_exp_f32 v101, v85
    v_cvt_pk_bf16_f32 v113, v98, v99
    v_exp_f32 v102, v86
    v_exp_f32 v103, v87
    v_mfma_f32_32x32x16_bf16 v[128:143], a[204:207], v[116:119], v[128:143]
    v_exp_f32 v104, v88
    v_cvt_pk_bf16_f32 v114, v100, v101
    v_exp_f32 v105, v89
    v_cvt_pk_bf16_f32 v115, v102, v103
    v_exp_f32 v106, v90
    v_exp_f32 v107, v91
    v_mfma_f32_32x32x16_bf16 v[144:159], a[200:203], v[112:115], v[144:159]
    v_exp_f32 v108, v92
    v_cvt_pk_bf16_f32 v116, v104, v105
    v_exp_f32 v109, v93
    v_cvt_pk_bf16_f32 v117, v106, v107
    v_exp_f32 v110, v94
    v_exp_f32 v111, v95
    v_mfma_f32_32x32x16_bf16 v[80:95], a[56:59], v[168:171], 0
    v_exp_f32 v96, v64
    v_cvt_pk_bf16_f32 v118, v108, v109
    v_exp_f32 v97, v65
    v_cvt_pk_bf16_f32 v119, v110, v111
    v_exp_f32 v98, v66
    v_exp_f32 v99, v67
    v_mfma_f32_32x32x8_bf16 v[80:95], a[92:93], v[172:173], v[80:95]
    v_exp_f32 v100, v68
    v_cvt_pk_bf16_f32 v112, v96, v97
    v_exp_f32 v101, v69
    v_cvt_pk_bf16_f32 v113, v98, v99
    v_exp_f32 v102, v70
    v_exp_f32 v103, v71
    v_mfma_f32_32x32x16_bf16 v[144:159], a[204:207], v[116:119], v[144:159]
    v_exp_f32 v104, v72
    v_cvt_pk_bf16_f32 v114, v100, v101
    v_exp_f32 v105, v73
    v_cvt_pk_bf16_f32 v115, v102, v103
    v_exp_f32 v106, v74
    v_exp_f32 v107, v75
    s_waitcnt vmcnt(0)
    v_mfma_f32_32x32x16_bf16 v[128:143], a[208:211], v[112:115], v[128:143]
    v_exp_f32 v108, v76
    v_cvt_pk_bf16_f32 v116, v104, v105
    v_exp_f32 v109, v77
    v_cvt_pk_bf16_f32 v117, v106, v107
    v_exp_f32 v110, v78
    v_exp_f32 v111, v79
    v_mfma_f32_32x32x16_bf16 v[64:79], a[60:63], v[160:163], 0
    v_exp_f32 v96, v80
    v_cvt_pk_bf16_f32 v118, v108, v109
    v_exp_f32 v97, v81
    v_cvt_pk_bf16_f32 v119, v110, v111
    v_exp_f32 v98, v82
    v_exp_f32 v99, v83
    v_mfma_f32_32x32x8_bf16 v[64:79], a[94:95], v[164:165], v[64:79]
    v_exp_f32 v100, v84
    v_cvt_pk_bf16_f32 v112, v96, v97
    v_exp_f32 v101, v85
    v_cvt_pk_bf16_f32 v113, v98, v99
    v_exp_f32 v102, v86
    v_exp_f32 v103, v87
    v_mfma_f32_32x32x16_bf16 v[128:143], a[212:215], v[116:119], v[128:143]
    v_exp_f32 v104, v88
    v_cvt_pk_bf16_f32 v114, v100, v101
    v_exp_f32 v105, v89
    v_cvt_pk_bf16_f32 v115, v102, v103
    v_exp_f32 v106, v90
    v_exp_f32 v107, v91
    ds_read_b128 v[160:163], v27
    ds_read_b64 v[164:165], v28 offset:1024
    v_mfma_f32_32x32x16_bf16 v[144:159], a[208:211], v[112:115], v[144:159]
    v_exp_f32 v108, v92
    v_cvt_pk_bf16_f32 v116, v104, v105
    v_exp_f32 v109, v93
    v_cvt_pk_bf16_f32 v117, v106, v107
    v_exp_f32 v110, v94
    v_exp_f32 v111, v95
    v_mfma_f32_32x32x16_bf16 v[80:95], a[60:63], v[168:171], 0
    v_exp_f32 v96, v64
    v_cvt_pk_bf16_f32 v118, v108, v109
    v_exp_f32 v97, v65
    v_cvt_pk_bf16_f32 v119, v110, v111
    v_exp_f32 v98, v66
    v_exp_f32 v99, v67
    v_mfma_f32_32x32x8_bf16 v[80:95], a[94:95], v[172:173], v[80:95]
    v_exp_f32 v100, v68
    v_cvt_pk_bf16_f32 v112, v96, v97
    v_exp_f32 v101, v69
    v_cvt_pk_bf16_f32 v113, v98, v99
    v_exp_f32 v102, v70
    v_exp_f32 v103, v71
    s_mov_b32 exec_hi, 0
    buffer_load_dword v25, v26, s[4:7], s46 offen
    s_mov_b32 exec_hi, -1
    v_mfma_f32_32x32x16_bf16 v[144:159], a[212:215], v[116:119], v[144:159]
    v_exp_f32 v104, v72
    v_cvt_pk_bf16_f32 v114, v100, v101
    v_exp_f32 v105, v73
    v_cvt_pk_bf16_f32 v115, v102, v103
    v_exp_f32 v106, v74
    v_exp_f32 v107, v75
    ds_read_b128 v[168:171], v27 offset:1536
    ds_read_b64 v[172:173], v28 offset:2560
    v_mfma_f32_32x32x16_bf16 v[128:143], a[216:219], v[112:115], v[128:143]
    v_exp_f32 v108, v76
    v_cvt_pk_bf16_f32 v116, v104, v105
    v_exp_f32 v109, v77
    v_cvt_pk_bf16_f32 v117, v106, v107
    v_exp_f32 v110, v78
    v_exp_f32 v111, v79
    s_waitcnt lgkmcnt(2)
    v_mfma_f32_32x32x16_bf16 v[64:79], a[0:3], v[160:163], 0
    v_exp_f32 v96, v80
    v_cvt_pk_bf16_f32 v118, v108, v109
    v_exp_f32 v97, v81
    v_cvt_pk_bf16_f32 v119, v110, v111
    v_exp_f32 v98, v82
    v_exp_f32 v99, v83
    v_mfma_f32_32x32x8_bf16 v[64:79], a[64:65], v[164:165], v[64:79]
    v_exp_f32 v100, v84
    v_cvt_pk_bf16_f32 v112, v96, v97
    v_exp_f32 v101, v85
    v_cvt_pk_bf16_f32 v113, v98, v99
    v_exp_f32 v102, v86
    v_exp_f32 v103, v87
    v_mfma_f32_32x32x16_bf16 v[128:143], a[220:223], v[116:119], v[128:143]
    v_exp_f32 v104, v88
    v_cvt_pk_bf16_f32 v114, v100, v101
    v_exp_f32 v105, v89
    v_cvt_pk_bf16_f32 v115, v102, v103
    v_exp_f32 v106, v90
    v_exp_f32 v107, v91
    v_mfma_f32_32x32x16_bf16 v[144:159], a[216:219], v[112:115], v[144:159]
    v_exp_f32 v108, v92
    v_cvt_pk_bf16_f32 v116, v104, v105
    v_exp_f32 v109, v93
    v_cvt_pk_bf16_f32 v117, v106, v107
    v_exp_f32 v110, v94
    v_exp_f32 v111, v95
    .p2align 3
L_att_loop:
    s_waitcnt lgkmcnt(0)
    v_mfma_f32_32x32x16_bf16 v[80:95], a[0:3], v[168:171], 0
    v_exp_f32 v96, v64
    v_cvt_pk_bf16_f32 v118, v108, v109
    v_exp_f32 v97, v65
    v_cvt_pk_bf16_f32 v119, v110, v111
    v_exp_f32 v98, v66
    v_exp_f32 v99, v67
    ds_write_b128 v29, v[128:131] offset:0
    v_mfma_f32_32x32x8_bf16 v[80:95], a[64:65], v[172:173], v[80:95]
    v_exp_f32 v100, v68
    v_cvt_pk_bf16_f32 v176, v96, v97
    v_exp_f32 v101, v69
    v_cvt_pk_bf16_f32 v177, v98, v99
    v_exp_f32 v102, v70
    v_exp_f32 v103, v71
    ds_write_b128 v29, v[132:135] offset:1024
    v_mfma_f32_32x32x16_bf16 v[144:159], a[220:223], v[116:119], v[144:159]
    v_exp_f32 v104, v72
    v_cvt_pk_bf16_f32 v178, v100, v101
    v_exp_f32 v105, v73
    v_cvt_pk_bf16_f32 v179, v102, v103
    v_exp_f32 v106, v74
    v_exp_f32 v107, v75
    ds_write_b128 v29, v[136:139] offset:2048
    v_exp_f32 v108, v76
    v_cvt_pk_bf16_f32 v180, v104, v105
    v_exp_f32 v109, v77
    v_cvt_pk_bf16_f32 v181, v106, v107
    v_exp_f32 v110, v78
    v_exp_f32 v111, v79
    v_mfma_f32_32x32x16_bf16 v[64:79], a[4:7], v[160:163], 0
    v_exp_f32 v96, v80
    v_cvt_pk_bf16_f32 v182, v108, v109
    v_exp_f32 v97, v81
    v_cvt_pk_bf16_f32 v183, v110, v111
    v_exp_f32 v98, v82
    v_exp_f32 v99, v83
    ds_write_b128 v29, v[144:147] offset:3072
    ds_write_b128 v29, v[148:151] offset:4096
    v_mfma_f32_32x32x8_bf16 v[64:79], a[66:67], v[164:165], v[64:79]
    v_exp_f32 v100, v84
    v_cvt_pk_bf16_f32 v184, v96, v97
    v_exp_f32 v101, v85
    v_cvt_pk_bf16_f32 v185, v98, v99
    v_exp_f32 v102, v86
    v_exp_f32 v103, v87
    ds_write_b128 v29, v[152:155] offset:5120
    v_exp_f32 v104, v88
    v_cvt_pk_bf16_f32 v186, v100, v101
    v_exp_f32 v105, v89
    v_cvt_pk_bf16_f32 v187, v102, v103
    v_exp_f32 v106, v90
    v_exp_f32 v107, v91
    v_exp_f32 v108, v92
    v_cvt_pk_bf16_f32 v188, v104, v105
    v_exp_f32 v109, v93
    v_cvt_pk_bf16_f32 v189, v106, v107
    v_exp_f32 v110, v94
    v_exp_f32 v111, v95
    s_waitcnt lgkmcnt(0)
    s_barrier
    ds_read_b128 v[128:131], v30 offset:0
    ds_read_b128 v[132:135], v30 offset:1024
    ds_read_b128 v[136:139], v30 offset:2048
    v_mfma_f32_32x32x16_bf16 v[80:95], a[4:7], v[168:171], 0
    v_exp_f32 v96, v64
    v_cvt_pk_bf16_f32 v190, v108, v109
    v_exp_f32 v97, v65
    v_cvt_pk_bf16_f32 v191, v110, v111
    v_exp_f32 v98, v66
    v_exp_f32 v99, v67
    ds_read_b128 v[144:147], v30 offset:3072
    ds_read_b128 v[148:151], v30 offset:4096
    v_mfma_f32_32x32x8_bf16 v[80:95], a[66:67], v[172:173], v[80:95]
    v_exp_f32 v100, v68
    v_cvt_pk_bf16_f32 v112, v96, v97
    v_exp_f32 v101, v69
    v_cvt_pk_bf16_f32 v113, v98, v99
    v_exp_f32 v102, v70
    v_exp_f32 v103, v71
    ds_read_b128 v[152:155], v30 offset:5120
    v_exp_f32 v104, v72
    v_cvt_pk_bf16_f32 v114, v100, v101
    v_exp_f32 v105, v73
    v_cvt_pk_bf16_f32 v115, v102, v103
    v_exp_f32 v106, v74
    v_exp_f32 v107, v75
    s_waitcnt lgkmcnt(3)
    v_mfma_f32_32x32x16_bf16 v[128:143], a[104:107], v[112:115], v[128:143]
    v_exp_f32 v108, v76
    v_cvt_pk_bf16_f32 v116, v104, v105
    v_exp_f32 v109, v77
    v_cvt_pk_bf16_f32 v117, v106, v107
    v_exp_f32 v110, v78
    v_exp_f32 v111, v79
    v_mfma_f32_32x32x16_bf16 v[64:79], a[8:11], v[160:163], 0
    v_exp_f32 v96, v80
    v_cvt_pk_bf16_f32 v118, v108, v109
    v_exp_f32 v97, v81
    v_cvt_pk_bf16_f32 v119, v110, v111
    v_exp_f32 v98, v82
    v_exp_f32 v99, v83
    v_mfma_f32_32x32x8_bf16 v[64:79], a[68:69], v[164:165], v[64:79]
    v_exp_f32 v100, v84
    v_cvt_pk_bf16_f32 v112, v96, v97
    v_exp_f32 v101, v85
    v_cvt_pk_bf16_f32 v113, v98, v99
    v_exp_f32 v102, v86
    v_exp_f32 v103, v87
    v_mfma_f32_32x32x16_bf16 v[128:143], a[108:111], v[116:119], v[128:143]
    v_exp_f32 v104, v88
    v_cvt_pk_bf16_f32 v114, v100, v101
    v_exp_f32 v105, v89
    v_cvt_pk_bf16_f32 v115, v102, v103
    v_exp_f32 v106, v90
    v_exp_f32 v107, v91
    s_waitcnt lgkmcnt(0)
    v_mfma_f32_32x32x16_bf16 v[144:159], a[104:107], v[112:115], v[144:159]
    v_exp_f32 v108, v92
    v_cvt_pk_bf16_f32 v116, v104, v105
    v_exp_f32 v109, v93
    v_cvt_pk_bf16_f32 v117, v106, v107
    v_exp_f32 v110, v94
    v_exp_f32 v111, v95
    v_mfma_f32_32x32x16_bf16 v[80:95], a[8:11], v[168:171], 0
    v_exp_f32 v96, v64
    v_cvt_pk_bf16_f32 v118, v108, v109
    v_exp_f32 v97, v65
    v_cvt_pk_bf16_f32 v119, v110, v111
    v_exp_f32 v98, v66
    v_exp_f32 v99, v67
    v_mov_b32 v29, v30
    s_add_u32 s45, s45, 1
    s_and_b32 s45, s45, 3
    v_mfma_f32_32x32x8_bf16 v[80:95], a[68:69], v[172:173], v[80:95]
    v_exp_f32 v100, v68
    v_cvt_pk_bf16_f32 v112, v96, v97
    v_exp_f32 v101, v69
    v_cvt_pk_bf16_f32 v113, v98, v99
    v_exp_f32 v102, v70
    v_exp_f32 v103, v71
    s_mov_b32 m0, s54
    s_mul_i32 s47, s45, 6144
    s_add_u32 s47, s47, 102400
    v_add_u32 v30, s47, v1
    v_mfma_f32_32x32x16_bf16 v[144:159], a[108:111], v[116:119], v[144:159]
    v_exp_f32 v104, v72
    v_cvt_pk_bf16_f32 v114, v100, v101
    v_exp_f32 v105, v73
    v_cvt_pk_bf16_f32 v115, v102, v103
    v_exp_f32 v106, v74
    v_exp_f32 v107, v75
    buffer_load_dwordx4 v1, s[4:7], s53 offen offset:0 sc1 lds
    s_mul_i32 s47, s45, 3072
    s_add_u32 s47, s47, 133120
    v_add_u32 v27, s47, v1
    v_add_u32 v28, s47, v32
    v_mfma_f32_32x32x16_bf16 v[128:143], a[112:115], v[112:115], v[128:143]
    v_exp_f32 v108, v76
    v_cvt_pk_bf16_f32 v116, v104, v105
    v_exp_f32 v109, v77
    v_cvt_pk_bf16_f32 v117, v106, v107
    v_exp_f32 v110, v78
    v_exp_f32 v111, v79
    v_mfma_f32_32x32x16_bf16 v[64:79], a[12:15], v[160:163], 0
    v_exp_f32 v96, v80
    v_cvt_pk_bf16_f32 v118, v108, v109
    v_exp_f32 v97, v81
    v_cvt_pk_bf16_f32 v119, v110, v111
    v_exp_f32 v98, v82
    v_exp_f32 v99, v83
    v_mfma_f32_32x32x8_bf16 v[64:79], a[70:71], v[164:165], v[64:79]
    v_exp_f32 v100, v84
    v_cvt_pk_bf16_f32 v112, v96, v97
    v_exp_f32 v101, v85
    v_cvt_pk_bf16_f32 v113, v98, v99
    v_exp_f32 v102, v86
    v_exp_f32 v103, v87
    v_mfma_f32_32x32x16_bf16 v[128:143], a[116:119], v[116:119], v[128:143]
    v_exp_f32 v104, v88
    v_cvt_pk_bf16_f32 v114, v100, v101
    v_exp_f32 v105, v89
    v_cvt_pk_bf16_f32 v115, v102, v103
    v_exp_f32 v106, v90
    v_exp_f32 v107, v91
    v_mfma_f32_32x32x16_bf16 v[144:159], a[112:115], v[112:115], v[144:159]
    v_exp_f32 v108, v92
    v_cvt_pk_bf16_f32 v116, v104, v105
    v_exp_f32 v109, v93
    v_cvt_pk_bf16_f32 v117, v106, v107
    v_exp_f32 v110, v94
    v_exp_f32 v111, v95
    v_mfma_f32_32x32x16_bf16 v[80:95], a[12:15], v[168:171], 0
    v_exp_f32 v96, v64
    v_cvt_pk_bf16_f32 v118, v108, v109
    v_exp_f32 v97, v65
    v_cvt_pk_bf16_f32 v119, v110, v111
    v_exp_f32 v98, v66
    v_exp_f32 v99, v67
    v_mfma_f32_32x32x8_bf16 v[80:95], a[70:71], v[172:173], v[80:95]
    v_exp_f32 v100, v68
    v_cvt_pk_bf16_f32 v112, v96, v97
    v_exp_f32 v101, v69
    v_cvt_pk_bf16_f32 v113, v98, v99
    v_exp_f32 v102, v70
    v_exp_f32 v103, v71
    v_mfma_f32_32x32x16_bf16 v[144:159], a[116:119], v[116:119], v[144:159]
    v_exp_f32 v104, v72
    v_cvt_pk_bf16_f32 v114, v100, v101
    v_exp_f32 v105, v73
    v_cvt_pk_bf16_f32 v115, v102, v103
    v_exp_f32 v106, v74
    v_exp_f32 v107, v75
    v_mfma_f32_32x32x16_bf16 v[128:143], a[120:123], v[112:115], v[128:143]
    v_exp_f32 v108, v76
    v_cvt_pk_bf16_f32 v116, v104, v105
    v_exp_f32 v109, v77
    v_cvt_pk_bf16_f32 v117, v106, v107
    v_exp_f32 v110, v78
    v_exp_f32 v111, v79
    v_mfma_f32_32x32x16_bf16 v[64:79], a[16:19], v[160:163], 0
    v_exp_f32 v96, v80
    v_cvt_pk_bf16_f32 v118, v108, v109
    v_exp_f32 v97, v81
    v_cvt_pk_bf16_f32 v119, v110, v111
    v_exp_f32 v98, v82
    v_exp_f32 v99, v83
    v_mfma_f32_32x32x8_bf16 v[64:79], a[72:73], v[164:165], v[64:79]
    v_exp_f32 v100, v84
    v_cvt_pk_bf16_f32 v112, v96, v97
    v_exp_f32 v101, v85
    v_cvt_pk_bf16_f32 v113, v98, v99
    v_exp_f32 v102, v86
    v_exp_f32 v103, v87
    v_mfma_f32_32x32x16_bf16 v[128:143], a[124:127], v[116:119], v[128:143]
    v_exp_f32 v104, v88
    v_cvt_pk_bf16_f32 v114, v100, v101
    v_exp_f32 v105, v89
    v_cvt_pk_bf16_f32 v115, v102, v103
    v_exp_f32 v106, v90
    v_exp_f32 v107, v91
    buffer_load_dwordx4 v1, s[4:7], s53 offen offset:1024 sc1 lds
    v_mfma_f32_32x32x16_bf16 v[144:159], a[120:123], v[112:115], v[144:159]
    v_exp_f32 v108, v92
    v_cvt_pk_bf16_f32 v116, v104, v105
    v_exp_f32 v109, v93
    v_cvt_pk_bf16_f32 v117, v106, v107
    v_exp_f32 v110, v94
    v_exp_f32 v111, v95
    v_mfma_f32_32x32x16_bf16 v[80:95], a[16:19], v[168:171], 0
    v_exp_f32 v96, v64
    v_cvt_pk_bf16_f32 v118, v108, v109
    v_exp_f32 v97, v65
    v_cvt_pk_bf16_f32 v119, v110, v111
    v_mfma_f32_32x32x16_bf16 v[128:143], a[96:99], v[176:179], v[128:143]
    v_exp_f32 v98, v66
    v_exp_f32 v99, v67
    v_mfma_f32_32x32x8_bf16 v[80:95], a[72:73], v[172:173], v[80:95]
    v_exp_f32 v100, v68
    v_cvt_pk_bf16_f32 v112, v96, v97
    v_exp_f32 v101, v69
    v_cvt_pk_bf16_f32 v113, v98, v99
    v_exp_f32 v102, v70
    v_exp_f32 v103, v71
    v_mfma_f32_32x32x16_bf16 v[144:159], a[124:127], v[116:119], v[144:159]
    v_exp_f32 v104, v72
    v_cvt_pk_bf16_f32 v114, v100, v101
    v_exp_f32 v105, v73
    v_cvt_pk_bf16_f32 v115, v102, v103
    v_exp_f32 v106, v74
    v_exp_f32 v107, v75
    v_mfma_f32_32x32x16_bf16 v[128:143], a[128:131], v[112:115], v[128:143]
    v_exp_f32 v108, v76
    v_cvt_pk_bf16_f32 v116, v104, v105
    v_exp_f32 v109, v77
    v_cvt_pk_bf16_f32 v117, v106, v107
    v_exp_f32 v110, v78
    v_exp_f32 v111, v79
    v_mfma_f32_32x32x16_bf16 v[64:79], a[20:23], v[160:163], 0
    v_exp_f32 v96, v80
    v_cvt_pk_bf16_f32 v118, v108, v109
    v_exp_f32 v97, v81
    v_cvt_pk_bf16_f32 v119, v110, v111
    v_mfma_f32_32x32x16_bf16 v[144:159], a[96:99], v[184:187], v[144:159]
    v_exp_f32 v98, v82
    v_exp_f32 v99, v83
    v_mfma_f32_32x32x8_bf16 v[64:79], a[74:75], v[164:165], v[64:79]
    v_exp_f32 v100, v84
    v_cvt_pk_bf16_f32 v112, v96, v97
    v_exp_f32 v101, v85
    v_cvt_pk_bf16_f32 v113, v98, v99
    v_exp_f32 v102, v86
    v_exp_f32 v103, v87
    v_mfma_f32_32x32x16_bf16 v[128:143], a[132:135], v[116:119], v[128:143]
    v_exp_f32 v104, v88
    v_cvt_pk_bf16_f32 v114, v100, v101
    v_exp_f32 v105, v89
    v_cvt_pk_bf16_f32 v115, v102, v103
    v_exp_f32 v106, v90
    v_exp_f32 v107, v91
    v_mfma_f32_32x32x16_bf16 v[144:159], a[128:131], v[112:115], v[144:159]
    v_exp_f32 v108, v92
    v_cvt_pk_bf16_f32 v116, v104, v105
    v_exp_f32 v109, v93
    v_cvt_pk_bf16_f32 v117, v106, v107
    v_exp_f32 v110, v94
    v_exp_f32 v111, v95
    v_mfma_f32_32x32x16_bf16 v[80:95], a[20:23], v[168:171], 0
    v_exp_f32 v96, v64
    v_cvt_pk_bf16_f32 v118, v108, v109
    v_exp_f32 v97, v65
    v_cvt_pk_bf16_f32 v119, v110, v111
    v_exp_f32 v98, v66
    v_exp_f32 v99, v67
    v_mfma_f32_32x32x8_bf16 v[80:95], a[74:75], v[172:173], v[80:95]
    v_exp_f32 v100, v68
    v_cvt_pk_bf16_f32 v112, v96, v97
    v_exp_f32 v101, v69
    v_cvt_pk_bf16_f32 v113, v98, v99
    v_exp_f32 v102, v70
    v_exp_f32 v103, v71
    v_mfma_f32_32x32x16_bf16 v[144:159], a[132:135], v[116:119], v[144:159]
    v_exp_f32 v104, v72
    v_cvt_pk_bf16_f32 v114, v100, v101
    v_exp_f32 v105, v73
    v_cvt_pk_bf16_f32 v115, v102, v103
    v_exp_f32 v106, v74
    v_exp_f32 v107, v75
    buffer_load_dwordx4 v1, s[4:7], s53 offen offset:2048 sc1 lds
    v_mfma_f32_32x32x16_bf16 v[128:143], a[136:139], v[112:115], v[128:143]
    v_exp_f32 v108, v76
    v_cvt_pk_bf16_f32 v116, v104, v105
    v_exp_f32 v109, v77
    v_cvt_pk_bf16_f32 v117, v106, v107
    v_exp_f32 v110, v78
    v_exp_f32 v111, v79
    v_mfma_f32_32x32x16_bf16 v[64:79], a[24:27], v[160:163], 0
    v_exp_f32 v96, v80
    v_cvt_pk_bf16_f32 v118, v108, v109
    v_exp_f32 v97, v81
    v_cvt_pk_bf16_f32 v119, v110, v111
    v_exp_f32 v98, v82
    v_exp_f32 v99, v83
    v_mfma_f32_32x32x8_bf16 v[64:79], a[76:77], v[164:165], v[64:79]
    v_exp_f32 v100, v84
    v_cvt_pk_bf16_f32 v112, v96, v97
    v_exp_f32 v101, v85
    v_cvt_pk_bf16_f32 v113, v98, v99
    v_exp_f32 v102, v86
    v_exp_f32 v103, v87
    v_mfma_f32_32x32x16_bf16 v[128:143], a[140:143], v[116:119], v[128:143]
    v_exp_f32 v104, v88
    v_cvt_pk_bf16_f32 v114, v100, v101
    v_exp_f32 v105, v89
    v_cvt_pk_bf16_f32 v115, v102, v103
    v_exp_f32 v106, v90
    v_exp_f32 v107, v91
    v_mfma_f32_32x32x16_bf16 v[144:159], a[136:139], v[112:115], v[144:159]
    v_exp_f32 v108, v92
    v_cvt_pk_bf16_f32 v116, v104, v105
    v_exp_f32 v109, v93
    v_cvt_pk_bf16_f32 v117, v106, v107
    v_exp_f32 v110, v94
    v_exp_f32 v111, v95
    v_mfma_f32_32x32x16_bf16 v[80:95], a[24:27], v[168:171], 0
    v_exp_f32 v96, v64
    v_cvt_pk_bf16_f32 v118, v108, v109
    v_exp_f32 v97, v65
    v_cvt_pk_bf16_f32 v119, v110, v111
    v_mfma_f32_32x32x16_bf16 v[128:143], a[100:103], v[180:183], v[128:143]
    v_exp_f32 v98, v66
    v_exp_f32 v99, v67
    v_mfma_f32_32x32x8_bf16 v[80:95], a[76:77], v[172:173], v[80:95]
    v_exp_f32 v100, v68
    v_cvt_pk_bf16_f32 v112, v96, v97
    v_exp_f32 v101, v69
    v_cvt_pk_bf16_f32 v113, v98, v99
    v_exp_f32 v102, v70
    v_exp_f32 v103, v71
    v_mfma_f32_32x32x16_bf16 v[144:159], a[140:143], v[116:119], v[144:159]
    v_exp_f32 v104, v72
    v_cvt_pk_bf16_f32 v114, v100, v101
    v_exp_f32 v105, v73
    v_cvt_pk_bf16_f32 v115, v102, v103
    v_exp_f32 v106, v74
    v_exp_f32 v107, v75
    v_mfma_f32_32x32x16_bf16 v[128:143], a[144:147], v[112:115], v[128:143]
    v_exp_f32 v108, v76
    v_cvt_pk_bf16_f32 v116, v104, v105
    v_exp_f32 v109, v77
    v_cvt_pk_bf16_f32 v117, v106, v107
    v_exp_f32 v110, v78
    v_exp_f32 v111, v79
    v_mfma_f32_32x32x16_bf16 v[64:79], a[28:31], v[160:163], 0
    v_exp_f32 v96, v80
    v_cvt_pk_bf16_f32 v118, v108, v109
    v_exp_f32 v97, v81
    v_cvt_pk_bf16_f32 v119, v110, v111
    v_mfma_f32_32x32x16_bf16 v[144:159], a[100:103], v[188:191], v[144:159]
    v_exp_f32 v98, v82
    v_exp_f32 v99, v83
    v_mfma_f32_32x32x8_bf16 v[64:79], a[78:79], v[164:165], v[64:79]
    v_exp_f32 v100, v84
    v_cvt_pk_bf16_f32 v112, v96, v97
    v_exp_f32 v101, v85
    v_cvt_pk_bf16_f32 v113, v98, v99
    v_exp_f32 v102, v86
    v_exp_f32 v103, v87
    v_mfma_f32_32x32x16_bf16 v[128:143], a[148:151], v[116:119], v[128:143]
    v_exp_f32 v104, v88
    v_cvt_pk_bf16_f32 v114, v100, v101
    v_exp_f32 v105, v89
    v_cvt_pk_bf16_f32 v115, v102, v103
    v_exp_f32 v106, v90
    v_exp_f32 v107, v91
    buffer_load_dwordx4 v1, s[4:7], s53 offen offset:3072 sc1 lds
    v_mfma_f32_32x32x16_bf16 v[144:159], a[144:147], v[112:115], v[144:159]
    v_exp_f32 v108, v92
    v_cvt_pk_bf16_f32 v116, v104, v105
    v_exp_f32 v109, v93
    v_cvt_pk_bf16_f32 v117, v106, v107
    v_exp_f32 v110, v94
    v_exp_f32 v111, v95
    v_mfma_f32_32x32x16_bf16 v[80:95], a[28:31], v[168:171], 0
    v_exp_f32 v96, v64
    v_cvt_pk_bf16_f32 v118, v108, v109
    v_exp_f32 v97, v65
    v_cvt_pk_bf16_f32 v119, v110, v111
    v_exp_f32 v98, v66
    v_exp_f32 v99, v67
    v_mfma_f32_32x32x8_bf16 v[80:95], a[78:79], v[172:173], v[80:95]
    v_exp_f32 v100, v68
    v_cvt_pk_bf16_f32 v112, v96, v97
    v_exp_f32 v101, v69
    v_cvt_pk_bf16_f32 v113, v98, v99
    v_exp_f32 v102, v70
    v_exp_f32 v103, v71
    v_mfma_f32_32x32x16_bf16 v[144:159], a[148:151], v[116:119], v[144:159]
    v_exp_f32 v104, v72
    v_cvt_pk_bf16_f32 v114, v100, v101
    v_exp_f32 v105, v73
    v_cvt_pk_bf16_f32 v115, v102, v103
    v_exp_f32 v106, v74
    v_exp_f32 v107, v75
    v_mfma_f32_32x32x16_bf16 v[128:143], a[152:155], v[112:115], v[128:143]
    v_exp_f32 v108, v76
    v_cvt_pk_bf16_f32 v116, v104, v105
    v_exp_f32 v109, v77
    v_cvt_pk_bf16_f32 v117, v106, v107
    v_exp_f32 v110, v78
    v_exp_f32 v111, v79
    v_mfma_f32_32x32x16_bf16 v[64:79], a[32:35], v[160:163], 0
    v_exp_f32 v96, v80
    v_cvt_pk_bf16_f32 v118, v108, v109
    v_exp_f32 v97, v81
    v_cvt_pk_bf16_f32 v119, v110, v111
    v_exp_f32 v98, v82
    v_exp_f32 v99, v83
    v_mfma_f32_32x32x8_bf16 v[64:79], a[80:81], v[164:165], v[64:79]
    v_exp_f32 v100, v84
    v_cvt_pk_bf16_f32 v112, v96, v97
    v_exp_f32 v101, v85
    v_cvt_pk_bf16_f32 v113, v98, v99
    v_exp_f32 v102, v86
    v_exp_f32 v103, v87
    v_mfma_f32_32x32x16_bf16 v[128:143], a[156:159], v[116:119], v[128:143]
    v_exp_f32 v104, v88
    v_cvt_pk_bf16_f32 v114, v100, v101
    v_exp_f32 v105, v89
    v_cvt_pk_bf16_f32 v115, v102, v103
    v_exp_f32 v106, v90
    v_exp_f32 v107, v91
    v_mfma_f32_32x32x16_bf16 v[144:159], a[152:155], v[112:115], v[144:159]
    v_exp_f32 v108, v92
    v_cvt_pk_bf16_f32 v116, v104, v105
    v_exp_f32 v109, v93
    v_cvt_pk_bf16_f32 v117, v106, v107
    v_exp_f32 v110, v94
    v_exp_f32 v111, v95
    v_mfma_f32_32x32x16_bf16 v[80:95], a[32:35], v[168:171], 0
    v_exp_f32 v96, v64
    v_cvt_pk_bf16_f32 v118, v108, v109
    v_exp_f32 v97, v65
    v_cvt_pk_bf16_f32 v119, v110, v111
    v_exp_f32 v98, v66
    v_exp_f32 v99, v67
    v_mfma_f32_32x32x8_bf16 v[80:95], a[80:81], v[172:173], v[80:95]
    v_exp_f32 v100, v68
    v_cvt_pk_bf16_f32 v112, v96, v97
    v_exp_f32 v101, v69
    v_cvt_pk_bf16_f32 v113, v98, v99
    v_exp_f32 v102, v70
    v_exp_f32 v103, v71
    s_add_u32 m0, s54, 1024
    s_add_u32 s53, s53, 1024
    v_mfma_f32_32x32x16_bf16 v[144:159], a[156:159], v[116:119], v[144:159]
    v_exp_f32 v104, v72
    v_cvt_pk_bf16_f32 v114, v100, v101
    v_exp_f32 v105, v73
    v_cvt_pk_bf16_f32 v115, v102, v103
    v_exp_f32 v106, v74
    v_exp_f32 v107, v75
    buffer_load_dwordx4 v1, s[4:7], s53 offen offset:3072 sc1 lds
    s_add_u32 s54, s54, 5120
    s_add_u32 s53, s53, 4096
    v_mfma_f32_32x32x16_bf16 v[128:143], a[160:163], v[112:115], v[128:143]
    v_exp_f32 v108, v76
    v_cvt_pk_bf16_f32 v116, v104, v105
    v_exp_f32 v109, v77
    v_cvt_pk_bf16_f32 v117, v106, v107
    v_exp_f32 v110, v78
    v_exp_f32 v111, v79
    v_mfma_f32_32x32x16_bf16 v[64:79], a[36:39], v[160:163], 0
    v_exp_f32 v96, v80
    v_cvt_pk_bf16_f32 v118, v108, v109
    v_exp_f32 v97, v81
    v_cvt_pk_bf16_f32 v119, v110, v111
    v_exp_f32 v98, v82
    v_exp_f32 v99, v83
    v_mfma_f32_32x32x8_bf16 v[64:79], a[82:83], v[164:165], v[64:79]
    v_exp_f32 v100, v84
    v_cvt_pk_bf16_f32 v112, v96, v97
    v_exp_f32 v101, v85
    v_cvt_pk_bf16_f32 v113, v98, v99
    v_exp_f32 v102, v86
    v_exp_f32 v103, v87
    v_mfma_f32_32x32x16_bf16 v[128:143], a[164:167], v[116:119], v[128:143]
    v_exp_f32 v104, v88
    v_cvt_pk_bf16_f32 v114, v100, v101
    v_exp_f32 v105, v89
    v_cvt_pk_bf16_f32 v115, v102, v103
    v_exp_f32 v106, v90
    v_exp_f32 v107, v91
    v_mfma_f32_32x32x16_bf16 v[144:159], a[160:163], v[112:115], v[144:159]
    v_exp_f32 v108, v92
    v_cvt_pk_bf16_f32 v116, v104, v105
    v_exp_f32 v109, v93
    v_cvt_pk_bf16_f32 v117, v106, v107
    v_exp_f32 v110, v94
    v_exp_f32 v111, v95
    v_mfma_f32_32x32x16_bf16 v[80:95], a[36:39], v[168:171], 0
    v_exp_f32 v96, v64
    v_cvt_pk_bf16_f32 v118, v108, v109
    v_exp_f32 v97, v65
    v_cvt_pk_bf16_f32 v119, v110, v111
    v_exp_f32 v98, v66
    v_exp_f32 v99, v67
    v_mfma_f32_32x32x8_bf16 v[80:95], a[82:83], v[172:173], v[80:95]
    v_exp_f32 v100, v68
    v_cvt_pk_bf16_f32 v112, v96, v97
    v_exp_f32 v101, v69
    v_cvt_pk_bf16_f32 v113, v98, v99
    v_exp_f32 v102, v70
    v_exp_f32 v103, v71
    v_mfma_f32_32x32x16_bf16 v[144:159], a[164:167], v[116:119], v[144:159]
    v_exp_f32 v104, v72
    v_cvt_pk_bf16_f32 v114, v100, v101
    v_exp_f32 v105, v73
    v_cvt_pk_bf16_f32 v115, v102, v103
    v_exp_f32 v106, v74
    v_exp_f32 v107, v75
    v_mfma_f32_32x32x16_bf16 v[128:143], a[168:171], v[112:115], v[128:143]
    v_exp_f32 v108, v76
    v_cvt_pk_bf16_f32 v116, v104, v105
    v_exp_f32 v109, v77
    v_cvt_pk_bf16_f32 v117, v106, v107
    v_exp_f32 v110, v78
    v_exp_f32 v111, v79
    v_mfma_f32_32x32x16_bf16 v[64:79], a[40:43], v[160:163], 0
    v_exp_f32 v96, v80
    v_cvt_pk_bf16_f32 v118, v108, v109
    v_exp_f32 v97, v81
    v_cvt_pk_bf16_f32 v119, v110, v111
    v_exp_f32 v98, v82
    v_exp_f32 v99, v83
    v_mfma_f32_32x32x8_bf16 v[64:79], a[84:85], v[164:165], v[64:79]
    v_exp_f32 v100, v84
    v_cvt_pk_bf16_f32 v112, v96, v97
    v_exp_f32 v101, v85
    v_cvt_pk_bf16_f32 v113, v98, v99
    v_exp_f32 v102, v86
    v_exp_f32 v103, v87
    s_mov_b32 m0, s52
    v_mfma_f32_32x32x16_bf16 v[128:143], a[172:175], v[116:119], v[128:143]
    v_exp_f32 v104, v88
    v_cvt_pk_bf16_f32 v114, v100, v101
    v_exp_f32 v105, v89
    v_cvt_pk_bf16_f32 v115, v102, v103
    v_exp_f32 v106, v90
    v_exp_f32 v107, v91
    buffer_load_dwordx4 v1, s[4:7], s43 offen offset:0 sc1 lds
    v_mfma_f32_32x32x16_bf16 v[144:159], a[168:171], v[112:115], v[144:159]
    v_exp_f32 v108, v92
    v_cvt_pk_bf16_f32 v116, v104, v105
    v_exp_f32 v109, v93
    v_cvt_pk_bf16_f32 v117, v106, v107
    v_exp_f32 v110, v94
    v_exp_f32 v111, v95
    v_mfma_f32_32x32x16_bf16 v[80:95], a[40:43], v[168:171], 0
    v_exp_f32 v96, v64
    v_cvt_pk_bf16_f32 v118, v108, v109
    v_exp_f32 v97, v65
    v_cvt_pk_bf16_f32 v119, v110, v111
    v_exp_f32 v98, v66
    v_exp_f32 v99, v67
    v_mfma_f32_32x32x8_bf16 v[80:95], a[84:85], v[172:173], v[80:95]
    v_exp_f32 v100, v68
    v_cvt_pk_bf16_f32 v112, v96, v97
    v_exp_f32 v101, v69
    v_cvt_pk_bf16_f32 v113, v98, v99
    v_exp_f32 v102, v70
    v_exp_f32 v103, v71
    v_mfma_f32_32x32x16_bf16 v[144:159], a[172:175], v[116:119], v[144:159]
    v_exp_f32 v104, v72
    v_cvt_pk_bf16_f32 v114, v100, v101
    v_exp_f32 v105, v73
    v_cvt_pk_bf16_f32 v115, v102, v103
    v_exp_f32 v106, v74
    v_exp_f32 v107, v75
    v_mfma_f32_32x32x16_bf16 v[128:143], a[176:179], v[112:115], v[128:143]
    v_exp_f32 v108, v76
    v_cvt_pk_bf16_f32 v116, v104, v105
    v_exp_f32 v109, v77
    v_cvt_pk_bf16_f32 v117, v106, v107
    v_exp_f32 v110, v78
    v_exp_f32 v111, v79
    v_mfma_f32_32x32x16_bf16 v[64:79], a[44:47], v[160:163], 0
    v_exp_f32 v96, v80
    v_cvt_pk_bf16_f32 v118, v108, v109
    v_exp_f32 v97, v81
    v_cvt_pk_bf16_f32 v119, v110, v111
    v_exp_f32 v98, v82
    v_exp_f32 v99, v83
    v_mfma_f32_32x32x8_bf16 v[64:79], a[86:87], v[164:165], v[64:79]
    v_exp_f32 v100, v84
    v_cvt_pk_bf16_f32 v112, v96, v97
    v_exp_f32 v101, v85
    v_cvt_pk_bf16_f32 v113, v98, v99
    v_exp_f32 v102, v86
    v_exp_f32 v103, v87
    v_mfma_f32_32x32x16_bf16 v[128:143], a[180:183], v[116:119], v[128:143]
    v_exp_f32 v104, v88
    v_cvt_pk_bf16_f32 v114, v100, v101
    v_exp_f32 v105, v89
    v_cvt_pk_bf16_f32 v115, v102, v103
    v_exp_f32 v106, v90
    v_exp_f32 v107, v91
    v_mfma_f32_32x32x16_bf16 v[144:159], a[176:179], v[112:115], v[144:159]
    v_exp_f32 v108, v92
    v_cvt_pk_bf16_f32 v116, v104, v105
    v_exp_f32 v109, v93
    v_cvt_pk_bf16_f32 v117, v106, v107
    v_exp_f32 v110, v94
    v_exp_f32 v111, v95
    v_mfma_f32_32x32x16_bf16 v[80:95], a[44:47], v[168:171], 0
    v_exp_f32 v96, v64
    v_cvt_pk_bf16_f32 v118, v108, v109
    v_exp_f32 v97, v65
    v_cvt_pk_bf16_f32 v119, v110, v111
    v_exp_f32 v98, v66
    v_exp_f32 v99, v67
    v_mfma_f32_32x32x8_bf16 v[80:95], a[86:87], v[172:173], v[80:95]
    v_exp_f32 v100, v68
    v_cvt_pk_bf16_f32 v112, v96, v97
    v_exp_f32 v101, v69
    v_cvt_pk_bf16_f32 v113, v98, v99
    v_exp_f32 v102, v70
    v_exp_f32 v103, v71
    v_mfma_f32_32x32x16_bf16 v[144:159], a[180:183], v[116:119], v[144:159]
    v_exp_f32 v104, v72
    v_cvt_pk_bf16_f32 v114, v100, v101
    v_exp_f32 v105, v73
    v_cvt_pk_bf16_f32 v115, v102, v103
    v_exp_f32 v106, v74
    v_exp_f32 v107, v75
    buffer_load_dwordx4 v1, s[4:7], s43 offen offset:1024 sc1 lds
    v_mfma_f32_32x32x16_bf16 v[128:143], a[184:187], v[112:115], v[128:143]
    v_exp_f32 v108, v76
    v_cvt_pk_bf16_f32 v116, v104, v105
    v_exp_f32 v109, v77
    v_cvt_pk_bf16_f32 v117, v106, v107
    v_exp_f32 v110, v78
    v_exp_f32 v111, v79
    v_mfma_f32_32x32x16_bf16 v[64:79], a[48:51], v[160:163], 0
    v_exp_f32 v96, v80
    v_cvt_pk_bf16_f32 v118, v108, v109
    v_exp_f32 v97, v81
    v_cvt_pk_bf16_f32 v119, v110, v111
    v_exp_f32 v98, v82
    v_exp_f32 v99, v83
    v_mfma_f32_32x32x8_bf16 v[64:79], a[88:89], v[164:165], v[64:79]
    v_exp_f32 v100, v84
    v_cvt_pk_bf16_f32 v112, v96, v97
    v_exp_f32 v101, v85
    v_cvt_pk_bf16_f32 v113, v98, v99
    v_exp_f32 v102, v86
    v_exp_f32 v103, v87
    v_mfma_f32_32x32x16_bf16 v[128:143], a[188:191], v[116:119], v[128:143]
    v_exp_f32 v104, v88
    v_cvt_pk_bf16_f32 v114, v100, v101
    v_exp_f32 v105, v89
    v_cvt_pk_bf16_f32 v115, v102, v103
    v_exp_f32 v106, v90
    v_exp_f32 v107, v91
    v_mfma_f32_32x32x16_bf16 v[144:159], a[184:187], v[112:115], v[144:159]
    v_exp_f32 v108, v92
    v_cvt_pk_bf16_f32 v116, v104, v105
    v_exp_f32 v109, v93
    v_cvt_pk_bf16_f32 v117, v106, v107
    v_exp_f32 v110, v94
    v_exp_f32 v111, v95
    v_mfma_f32_32x32x16_bf16 v[80:95], a[48:51], v[168:171], 0
    v_exp_f32 v96, v64
    v_cvt_pk_bf16_f32 v118, v108, v109
    v_exp_f32 v97, v65
    v_cvt_pk_bf16_f32 v119, v110, v111
    v_exp_f32 v98, v66
    v_exp_f32 v99, v67
    v_mfma_f32_32x32x8_bf16 v[80:95], a[88:89], v[172:173], v[80:95]
    v_exp_f32 v100, v68
    v_cvt_pk_bf16_f32 v112, v96, v97
    v_exp_f32 v101, v69
    v_cvt_pk_bf16_f32 v113, v98, v99
    v_exp_f32 v102, v70
    v_exp_f32 v103, v71
    v_mfma_f32_32x32x16_bf16 v[144:159], a[188:191], v[116:119], v[144:159]
    v_exp_f32 v104, v72
    v_cvt_pk_bf16_f32 v114, v100, v101
    v_exp_f32 v105, v73
    v_cvt_pk_bf16_f32 v115, v102, v103
    v_exp_f32 v106, v74
    v_exp_f32 v107, v75
    v_mfma_f32_32x32x16_bf16 v[128:143], a[192:195], v[112:115], v[128:143]
    v_exp_f32 v108, v76
    v_cvt_pk_bf16_f32 v116, v104, v105
    v_exp_f32 v109, v77
    v_cvt_pk_bf16_f32 v117, v106, v107
    v_exp_f32 v110, v78
    v_exp_f32 v111, v79
    v_mfma_f32_32x32x16_bf16 v[64:79], a[52:55], v[160:163], 0
    v_exp_f32 v96, v80
    v_cvt_pk_bf16_f32 v118, v108, v109
    v_exp_f32 v97, v81
    v_cvt_pk_bf16_f32 v119, v110, v111
    v_exp_f32 v98, v82
    v_exp_f32 v99, v83
    v_mfma_f32_32x32x8_bf16 v[64:79], a[90:91], v[164:165], v[64:79]
    v_exp_f32 v100, v84
    v_cvt_pk_bf16_f32 v112, v96, v97
    v_exp_f32 v101, v85
    v_cvt_pk_bf16_f32 v113, v98, v99
    v_exp_f32 v102, v86
    v_exp_f32 v103, v87
    v_mfma_f32_32x32x16_bf16 v[128:143], a[196:199], v[116:119], v[128:143]
    v_exp_f32 v104, v88
    v_cvt_pk_bf16_f32 v114, v100, v101
    v_exp_f32 v105, v89
    v_cvt_pk_bf16_f32 v115, v102, v103
    v_exp_f32 v106, v90
    v_exp_f32 v107, v91
    buffer_load_dwordx4 v1, s[4:7], s43 offen offset:2048 sc1 lds
    v_mfma_f32_32x32x16_bf16 v[144:159], a[192:195], v[112:115], v[144:159]
    v_exp_f32 v108, v92
    v_cvt_pk_bf16_f32 v116, v104, v105
    v_exp_f32 v109, v93
    v_cvt_pk_bf16_f32 v117, v106, v107
    v_exp_f32 v110, v94
    v_exp_f32 v111, v95
    v_mfma_f32_32x32x16_bf16 v[80:95], a[52:55], v[168:171], 0
    v_exp_f32 v96, v64
    v_cvt_pk_bf16_f32 v118, v108, v109
    v_exp_f32 v97, v65
    v_cvt_pk_bf16_f32 v119, v110, v111
    v_exp_f32 v98, v66
    v_exp_f32 v99, v67
    v_mfma_f32_32x32x8_bf16 v[80:95], a[90:91], v[172:173], v[80:95]
    v_exp_f32 v100, v68
    v_cvt_pk_bf16_f32 v112, v96, v97
    v_exp_f32 v101, v69
    v_cvt_pk_bf16_f32 v113, v98, v99
    v_exp_f32 v102, v70
    v_exp_f32 v103, v71
    v_mfma_f32_32x32x16_bf16 v[144:159], a[196:199], v[116:119], v[144:159]
    v_exp_f32 v104, v72
    v_cvt_pk_bf16_f32 v114, v100, v101
    v_exp_f32 v105, v73
    v_cvt_pk_bf16_f32 v115, v102, v103
    v_exp_f32 v106, v74
    v_exp_f32 v107, v75
    v_mfma_f32_32x32x16_bf16 v[128:143], a[200:203], v[112:115], v[128:143]
    v_exp_f32 v108, v76
    v_cvt_pk_bf16_f32 v116, v104, v105
    v_exp_f32 v109, v77
    v_cvt_pk_bf16_f32 v117, v106, v107
    v_exp_f32 v110, v78
    v_exp_f32 v111, v79
    v_mfma_f32_32x32x16_bf16 v[64:79], a[56:59], v[160:163], 0
    v_exp_f32 v96, v80
    v_cvt_pk_bf16_f32 v118, v108, v109
    v_exp_f32 v97, v81
    v_cvt_pk_bf16_f32 v119, v110, v111
    v_exp_f32 v98, v82
    v_exp_f32 v99, v83
    v_mfma_f32_32x32x8_bf16 v[64:79], a[92:93], v[164:165], v[64:79]
    v_exp_f32 v100, v84
    v_cvt_pk_bf16_f32 v112, v96, v97
    v_exp_f32 v101, v85
    v_cvt_pk_bf16_f32 v113, v98, v99
    v_exp_f32 v102, v86
    v_exp_f32 v103, v87
    v_mfma_f32_32x32x16_bf16 v[128:143], a[204:207], v[116:119], v[128:143]
    v_exp_f32 v104, v88
    v_cvt_pk_bf16_f32 v114, v100, v101
    v_exp_f32 v105, v89
    v_cvt_pk_bf16_f32 v115, v102, v103
    v_exp_f32 v106, v90
    v_exp_f32 v107, v91
    v_mfma_f32_32x32x16_bf16 v[144:159], a[200:203], v[112:115], v[144:159]
    v_exp_f32 v108, v92
    v_cvt_pk_bf16_f32 v116, v104, v105
    v_exp_f32 v109, v93
    v_cvt_pk_bf16_f32 v117, v106, v107
    v_exp_f32 v110, v94
    v_exp_f32 v111, v95
    v_mfma_f32_32x32x16_bf16 v[80:95], a[56:59], v[168:171], 0
    v_exp_f32 v96, v64
    v_cvt_pk_bf16_f32 v118, v108, v109
    v_exp_f32 v97, v65
    v_cvt_pk_bf16_f32 v119, v110, v111
    v_exp_f32 v98, v66
    v_exp_f32 v99, v67
    v_mfma_f32_32x32x8_bf16 v[80:95], a[92:93], v[172:173], v[80:95]
    v_exp_f32 v100, v68
    v_cvt_pk_bf16_f32 v112, v96, v97
    v_exp_f32 v101, v69
    v_cvt_pk_bf16_f32 v113, v98, v99
    v_exp_f32 v102, v70
    v_exp_f32 v103, v71
    v_mfma_f32_32x32x16_bf16 v[144:159], a[204:207], v[116:119], v[144:159]
    v_exp_f32 v104, v72
    v_cvt_pk_bf16_f32 v114, v100, v101
    v_exp_f32 v105, v73
    v_cvt_pk_bf16_f32 v115, v102, v103
    v_exp_f32 v106, v74
    v_exp_f32 v107, v75
    buffer_load_dwordx4 v1, s[4:7], s43 offen offset:3072 sc1 lds
    v_mfma_f32_32x32x16_bf16 v[128:143], a[208:211], v[112:115], v[128:143]
    v_exp_f32 v108, v76
    v_cvt_pk_bf16_f32 v116, v104, v105
    v_exp_f32 v109, v77
    v_cvt_pk_bf16_f32 v117, v106, v107
    v_exp_f32 v110, v78
    v_exp_f32 v111, v79
    v_mfma_f32_32x32x16_bf16 v[64:79], a[60:63], v[160:163], 0
    v_exp_f32 v96, v80
    v_cvt_pk_bf16_f32 v118, v108, v109
    v_exp_f32 v97, v81
    v_cvt_pk_bf16_f32 v119, v110, v111
    v_exp_f32 v98, v82
    v_exp_f32 v99, v83
    v_mfma_f32_32x32x8_bf16 v[64:79], a[94:95], v[164:165], v[64:79]
    v_exp_f32 v100, v84
    v_cvt_pk_bf16_f32 v112, v96, v97
    v_exp_f32 v101, v85
    v_cvt_pk_bf16_f32 v113, v98, v99
    v_exp_f32 v102, v86
    v_exp_f32 v103, v87
    v_mfma_f32_32x32x16_bf16 v[128:143], a[212:215], v[116:119], v[128:143]
    v_exp_f32 v104, v88
    v_cvt_pk_bf16_f32 v114, v100, v101
    v_exp_f32 v105, v89
    v_cvt_pk_bf16_f32 v115, v102, v103
    v_exp_f32 v106, v90
    v_exp_f32 v107, v91
    ds_read_b128 v[160:163], v27
    ds_read_b64 v[164:165], v28 offset:1024
    v_mfma_f32_32x32x16_bf16 v[144:159], a[208:211], v[112:115], v[144:159]
    v_exp_f32 v108, v92
    v_cvt_pk_bf16_f32 v116, v104, v105
    v_exp_f32 v109, v93
    v_cvt_pk_bf16_f32 v117, v106, v107
    v_exp_f32 v110, v94
    v_exp_f32 v111, v95
    v_mfma_f32_32x32x16_bf16 v[80:95], a[60:63], v[168:171], 0
    v_exp_f32 v96, v64
    v_cvt_pk_bf16_f32 v118, v108, v109
    v_exp_f32 v97, v65
    v_cvt_pk_bf16_f32 v119, v110, v111
    v_exp_f32 v98, v66
    v_exp_f32 v99, v67
    v_mfma_f32_32x32x8_bf16 v[80:95], a[94:95], v[172:173], v[80:95]
    v_exp_f32 v100, v68
    v_cvt_pk_bf16_f32 v112, v96, v97
    v_exp_f32 v101, v69
    v_cvt_pk_bf16_f32 v113, v98, v99
    v_exp_f32 v102, v70
    v_exp_f32 v103, v71
    v_mfma_f32_32x32x16_bf16 v[144:159], a[212:215], v[116:119], v[144:159]
    v_exp_f32 v104, v72
    v_cvt_pk_bf16_f32 v114, v100, v101
    v_exp_f32 v105, v73
    v_cvt_pk_bf16_f32 v115, v102, v103
    v_exp_f32 v106, v74
    v_exp_f32 v107, v75
    ds_read_b128 v[168:171], v27 offset:1536
    ds_read_b64 v[172:173], v28 offset:2560
    v_mfma_f32_32x32x16_bf16 v[128:143], a[216:219], v[112:115], v[128:143]
    v_exp_f32 v108, v76
    v_cvt_pk_bf16_f32 v116, v104, v105
    v_exp_f32 v109, v77
    v_cvt_pk_bf16_f32 v117, v106, v107
    v_exp_f32 v110, v78
    v_exp_f32 v111, v79
    s_waitcnt lgkmcnt(2)
    v_mfma_f32_32x32x16_bf16 v[64:79], a[0:3], v[160:163], 0
    v_exp_f32 v96, v80
    v_cvt_pk_bf16_f32 v118, v108, v109
    v_exp_f32 v97, v81
    v_cvt_pk_bf16_f32 v119, v110, v111
    v_exp_f32 v98, v82
    v_exp_f32 v99, v83
    v_mfma_f32_32x32x8_bf16 v[64:79], a[64:65], v[164:165], v[64:79]
    v_exp_f32 v100, v84
    v_cvt_pk_bf16_f32 v112, v96, v97
    v_exp_f32 v101, v85
    v_cvt_pk_bf16_f32 v113, v98, v99
    v_exp_f32 v102, v86
    v_exp_f32 v103, v87
    s_add_u32 m0, s52, 1024
    s_add_u32 s43, s43, 1024
    v_mfma_f32_32x32x16_bf16 v[128:143], a[220:223], v[116:119], v[128:143]
    v_exp_f32 v104, v88
    v_cvt_pk_bf16_f32 v114, v100, v101
    v_exp_f32 v105, v89
    v_cvt_pk_bf16_f32 v115, v102, v103
    v_exp_f32 v106, v90
    v_exp_f32 v107, v91
    buffer_load_dwordx4 v1, s[4:7], s43 offen offset:3072 sc1 lds
    s_add_u32 s52, s52, 5120
    s_add_u32 s43, s43, 4096
    v_mfma_f32_32x32x16_bf16 v[144:159], a[216:219], v[112:115], v[144:159]
    v_exp_f32 v108, v92
    v_cvt_pk_bf16_f32 v116, v104, v105
    v_exp_f32 v109, v93
    v_cvt_pk_bf16_f32 v117, v106, v107
    v_exp_f32 v110, v94
    v_exp_f32 v111, v95
    s_add_u32 s44, s44, 1
    s_cmp_lt_u32 s44, 3
    s_cbranch_scc1 L_att_loop
    v_cvt_pk_bf16_f32 v118, v108, v109
    v_cvt_pk_bf16_f32 v119, v110, v111
    s_cmp_eq_u32 s22, 0
    s_cselect_b32 s47, 81920, 0
    s_add_u32 s47, s47, 6795264
    v_mfma_f32_32x32x16_bf16 v[144:159], a[220:223], v[116:119], v[144:159]
    s_add_u32 s45, s64, s47
    s_add_u32 s46, s65, s47
    s_add_u32 s52, s67, 12845056
    s_lshl_b32 s53, s24, 3
    s_add_u32 s53, s53, 12845056
    v_mov_b32 v12, 0x71800000
    v_mov_b32 v14, 0
    v_mov_b32 v15, 0
    v_mov_b32 v4, s20
    v_mov_b32 v5, s21
    v_accvgpr_read_b32 v7, a246
    v_mov_b32 v8, v136
    v_mov_b32 v9, v136
    v_mov_b32 v10, v152
    v_mov_b32 v11, v152
    v_permlane32_swap_b32 v8, v9
    s_nop 0
    v_permlane32_swap_b32 v10, v11
    v_cmp_nlt_f32 s[48:49], v9, v12
    v_cmp_nlt_f32 s[50:51], v11, v12
    v_rcp_f32 v9, v9
    v_rcp_f32 v11, v11
    v_pk_mul_f32 v[128:129], v[128:129], v[8:9] op_sel:[0,1] op_sel_hi:[1,1]
    v_pk_mul_f32 v[130:131], v[130:131], v[8:9] op_sel:[0,1] op_sel_hi:[1,1]
    v_pk_mul_f32 v[132:133], v[132:133], v[8:9] op_sel:[0,1] op_sel_hi:[1,1]
    v_pk_mul_f32 v[134:135], v[134:135], v[8:9] op_sel:[0,1] op_sel_hi:[1,1]
    v_cvt_pk_bf16_f32 v100, v128, v129
    v_cvt_pk_bf16_f32 v101, v130, v131
    v_cvt_pk_bf16_f32 v102, v132, v133
    v_cvt_pk_bf16_f32 v103, v134, v135
    buffer_store_dwordx4 v[100:103], v1, s[88:91], s45 offen offset:0 sc1
    v_pk_mul_f32 v[144:145], v[144:145], v[10:11] op_sel:[0,1] op_sel_hi:[1,1]
    v_pk_mul_f32 v[146:147], v[146:147], v[10:11] op_sel:[0,1] op_sel_hi:[1,1]
    v_pk_mul_f32 v[148:149], v[148:149], v[10:11] op_sel:[0,1] op_sel_hi:[1,1]
    v_pk_mul_f32 v[150:151], v[150:151], v[10:11] op_sel:[0,1] op_sel_hi:[1,1]
    v_cvt_pk_bf16_f32 v104, v144, v145
    v_cvt_pk_bf16_f32 v105, v146, v147
    v_cvt_pk_bf16_f32 v106, v148, v149
    v_cvt_pk_bf16_f32 v107, v150, v151
    buffer_store_dwordx4 v[104:107], v1, s[88:91], s45 offen offset:1024 sc1
    s_mov_b32 exec_hi, 0
    v_pk_mul_f32 v[136:137], v[136:137], v[8:9] op_sel:[0,1] op_sel_hi:[1,1]
    v_cvt_pk_bf16_f32 v108, v136, v137
    v_pk_mul_f32 v[138:139], v[138:139], v[8:9] op_sel:[0,1] op_sel_hi:[1,1]
    v_cvt_pk_bf16_f32 v109, v138, v139
    v_pk_mul_f32 v[152:153], v[152:153], v[10:11] op_sel:[0,1] op_sel_hi:[1,1]
    v_cvt_pk_bf16_f32 v110, v152, v153
    v_pk_mul_f32 v[154:155], v[154:155], v[10:11] op_sel:[0,1] op_sel_hi:[1,1]
    v_cvt_pk_bf16_f32 v111, v154, v155
    buffer_store_dwordx4 v[108:111], v1, s[88:91], s46 offen sc1
    v_pk_fma_f32 v[14:15], v[136:137], 0, v[14:15]
    v_pk_fma_f32 v[14:15], v[138:139], 0, v[14:15]
    v_pk_fma_f32 v[14:15], v[152:153], 0, v[14:15]
    v_pk_fma_f32 v[14:15], v[154:155], 0, v[14:15]
    s_mov_b32 exec_hi, -1
    v_pk_fma_f32 v[14:15], v[128:129], 0, v[14:15]
    v_pk_fma_f32 v[14:15], v[130:131], 0, v[14:15]
    v_pk_fma_f32 v[14:15], v[132:133], 0, v[14:15]
    v_pk_fma_f32 v[14:15], v[134:135], 0, v[14:15]
    v_pk_fma_f32 v[14:15], v[144:145], 0, v[14:15]
    v_pk_fma_f32 v[14:15], v[146:147], 0, v[14:15]
    v_pk_fma_f32 v[14:15], v[148:149], 0, v[14:15]
    v_pk_fma_f32 v[14:15], v[150:151], 0, v[14:15]
    v_cmp_u_f32 vcc, v14, v15
    s_or_b64 s[48:49], s[48:49], s[50:51]
    s_or_b64 s[48:49], s[48:49], vcc
    s_cmp_lg_u64 s[48:49], 0
    s_cselect_b32 s48, 1, 0
    s_lshl_b32 s49, s22, 2
    s_add_u32 s49, s49, 158464
    v_mov_b32 v16, s49
    v_mov_b32 v17, s48
    v_mov_b32 v18, 158464
    ds_write_b32 v16, v17
    s_waitcnt lgkmcnt(0)
    s_barrier
    ds_read_b128 v[16:19], v18
    s_waitcnt lgkmcnt(0)
    v_or_b32 v16, v16, v17
    v_or3_b32 v16, v16, v18, v19
    s_nop 0
    v_readfirstlane_b32 s48, v16
    s_andn2_b32 s48, s48, s59
    s_cmp_lg_u32 s48, 0
    s_cbranch_scc1 L_fallback
    s_cmp_eq_u32 s22, 3
    s_waitcnt vmcnt(0)
    s_barrier
    s_cbranch_scc1 L_p5_b
    s_cmp_eq_u32 s27, 0
    s_cbranch_scc0 L_p5_c
    s_mul_i32 s54, s22, 17408
    s_min_u32 s54, s54, 33792
    s_add_u32 s55, s77, 6342656
    s_add_u32 s55, s55, s54
    s_add_u32 s54, s54, 102400
    s_mov_b32 m0, s54
    s_nop 0
    buffer_load_dwordx4 v1, s[4:7], s55 offen offset:0 sc1 lds
    buffer_load_dwordx4 v1, s[4:7], s55 offen offset:1024 sc1 lds
    buffer_load_dwordx4 v1, s[4:7], s55 offen offset:2048 sc1 lds
    buffer_load_dwordx4 v1, s[4:7], s55 offen offset:3072 sc1 lds
    s_add_u32 s54, s54, 4096
    s_add_u32 s55, s55, 4096
    s_mov_b32 m0, s54
    s_nop 0
    buffer_load_dwordx4 v1, s[4:7], s55 offen offset:0 sc1 lds
    buffer_load_dwordx4 v1, s[4:7], s55 offen offset:1024 sc1 lds
    buffer_load_dwordx4 v1, s[4:7], s55 offen offset:2048 sc1 lds
    buffer_load_dwordx4 v1, s[4:7], s55 offen offset:3072 sc1 lds
    s_add_u32 s54, s54, 4096
    s_add_u32 s55, s55, 4096
    s_mov_b32 m0, s54
    s_nop 0
    buffer_load_dwordx4 v1, s[4:7], s55 offen offset:0 sc1 lds
    buffer_load_dwordx4 v1, s[4:7], s55 offen offset:1024 sc1 lds
    buffer_load_dwordx4 v1, s[4:7], s55 offen offset:2048 sc1 lds
    buffer_load_dwordx4 v1, s[4:7], s55 offen offset:3072 sc1 lds
    s_add_u32 s54, s54, 4096
    s_add_u32 s55, s55, 4096
    s_mov_b32 m0, s54
    s_nop 0
    buffer_load_dwordx4 v1, s[4:7], s55 offen offset:0 sc1 lds
    buffer_load_dwordx4 v1, s[4:7], s55 offen offset:1024 sc1 lds
    buffer_load_dwordx4 v1, s[4:7], s55 offen offset:2048 sc1 lds
    buffer_load_dwordx4 v1, s[4:7], s55 offen offset:3072 sc1 lds
    s_add_u32 s54, s54, 4096
    s_add_u32 s55, s55, 4096
    s_mov_b32 m0, s54
    s_nop 0
    buffer_load_dwordx4 v1, s[4:7], s55 offen offset:0 sc1 lds
    s_branch L_p5_c
L_p5_b:
    s_mov_b64 exec, 0xff
    buffer_store_dwordx2 v[4:5], v7, s[88:91], s53 offen sc1
    s_mov_b64 exec, -1
L_p5_c:
    v_accvgpr_read_b32 v64, a224
    v_accvgpr_read_b32 v65, a225
    v_accvgpr_read_b32 v66, a226
    v_accvgpr_read_b32 v67, a227
    v_accvgpr_read_b32 v68, a228
    v_accvgpr_read_b32 v69, a229
    v_accvgpr_read_b32 v70, a230
    v_accvgpr_read_b32 v71, a231
    v_accvgpr_read_b32 v72, a232
    v_accvgpr_read_b32 v73, a233
    v_accvgpr_read_b32 v74, a234
    v_accvgpr_read_b32 v75, a235
    v_accvgpr_read_b32 v76, a236
    v_accvgpr_read_b32 v77, a237
    v_accvgpr_read_b32 v78, a238
    v_accvgpr_read_b32 v79, a239
    v_accvgpr_read_b32 v80, a240
    v_accvgpr_read_b32 v81, a241
    v_accvgpr_read_b32 v82, a242
    v_accvgpr_read_b32 v83, a243
    s_add_u32 s40, s66, 6815744
    s_cmp_eq_u32 s22, 3
    s_cbranch_scc0 L_p5_d
    s_mov_b64 exec, 0xff
    s_mov_b32 s36, 0
L_poll_33:
    buffer_load_dwordx2 v[4:5], v32, s[88:91], s52 offen sc1
    s_add_u32 s36, s36, 1
    s_cmp_gt_u32 s36, 2097152
    s_cbranch_scc1 L_abort
    s_waitcnt vmcnt(0)
    v_cmp_ne_u64 vcc, s[20:21], v[4:5]
    s_cbranch_vccnz L_poll_33
    s_mov_b64 exec, -1
L_p5_d:
    s_barrier
    buffer_load_dwordx4 a[0:3], v1, s[88:91], s40 offen offset:0 sc1
    buffer_load_dwordx4 a[4:7], v1, s[88:91], s40 offen offset:1024 sc1
    buffer_load_dwordx4 a[8:11], v1, s[88:91], s40 offen offset:2048 sc1
    buffer_load_dwordx4 a[12:15], v1, s[88:91], s40 offen offset:3072 sc1
    s_add_u32 s40, s40, 4096
    buffer_load_dwordx4 a[16:19], v1, s[88:91], s40 offen offset:0 sc1
    buffer_load_dwordx4 a[20:23], v1, s[88:91], s40 offen offset:1024 sc1
    buffer_load_dwordx4 a[24:27], v1, s[88:91], s40 offen offset:2048 sc1
    buffer_load_dwordx4 a[28:31], v1, s[88:91], s40 offen offset:3072 sc1
    s_add_u32 s40, s40, 4096
    buffer_load_dwordx4 a[32:35], v1, s[88:91], s40 offen offset:0 sc1
    buffer_load_dwordx4 a[36:39], v1, s[88:91], s40 offen offset:1024 sc1
    s_add_u32 s45, s64, 9437184
    s_add_u32 s46, s65, 9437184
    s_add_u32 s48, s76, 12058624
    v_mov_b32 v4, s20
    v_mov_b32 v5, s21
    v_accvgpr_read_b32 v7, a247
    s_and_b32 s53, s23, 1
    s_lshl_b32 s53, s53, 6
    s_lshl_b32 s49, s24, 3
    s_add_u32 s53, s53, s49
    s_add_u32 s53, s53, 12910592
    s_mul_i32 s50, s22, 13312
    s_min_u32 s50, s50, 37888
    s_add_u32 s51, s78, s50
    s_add_u32 s51, s51, 1048576
    s_cmp_eq_u32 s27, 1
    s_cbranch_scc1 L_final
    ds_read_b128 v[128:131], v1 offset:0
    ds_read_b128 v[132:135], v1 offset:1024
    ds_read_b128 v[136:139], v1 offset:2048
    ds_read_b128 v[140:143], v1 offset:3072
    ds_read_b128 v[144:147], v1 offset:4096
    ds_read_b128 v[148:151], v1 offset:5120
    ds_read_b128 v[152:155], v1 offset:6144
    ds_read_b128 v[156:159], v1 offset:7168
    ds_read_b128 v[160:163], v1 offset:8192
    ds_read_b128 v[164:167], v1 offset:9216
    s_waitcnt vmcnt(9) lgkmcnt(5)
    v_mfma_f32_16x16x32_bf16 v[64:67], v[128:131], a[0:3], v[64:67]
    ds_read_b128 v[168:171], v1 offset:10240
    v_mfma_f32_16x16x32_bf16 v[68:71], v[132:135], a[0:3], v[68:71]
    ds_read_b128 v[172:175], v1 offset:11264
    buffer_load_dwordx4 a[40:43], v1, s[88:91], s40 offen offset:2048 sc1
    v_mfma_f32_16x16x32_bf16 v[72:75], v[136:139], a[0:3], v[72:75]
    ds_read_b128 v[176:179], v1 offset:12288
    v_mfma_f32_16x16x32_bf16 v[76:79], v[140:143], a[0:3], v[76:79]
    ds_read_b128 v[180:183], v1 offset:13312
    v_mfma_f32_16x16x32_bf16 v[80:83], v[144:147], a[0:3], v[80:83]
    ds_read_b128 v[184:187], v1 offset:14336
    s_waitcnt vmcnt(9) lgkmcnt(5)
    v_mfma_f32_16x16x32_bf16 v[64:67], v[148:151], a[4:7], v[64:67]
    ds_read_b128 v[128:131], v1 offset:15360
    v_mfma_f32_16x16x32_bf16 v[68:71], v[152:155], a[4:7], v[68:71]
    ds_read_b128 v[132:135], v1 offset:16384
    buffer_load_dwordx4 a[44:47], v1, s[88:91], s40 offen offset:3072 sc1
    v_mfma_f32_16x16x32_bf16 v[72:75], v[156:159], a[4:7], v[72:75]
    ds_read_b128 v[136:139], v1 offset:17408
    v_mfma_f32_16x16x32_bf16 v[76:79], v[160:163], a[4:7], v[76:79]
    ds_read_b128 v[140:143], v1 offset:18432
    v_mfma_f32_16x16x32_bf16 v[80:83], v[164:167], a[4:7], v[80:83]
    ds_read_b128 v[144:147], v1 offset:19456
    s_waitcnt vmcnt(9) lgkmcnt(5)
    v_mfma_f32_16x16x32_bf16 v[64:67], v[168:171], a[8:11], v[64:67]
    ds_read_b128 v[148:151], v1 offset:20480
    v_mfma_f32_16x16x32_bf16 v[68:71], v[172:175], a[8:11], v[68:71]
    ds_read_b128 v[152:155], v1 offset:21504
    s_add_u32 s40, s40, 4096
    buffer_load_dwordx4 a[48:51], v1, s[88:91], s40 offen offset:0 sc1
    v_mfma_f32_16x16x32_bf16 v[72:75], v[176:179], a[8:11], v[72:75]
    ds_read_b128 v[156:159], v1 offset:22528
    v_mfma_f32_16x16x32_bf16 v[76:79], v[180:183], a[8:11], v[76:79]
    ds_read_b128 v[160:163], v1 offset:23552
    v_mfma_f32_16x16x32_bf16 v[80:83], v[184:187], a[8:11], v[80:83]
    ds_read_b128 v[164:167], v1 offset:24576
    s_waitcnt vmcnt(9) lgkmcnt(5)
    v_mfma_f32_16x16x32_bf16 v[64:67], v[128:131], a[12:15], v[64:67]
    ds_read_b128 v[168:171], v1 offset:25600
    v_mfma_f32_16x16x32_bf16 v[68:71], v[132:135], a[12:15], v[68:71]
    ds_read_b128 v[172:175], v1 offset:26624
    buffer_load_dwordx4 a[52:55], v1, s[88:91], s40 offen offset:1024 sc1
    v_mfma_f32_16x16x32_bf16 v[72:75], v[136:139], a[12:15], v[72:75]
    ds_read_b128 v[176:179], v1 offset:27648
    v_mfma_f32_16x16x32_bf16 v[76:79], v[140:143], a[12:15], v[76:79]
    ds_read_b128 v[180:183], v1 offset:28672
    v_mfma_f32_16x16x32_bf16 v[80:83], v[144:147], a[12:15], v[80:83]
    ds_read_b128 v[184:187], v1 offset:29696
    s_waitcnt vmcnt(9) lgkmcnt(5)
    v_mfma_f32_16x16x32_bf16 v[64:67], v[148:151], a[16:19], v[64:67]
    ds_read_b128 v[128:131], v1 offset:30720
    v_mfma_f32_16x16x32_bf16 v[68:71], v[152:155], a[16:19], v[68:71]
    ds_read_b128 v[132:135], v1 offset:31744
    buffer_load_dwordx4 a[56:59], v1, s[88:91], s40 offen offset:2048 sc1
    v_mfma_f32_16x16x32_bf16 v[72:75], v[156:159], a[16:19], v[72:75]
    ds_read_b128 v[136:139], v1 offset:32768
    v_mfma_f32_16x16x32_bf16 v[76:79], v[160:163], a[16:19], v[76:79]
    ds_read_b128 v[140:143], v1 offset:33792
    v_mfma_f32_16x16x32_bf16 v[80:83], v[164:167], a[16:19], v[80:83]
    ds_read_b128 v[144:147], v1 offset:34816
    s_waitcnt vmcnt(9) lgkmcnt(5)
    v_mfma_f32_16x16x32_bf16 v[64:67], v[168:171], a[20:23], v[64:67]
    ds_read_b128 v[148:151], v1 offset:35840
    v_mfma_f32_16x16x32_bf16 v[68:71], v[172:175], a[20:23], v[68:71]
    ds_read_b128 v[152:155], v1 offset:36864
    buffer_load_dwordx4 a[60:63], v1, s[88:91], s40 offen offset:3072 sc1
    v_mfma_f32_16x16x32_bf16 v[72:75], v[176:179], a[20:23], v[72:75]
    ds_read_b128 v[156:159], v1 offset:37888
    v_mfma_f32_16x16x32_bf16 v[76:79], v[180:183], a[20:23], v[76:79]
    ds_read_b128 v[160:163], v1 offset:38912
    v_mfma_f32_16x16x32_bf16 v[80:83], v[184:187], a[20:23], v[80:83]
    ds_read_b128 v[164:167], v1 offset:39936
    s_waitcnt vmcnt(9) lgkmcnt(5)
    v_mfma_f32_16x16x32_bf16 v[64:67], v[128:131], a[24:27], v[64:67]
    ds_read_b128 v[168:171], v1 offset:40960
    v_mfma_f32_16x16x32_bf16 v[68:71], v[132:135], a[24:27], v[68:71]
    ds_read_b128 v[172:175], v1 offset:41984
    s_add_u32 s40, s40, 4096
    buffer_load_dwordx4 a[64:67], v1, s[88:91], s40 offen offset:0 sc1
    v_mfma_f32_16x16x32_bf16 v[72:75], v[136:139], a[24:27], v[72:75]
    ds_read_b128 v[176:179], v1 offset:43008
    v_mfma_f32_16x16x32_bf16 v[76:79], v[140:143], a[24:27], v[76:79]
    ds_read_b128 v[180:183], v1 offset:44032
    v_mfma_f32_16x16x32_bf16 v[80:83], v[144:147], a[24:27], v[80:83]
    ds_read_b128 v[184:187], v1 offset:45056
    s_waitcnt vmcnt(9) lgkmcnt(5)
    v_mfma_f32_16x16x32_bf16 v[64:67], v[148:151], a[28:31], v[64:67]
    ds_read_b128 v[128:131], v1 offset:46080
    v_mfma_f32_16x16x32_bf16 v[68:71], v[152:155], a[28:31], v[68:71]
    ds_read_b128 v[132:135], v1 offset:47104
    buffer_load_dwordx4 a[68:71], v1, s[88:91], s40 offen offset:1024 sc1
    v_mfma_f32_16x16x32_bf16 v[72:75], v[156:159], a[28:31], v[72:75]
    ds_read_b128 v[136:139], v1 offset:48128
    v_mfma_f32_16x16x32_bf16 v[76:79], v[160:163], a[28:31], v[76:79]
    ds_read_b128 v[140:143], v1 offset:49152
    v_mfma_f32_16x16x32_bf16 v[80:83], v[164:167], a[28:31], v[80:83]
    ds_read_b128 v[144:147], v1 offset:50176
    s_waitcnt vmcnt(9) lgkmcnt(5)
    s_barrier
    v_mfma_f32_16x16x32_bf16 v[64:67], v[168:171], a[32:35], v[64:67]
    ds_read_b128 v[148:151], v34 offset:0
    v_mfma_f32_16x16x32_bf16 v[68:71], v[172:175], a[32:35], v[68:71]
    ds_read_b128 v[152:155], v34 offset:1024
    buffer_load_dwordx4 a[72:75], v1, s[88:91], s40 offen offset:2048 sc1
    v_mfma_f32_16x16x32_bf16 v[72:75], v[176:179], a[32:35], v[72:75]
    ds_read_b128 v[156:159], v34 offset:2048
    v_mfma_f32_16x16x32_bf16 v[76:79], v[180:183], a[32:35], v[76:79]
    ds_read_b128 v[160:163], v34 offset:3072
    v_mfma_f32_16x16x32_bf16 v[80:83], v[184:187], a[32:35], v[80:83]
    ds_read_b128 v[164:167], v34 offset:4096
    s_waitcnt vmcnt(9) lgkmcnt(5)
    v_mfma_f32_16x16x32_bf16 v[64:67], v[128:131], a[36:39], v[64:67]
    ds_read_b128 v[168:171], v34 offset:5120
    v_mfma_f32_16x16x32_bf16 v[68:71], v[132:135], a[36:39], v[68:71]
    ds_read_b128 v[172:175], v34 offset:6144
    buffer_load_dwordx4 a[76:79], v1, s[88:91], s40 offen offset:3072 sc1
    v_mfma_f32_16x16x32_bf16 v[72:75], v[136:139], a[36:39], v[72:75]
    ds_read_b128 v[176:179], v34 offset:7168
    v_mfma_f32_16x16x32_bf16 v[76:79], v[140:143], a[36:39], v[76:79]
    ds_read_b128 v[180:183], v34 offset:8192
    v_mfma_f32_16x16x32_bf16 v[80:83], v[144:147], a[36:39], v[80:83]
    ds_read_b128 v[184:187], v34 offset:9216
    s_waitcnt vmcnt(9) lgkmcnt(5)
    v_mfma_f32_16x16x32_bf16 v[64:67], v[148:151], a[40:43], v[64:67]
    ds_read_b128 v[128:131], v34 offset:10240
    v_mfma_f32_16x16x32_bf16 v[68:71], v[152:155], a[40:43], v[68:71]
    ds_read_b128 v[132:135], v34 offset:11264
    v_mfma_f32_16x16x32_bf16 v[72:75], v[156:159], a[40:43], v[72:75]
    ds_read_b128 v[136:139], v34 offset:12288
    v_mfma_f32_16x16x32_bf16 v[76:79], v[160:163], a[40:43], v[76:79]
    ds_read_b128 v[140:143], v34 offset:13312
    v_mfma_f32_16x16x32_bf16 v[80:83], v[164:167], a[40:43], v[80:83]
    ds_read_b128 v[144:147], v34 offset:14336
    s_barrier
    s_mov_b32 m0, s50
    s_nop 0
    buffer_load_dwordx4 v1, s[4:7], s51 offen offset:0 sc1 lds
    buffer_load_dwordx4 v1, s[4:7], s51 offen offset:1024 sc1 lds
    s_waitcnt vmcnt(10) lgkmcnt(5)
    v_mfma_f32_16x16x32_bf16 v[64:67], v[168:171], a[44:47], v[64:67]
    ds_read_b128 v[148:151], v34 offset:15360
    v_mfma_f32_16x16x32_bf16 v[68:71], v[172:175], a[44:47], v[68:71]
    ds_read_b128 v[152:155], v34 offset:16384
    v_mfma_f32_16x16x32_bf16 v[72:75], v[176:179], a[44:47], v[72:75]
    ds_read_b128 v[156:159], v34 offset:17408
    v_mfma_f32_16x16x32_bf16 v[76:79], v[180:183], a[44:47], v[76:79]
    ds_read_b128 v[160:163], v34 offset:18432
    v_mfma_f32_16x16x32_bf16 v[80:83], v[184:187], a[44:47], v[80:83]
    ds_read_b128 v[164:167], v34 offset:19456
    buffer_load_dwordx4 v1, s[4:7], s51 offen offset:2048 sc1 lds
    s_waitcnt vmcnt(10) lgkmcnt(5)
    v_mfma_f32_16x16x32_bf16 v[64:67], v[128:131], a[48:51], v[64:67]
    ds_read_b128 v[168:171], v34 offset:20480
    v_mfma_f32_16x16x32_bf16 v[68:71], v[132:135], a[48:51], v[68:71]
    ds_read_b128 v[172:175], v34 offset:21504
    v_mfma_f32_16x16x32_bf16 v[72:75], v[136:139], a[48:51], v[72:75]
    ds_read_b128 v[176:179], v34 offset:22528
    v_mfma_f32_16x16x32_bf16 v[76:79], v[140:143], a[48:51], v[76:79]
    ds_read_b128 v[180:183], v34 offset:23552
    v_mfma_f32_16x16x32_bf16 v[80:83], v[144:147], a[48:51], v[80:83]
    ds_read_b128 v[184:187], v34 offset:24576
    buffer_load_dwordx4 v1, s[4:7], s51 offen offset:3072 sc1 lds
    s_waitcnt vmcnt(10) lgkmcnt(5)
    v_mfma_f32_16x16x32_bf16 v[64:67], v[148:151], a[52:55], v[64:67]
    ds_read_b128 v[128:131], v34 offset:25600
    v_mfma_f32_16x16x32_bf16 v[68:71], v[152:155], a[52:55], v[68:71]
    ds_read_b128 v[132:135], v34 offset:26624
    v_mfma_f32_16x16x32_bf16 v[72:75], v[156:159], a[52:55], v[72:75]
    ds_read_b128 v[136:139], v34 offset:27648
    v_mfma_f32_16x16x32_bf16 v[76:79], v[160:163], a[52:55], v[76:79]
    ds_read_b128 v[140:143], v34 offset:28672
    v_mfma_f32_16x16x32_bf16 v[80:83], v[164:167], a[52:55], v[80:83]
    ds_read_b128 v[144:147], v34 offset:29696
    s_add_u32 s50, s50, 4096
    s_add_u32 s51, s51, 4096
    s_mov_b32 m0, s50
    s_nop 0
    buffer_load_dwordx4 v1, s[4:7], s51 offen offset:0 sc1 lds
    buffer_load_dwordx4 v1, s[4:7], s51 offen offset:1024 sc1 lds
    s_waitcnt vmcnt(11) lgkmcnt(5)
    v_mfma_f32_16x16x32_bf16 v[64:67], v[168:171], a[56:59], v[64:67]
    ds_read_b128 v[148:151], v34 offset:30720
    v_mfma_f32_16x16x32_bf16 v[68:71], v[172:175], a[56:59], v[68:71]
    ds_read_b128 v[152:155], v34 offset:31744
    v_mfma_f32_16x16x32_bf16 v[72:75], v[176:179], a[56:59], v[72:75]
    ds_read_b128 v[156:159], v34 offset:32768
    v_mfma_f32_16x16x32_bf16 v[76:79], v[180:183], a[56:59], v[76:79]
    ds_read_b128 v[160:163], v34 offset:33792
    v_mfma_f32_16x16x32_bf16 v[80:83], v[184:187], a[56:59], v[80:83]
    ds_read_b128 v[164:167], v34 offset:34816
    buffer_load_dwordx4 v1, s[4:7], s51 offen offset:2048 sc1 lds
    s_waitcnt vmcnt(11) lgkmcnt(5)
    v_mfma_f32_16x16x32_bf16 v[64:67], v[128:131], a[60:63], v[64:67]
    ds_read_b128 v[168:171], v34 offset:35840
    v_mfma_f32_16x16x32_bf16 v[68:71], v[132:135], a[60:63], v[68:71]
    ds_read_b128 v[172:175], v34 offset:36864
    v_mfma_f32_16x16x32_bf16 v[72:75], v[136:139], a[60:63], v[72:75]
    ds_read_b128 v[176:179], v34 offset:37888
    v_mfma_f32_16x16x32_bf16 v[76:79], v[140:143], a[60:63], v[76:79]
    ds_read_b128 v[180:183], v34 offset:38912
    v_mfma_f32_16x16x32_bf16 v[80:83], v[144:147], a[60:63], v[80:83]
    ds_read_b128 v[184:187], v34 offset:39936
    buffer_load_dwordx4 v1, s[4:7], s51 offen offset:3072 sc1 lds
    s_waitcnt vmcnt(11) lgkmcnt(5)
    v_mfma_f32_16x16x32_bf16 v[64:67], v[148:151], a[64:67], v[64:67]
    ds_read_b128 v[128:131], v34 offset:40960
    v_mfma_f32_16x16x32_bf16 v[68:71], v[152:155], a[64:67], v[68:71]
    ds_read_b128 v[132:135], v34 offset:41984
    v_mfma_f32_16x16x32_bf16 v[72:75], v[156:159], a[64:67], v[72:75]
    ds_read_b128 v[136:139], v34 offset:43008
    v_mfma_f32_16x16x32_bf16 v[76:79], v[160:163], a[64:67], v[76:79]
    ds_read_b128 v[140:143], v34 offset:44032
    v_mfma_f32_16x16x32_bf16 v[80:83], v[164:167], a[64:67], v[80:83]
    ds_read_b128 v[144:147], v34 offset:45056
    s_add_u32 s50, s50, 4096
    s_add_u32 s51, s51, 4096
    s_mov_b32 m0, s50
    s_nop 0
    buffer_load_dwordx4 v1, s[4:7], s51 offen offset:0 sc1 lds
    buffer_load_dwordx4 v1, s[4:7], s51 offen offset:1024 sc1 lds
    s_waitcnt vmcnt(12) lgkmcnt(5)
    v_mfma_f32_16x16x32_bf16 v[64:67], v[168:171], a[68:71], v[64:67]
    ds_read_b128 v[148:151], v34 offset:46080
    v_mfma_f32_16x16x32_bf16 v[68:71], v[172:175], a[68:71], v[68:71]
    ds_read_b128 v[152:155], v34 offset:47104
    v_mfma_f32_16x16x32_bf16 v[72:75], v[176:179], a[68:71], v[72:75]
    ds_read_b128 v[156:159], v34 offset:48128
    v_mfma_f32_16x16x32_bf16 v[76:79], v[180:183], a[68:71], v[76:79]
    ds_read_b128 v[160:163], v34 offset:49152
    v_mfma_f32_16x16x32_bf16 v[80:83], v[184:187], a[68:71], v[80:83]
    ds_read_b128 v[164:167], v34 offset:50176
    buffer_load_dwordx4 v1, s[4:7], s51 offen offset:2048 sc1 lds
    s_waitcnt vmcnt(12) lgkmcnt(5)
    v_mfma_f32_16x16x32_bf16 v[64:67], v[128:131], a[72:75], v[64:67]
    v_mfma_f32_16x16x32_bf16 v[68:71], v[132:135], a[72:75], v[68:71]
    v_mfma_f32_16x16x32_bf16 v[72:75], v[136:139], a[72:75], v[72:75]
    v_mfma_f32_16x16x32_bf16 v[76:79], v[140:143], a[72:75], v[76:79]
    v_mfma_f32_16x16x32_bf16 v[80:83], v[144:147], a[72:75], v[80:83]
    buffer_load_dwordx4 v1, s[4:7], s51 offen offset:3072 sc1 lds
    s_waitcnt vmcnt(12) lgkmcnt(0)
    v_mfma_f32_16x16x32_bf16 v[64:67], v[148:151], a[76:79], v[64:67]
    v_mfma_f32_16x16x32_bf16 v[68:71], v[152:155], a[76:79], v[68:71]
    v_mfma_f32_16x16x32_bf16 v[72:75], v[156:159], a[76:79], v[72:75]
    v_mfma_f32_16x16x32_bf16 v[76:79], v[160:163], a[76:79], v[76:79]
    v_mfma_f32_16x16x32_bf16 v[80:83], v[164:167], a[76:79], v[80:83]
    s_add_u32 s50, s50, 4096
    s_add_u32 s51, s51, 4096
    s_mov_b32 m0, s50
    s_nop 0
    buffer_load_dwordx4 v1, s[4:7], s51 offen offset:0 sc1 lds
    v_cvt_pk_bf16_f32 v100, v64, v65
    v_cvt_pk_bf16_f32 v101, v66, v67
    v_cvt_pk_bf16_f32 v102, v68, v69
    v_cvt_pk_bf16_f32 v103, v70, v71
    buffer_store_dwordx4 v[100:103], v1, s[88:91], s45 offen sc1
    v_cvt_pk_bf16_f32 v104, v72, v73
    v_cvt_pk_bf16_f32 v105, v74, v75
    v_cvt_pk_bf16_f32 v106, v76, v77
    v_cvt_pk_bf16_f32 v107, v78, v79
    buffer_store_dwordx4 v[104:107], v1, s[88:91], s45 offen offset:1024 sc1
    v_cvt_pk_bf16_f32 v108, v80, v81
    v_cvt_pk_bf16_f32 v109, v82, v83
    v_mov_b32 v112, v108
    v_mov_b32 v113, v109
    v_mov_b32 v114, v112
    v_mov_b32 v115, v113
    s_nop 0
    v_permlane16_swap_b32 v112, v114
    v_permlane16_swap_b32 v113, v115
    s_mov_b32 exec_lo, 0xffff
    s_mov_b32 exec_hi, 0xffff
    buffer_store_dwordx4 v[112:115], v53, s[88:91], s46 offen sc1
    s_mov_b64 exec, -1
    v_pk_add_f32 v[8:9], v[64:65], v[66:67]
    v_pk_mul_f32 v[10:11], v[64:65], v[64:65]
    v_pk_fma_f32 v[10:11], v[66:67], v[66:67], v[10:11]
    v_pk_add_f32 v[8:9], v[8:9], v[68:69]
    v_pk_fma_f32 v[10:11], v[68:69], v[68:69], v[10:11]
    v_pk_add_f32 v[8:9], v[8:9], v[70:71]
    v_pk_fma_f32 v[10:11], v[70:71], v[70:71], v[10:11]
    v_pk_add_f32 v[8:9], v[8:9], v[72:73]
    v_pk_fma_f32 v[10:11], v[72:73], v[72:73], v[10:11]
    v_pk_add_f32 v[8:9], v[8:9], v[74:75]
    v_pk_fma_f32 v[10:11], v[74:75], v[74:75], v[10:11]
    v_pk_add_f32 v[8:9], v[8:9], v[76:77]
    v_pk_fma_f32 v[10:11], v[76:77], v[76:77], v[10:11]
    v_pk_add_f32 v[8:9], v[8:9], v[78:79]
    v_pk_fma_f32 v[10:11], v[78:79], v[78:79], v[10:11]
    v_pk_add_f32 v[8:9], v[8:9], v[80:81]
    v_pk_fma_f32 v[10:11], v[80:81], v[80:81], v[10:11]
    v_pk_add_f32 v[8:9], v[8:9], v[82:83]
    v_pk_fma_f32 v[10:11], v[82:83], v[82:83], v[10:11]
    v_add_f32 v8, v8, v9
    v_add_f32 v9, v10, v11
    v_mov_b32 v10, v8
    v_mov_b32 v11, v9
    s_nop 0
    v_permlane32_swap_b32 v8, v10
    v_permlane32_swap_b32 v9, v11
    v_pk_add_f32 v[8:9], v[8:9], v[10:11]
    v_mov_b32 v10, v8
    v_mov_b32 v11, v9
    s_nop 0
    v_permlane16_swap_b32 v8, v10
    v_permlane16_swap_b32 v9, v11
    v_pk_add_f32 v[12:13], v[8:9], v[10:11]
    s_mov_b64 exec, 0xffff
    buffer_store_dwordx4 v[12:15], v52, s[88:91], s48 offen sc1
    s_mov_b64 exec, -1
    v_lshlrev_b32 v8, 16, v100
    v_and_b32 v9, 0xffff0000, v100
    v_accvgpr_write_b32 a224, v8
    v_accvgpr_write_b32 a225, v9
    v_lshlrev_b32 v8, 16, v101
    v_and_b32 v9, 0xffff0000, v101
    v_accvgpr_write_b32 a226, v8
    v_accvgpr_write_b32 a227, v9
    v_lshlrev_b32 v8, 16, v102
    v_and_b32 v9, 0xffff0000, v102
    v_accvgpr_write_b32 a228, v8
    v_accvgpr_write_b32 a229, v9
    v_lshlrev_b32 v8, 16, v103
    v_and_b32 v9, 0xffff0000, v103
    v_accvgpr_write_b32 a230, v8
    v_accvgpr_write_b32 a231, v9
    v_lshlrev_b32 v8, 16, v104
    v_and_b32 v9, 0xffff0000, v104
    v_accvgpr_write_b32 a232, v8
    v_accvgpr_write_b32 a233, v9
    v_lshlrev_b32 v8, 16, v105
    v_and_b32 v9, 0xffff0000, v105
    v_accvgpr_write_b32 a234, v8
    v_accvgpr_write_b32 a235, v9
    v_lshlrev_b32 v8, 16, v106
    v_and_b32 v9, 0xffff0000, v106
    v_accvgpr_write_b32 a236, v8
    v_accvgpr_write_b32 a237, v9
    v_lshlrev_b32 v8, 16, v107
    v_and_b32 v9, 0xffff0000, v107
    v_accvgpr_write_b32 a238, v8
    v_accvgpr_write_b32 a239, v9
    v_lshlrev_b32 v8, 16, v108
    v_and_b32 v9, 0xffff0000, v108
    v_accvgpr_write_b32 a240, v8
    v_accvgpr_write_b32 a241, v9
    v_lshlrev_b32 v8, 16, v109
    v_and_b32 v9, 0xffff0000, v109
    v_accvgpr_write_b32 a242, v8
    v_accvgpr_write_b32 a243, v9
    s_lshl_b32 s44, s25, 2
    s_add_u32 s44, s44, s22
    s_mul_i32 s40, s44, 40960
    s_add_u32 s40, s40, 9437184
    s_add_u32 s42, s40, 20480
    s_lshl_b32 s41, s44, 12
    s_add_u32 s41, s41, 12058624
    s_add_u32 s44, s67, 12910592
    s_mul_i32 s50, s22, 13312
    s_min_u32 s50, s50, 37888
    s_add_u32 s0, s50, 102400
    s_add_u32 s1, s78, s0
    s_add_u32 s1, s1, 1048576
    s_cmp_eq_u32 s22, 3
    s_waitcnt vmcnt(0)
    s_barrier
    s_cbranch_scc1 L_h_34
    s_branch L_h_35
L_h_34:
    s_mov_b64 exec, 0xffff
    buffer_store_dwordx2 v[4:5], v7, s[88:91], s53 offen sc1
    s_mov_b64 exec, -1
L_h_35:
    s_cmp_eq_u32 s22, 3
    s_cbranch_scc0 L_h_36
    s_mov_b64 exec, 0xffff
    s_mov_b32 s36, 0
L_poll_37:
    buffer_load_dwordx2 v[4:5], v32, s[88:91], s44 offen sc1
    s_add_u32 s36, s36, 1
    s_cmp_gt_u32 s36, 2097152
    s_cbranch_scc1 L_abort
    s_waitcnt vmcnt(0)
    v_cmp_ne_u64 vcc, s[20:21], v[4:5]
    s_cbranch_vccnz L_poll_37
    s_mov_b64 exec, -1
L_h_36:
    s_barrier
    buffer_load_dwordx4 a[0:3], v1, s[88:91], s40 offen offset:0 sc1
    buffer_load_dwordx4 a[80:83], v1, s[88:91], s42 offen offset:0 sc1
    buffer_load_dwordx4 a[4:7], v1, s[88:91], s40 offen offset:1024 sc1
    buffer_load_dwordx4 a[84:87], v1, s[88:91], s42 offen offset:1024 sc1
    buffer_load_dwordx4 a[8:11], v1, s[88:91], s40 offen offset:2048 sc1
    buffer_load_dwordx4 a[88:91], v1, s[88:91], s42 offen offset:2048 sc1
    buffer_load_dwordx4 a[12:15], v1, s[88:91], s40 offen offset:3072 sc1
    buffer_load_dwordx4 a[92:95], v1, s[88:91], s42 offen offset:3072 sc1
    buffer_load_dwordx2 v[20:21], v246, s[88:91], s41 offen offset:0 sc1
    buffer_load_dwordx2 v[22:23], v246, s[88:91], s41 offen offset:256 sc1
    buffer_load_dwordx2 v[24:25], v246, s[88:91], s41 offen offset:2048 sc1
    buffer_load_dwordx2 v[26:27], v246, s[88:91], s41 offen offset:2304 sc1
    s_mov_b32 s27, 1
    s_branch L_P1
L_final:
    ds_read_b128 v[128:131], v1 offset:0
    ds_read_b128 v[132:135], v1 offset:1024
    ds_read_b128 v[136:139], v1 offset:2048
    ds_read_b128 v[140:143], v1 offset:3072
    ds_read_b128 v[144:147], v1 offset:4096
    ds_read_b128 v[148:151], v1 offset:5120
    ds_read_b128 v[152:155], v1 offset:6144
    ds_read_b128 v[156:159], v1 offset:7168
    ds_read_b128 v[160:163], v1 offset:8192
    ds_read_b128 v[164:167], v1 offset:9216
    s_waitcnt vmcnt(9) lgkmcnt(5)
    v_mfma_f32_16x16x32_bf16 v[64:67], v[128:131], a[0:3], v[64:67]
    ds_read_b128 v[168:171], v1 offset:10240
    v_mfma_f32_16x16x32_bf16 v[68:71], v[132:135], a[0:3], v[68:71]
    ds_read_b128 v[172:175], v1 offset:11264
    buffer_load_dwordx4 a[40:43], v1, s[88:91], s40 offen offset:2048 sc1
    v_mfma_f32_16x16x32_bf16 v[72:75], v[136:139], a[0:3], v[72:75]
    ds_read_b128 v[176:179], v1 offset:12288
    v_mfma_f32_16x16x32_bf16 v[76:79], v[140:143], a[0:3], v[76:79]
    ds_read_b128 v[180:183], v1 offset:13312
    v_mfma_f32_16x16x32_bf16 v[80:83], v[144:147], a[0:3], v[80:83]
    ds_read_b128 v[184:187], v1 offset:14336
    s_waitcnt vmcnt(9) lgkmcnt(5)
    v_mfma_f32_16x16x32_bf16 v[64:67], v[148:151], a[4:7], v[64:67]
    ds_read_b128 v[128:131], v1 offset:15360
    v_mfma_f32_16x16x32_bf16 v[68:71], v[152:155], a[4:7], v[68:71]
    ds_read_b128 v[132:135], v1 offset:16384
    buffer_load_dwordx4 a[44:47], v1, s[88:91], s40 offen offset:3072 sc1
    v_mfma_f32_16x16x32_bf16 v[72:75], v[156:159], a[4:7], v[72:75]
    ds_read_b128 v[136:139], v1 offset:17408
    v_mfma_f32_16x16x32_bf16 v[76:79], v[160:163], a[4:7], v[76:79]
    ds_read_b128 v[140:143], v1 offset:18432
    v_mfma_f32_16x16x32_bf16 v[80:83], v[164:167], a[4:7], v[80:83]
    ds_read_b128 v[144:147], v1 offset:19456
    s_waitcnt vmcnt(9) lgkmcnt(5)
    v_mfma_f32_16x16x32_bf16 v[64:67], v[168:171], a[8:11], v[64:67]
    ds_read_b128 v[148:151], v1 offset:20480
    v_mfma_f32_16x16x32_bf16 v[68:71], v[172:175], a[8:11], v[68:71]
    ds_read_b128 v[152:155], v1 offset:21504
    s_add_u32 s40, s40, 4096
    buffer_load_dwordx4 a[48:51], v1, s[88:91], s40 offen offset:0 sc1
    v_mfma_f32_16x16x32_bf16 v[72:75], v[176:179], a[8:11], v[72:75]
    ds_read_b128 v[156:159], v1 offset:22528
    v_mfma_f32_16x16x32_bf16 v[76:79], v[180:183], a[8:11], v[76:79]
    ds_read_b128 v[160:163], v1 offset:23552
    v_mfma_f32_16x16x32_bf16 v[80:83], v[184:187], a[8:11], v[80:83]
    ds_read_b128 v[164:167], v1 offset:24576
    s_waitcnt vmcnt(9) lgkmcnt(5)
    v_mfma_f32_16x16x32_bf16 v[64:67], v[128:131], a[12:15], v[64:67]
    ds_read_b128 v[168:171], v1 offset:25600
    v_mfma_f32_16x16x32_bf16 v[68:71], v[132:135], a[12:15], v[68:71]
    ds_read_b128 v[172:175], v1 offset:26624
    buffer_load_dwordx4 a[52:55], v1, s[88:91], s40 offen offset:1024 sc1
    v_mfma_f32_16x16x32_bf16 v[72:75], v[136:139], a[12:15], v[72:75]
    ds_read_b128 v[176:179], v1 offset:27648
    v_mfma_f32_16x16x32_bf16 v[76:79], v[140:143], a[12:15], v[76:79]
    ds_read_b128 v[180:183], v1 offset:28672
    v_mfma_f32_16x16x32_bf16 v[80:83], v[144:147], a[12:15], v[80:83]
    ds_read_b128 v[184:187], v1 offset:29696
    s_waitcnt vmcnt(9) lgkmcnt(5)
    v_mfma_f32_16x16x32_bf16 v[64:67], v[148:151], a[16:19], v[64:67]
    ds_read_b128 v[128:131], v1 offset:30720
    v_mfma_f32_16x16x32_bf16 v[68:71], v[152:155], a[16:19], v[68:71]
    ds_read_b128 v[132:135], v1 offset:31744
    buffer_load_dwordx4 a[56:59], v1, s[88:91], s40 offen offset:2048 sc1
    v_mfma_f32_16x16x32_bf16 v[72:75], v[156:159], a[16:19], v[72:75]
    ds_read_b128 v[136:139], v1 offset:32768
    v_mfma_f32_16x16x32_bf16 v[76:79], v[160:163], a[16:19], v[76:79]
    ds_read_b128 v[140:143], v1 offset:33792
    v_mfma_f32_16x16x32_bf16 v[80:83], v[164:167], a[16:19], v[80:83]
    ds_read_b128 v[144:147], v1 offset:34816
    s_waitcnt vmcnt(9) lgkmcnt(5)
    v_mfma_f32_16x16x32_bf16 v[64:67], v[168:171], a[20:23], v[64:67]
    ds_read_b128 v[148:151], v1 offset:35840
    v_mfma_f32_16x16x32_bf16 v[68:71], v[172:175], a[20:23], v[68:71]
    ds_read_b128 v[152:155], v1 offset:36864
    buffer_load_dwordx4 a[60:63], v1, s[88:91], s40 offen offset:3072 sc1
    v_mfma_f32_16x16x32_bf16 v[72:75], v[176:179], a[20:23], v[72:75]
    ds_read_b128 v[156:159], v1 offset:37888
    v_mfma_f32_16x16x32_bf16 v[76:79], v[180:183], a[20:23], v[76:79]
    ds_read_b128 v[160:163], v1 offset:38912
    v_mfma_f32_16x16x32_bf16 v[80:83], v[184:187], a[20:23], v[80:83]
    ds_read_b128 v[164:167], v1 offset:39936
    s_waitcnt vmcnt(9) lgkmcnt(5)
    v_mfma_f32_16x16x32_bf16 v[64:67], v[128:131], a[24:27], v[64:67]
    ds_read_b128 v[168:171], v1 offset:40960
    v_mfma_f32_16x16x32_bf16 v[68:71], v[132:135], a[24:27], v[68:71]
    ds_read_b128 v[172:175], v1 offset:41984
    s_add_u32 s40, s40, 4096
    buffer_load_dwordx4 a[64:67], v1, s[88:91], s40 offen offset:0 sc1
    v_mfma_f32_16x16x32_bf16 v[72:75], v[136:139], a[24:27], v[72:75]
    ds_read_b128 v[176:179], v1 offset:43008
    v_mfma_f32_16x16x32_bf16 v[76:79], v[140:143], a[24:27], v[76:79]
    ds_read_b128 v[180:183], v1 offset:44032
    v_mfma_f32_16x16x32_bf16 v[80:83], v[144:147], a[24:27], v[80:83]
    ds_read_b128 v[184:187], v1 offset:45056
    s_waitcnt vmcnt(9) lgkmcnt(5)
    v_mfma_f32_16x16x32_bf16 v[64:67], v[148:151], a[28:31], v[64:67]
    ds_read_b128 v[128:131], v1 offset:46080
    v_mfma_f32_16x16x32_bf16 v[68:71], v[152:155], a[28:31], v[68:71]
    ds_read_b128 v[132:135], v1 offset:47104
    buffer_load_dwordx4 a[68:71], v1, s[88:91], s40 offen offset:1024 sc1
    v_mfma_f32_16x16x32_bf16 v[72:75], v[156:159], a[28:31], v[72:75]
    ds_read_b128 v[136:139], v1 offset:48128
    v_mfma_f32_16x16x32_bf16 v[76:79], v[160:163], a[28:31], v[76:79]
    ds_read_b128 v[140:143], v1 offset:49152
    v_mfma_f32_16x16x32_bf16 v[80:83], v[164:167], a[28:31], v[80:83]
    ds_read_b128 v[144:147], v1 offset:50176
    s_waitcnt vmcnt(9) lgkmcnt(5)
    v_mfma_f32_16x16x32_bf16 v[64:67], v[168:171], a[32:35], v[64:67]
    ds_read_b128 v[148:151], v38 offset:0
    v_mfma_f32_16x16x32_bf16 v[68:71], v[172:175], a[32:35], v[68:71]
    ds_read_b128 v[152:155], v38 offset:1024
    buffer_load_dwordx4 a[72:75], v1, s[88:91], s40 offen offset:2048 sc1
    v_mfma_f32_16x16x32_bf16 v[72:75], v[176:179], a[32:35], v[72:75]
    ds_read_b128 v[156:159], v38 offset:2048
    v_mfma_f32_16x16x32_bf16 v[76:79], v[180:183], a[32:35], v[76:79]
    ds_read_b128 v[160:163], v38 offset:3072
    v_mfma_f32_16x16x32_bf16 v[80:83], v[184:187], a[32:35], v[80:83]
    ds_read_b128 v[164:167], v38 offset:4096
    s_waitcnt vmcnt(9) lgkmcnt(5)
    v_mfma_f32_16x16x32_bf16 v[64:67], v[128:131], a[36:39], v[64:67]
    ds_read_b128 v[168:171], v38 offset:5120
    v_mfma_f32_16x16x32_bf16 v[68:71], v[132:135], a[36:39], v[68:71]
    ds_read_b128 v[172:175], v38 offset:6144
    buffer_load_dwordx4 a[76:79], v1, s[88:91], s40 offen offset:3072 sc1
    v_mfma_f32_16x16x32_bf16 v[72:75], v[136:139], a[36:39], v[72:75]
    ds_read_b128 v[176:179], v38 offset:7168
    v_mfma_f32_16x16x32_bf16 v[76:79], v[140:143], a[36:39], v[76:79]
    ds_read_b128 v[180:183], v38 offset:8192
    v_mfma_f32_16x16x32_bf16 v[80:83], v[144:147], a[36:39], v[80:83]
    ds_read_b128 v[184:187], v38 offset:9216
    s_waitcnt vmcnt(9) lgkmcnt(5)
    v_mfma_f32_16x16x32_bf16 v[64:67], v[148:151], a[40:43], v[64:67]
    ds_read_b128 v[128:131], v38 offset:10240
    v_mfma_f32_16x16x32_bf16 v[68:71], v[152:155], a[40:43], v[68:71]
    ds_read_b128 v[132:135], v38 offset:11264
    v_mfma_f32_16x16x32_bf16 v[72:75], v[156:159], a[40:43], v[72:75]
    ds_read_b128 v[136:139], v38 offset:12288
    v_mfma_f32_16x16x32_bf16 v[76:79], v[160:163], a[40:43], v[76:79]
    ds_read_b128 v[140:143], v38 offset:13312
    v_mfma_f32_16x16x32_bf16 v[80:83], v[164:167], a[40:43], v[80:83]
    ds_read_b128 v[144:147], v38 offset:14336
    s_waitcnt vmcnt(8) lgkmcnt(5)
    v_mfma_f32_16x16x32_bf16 v[64:67], v[168:171], a[44:47], v[64:67]
    ds_read_b128 v[148:151], v38 offset:15360
    v_mfma_f32_16x16x32_bf16 v[68:71], v[172:175], a[44:47], v[68:71]
    ds_read_b128 v[152:155], v38 offset:16384
    v_mfma_f32_16x16x32_bf16 v[72:75], v[176:179], a[44:47], v[72:75]
    ds_read_b128 v[156:159], v38 offset:17408
    v_mfma_f32_16x16x32_bf16 v[76:79], v[180:183], a[44:47], v[76:79]
    ds_read_b128 v[160:163], v38 offset:18432
    v_mfma_f32_16x16x32_bf16 v[80:83], v[184:187], a[44:47], v[80:83]
    ds_read_b128 v[164:167], v38 offset:19456
    s_waitcnt vmcnt(7) lgkmcnt(5)
    v_mfma_f32_16x16x32_bf16 v[64:67], v[128:131], a[48:51], v[64:67]
    ds_read_b128 v[168:171], v38 offset:20480
    v_mfma_f32_16x16x32_bf16 v[68:71], v[132:135], a[48:51], v[68:71]
    ds_read_b128 v[172:175], v38 offset:21504
    v_mfma_f32_16x16x32_bf16 v[72:75], v[136:139], a[48:51], v[72:75]
    ds_read_b128 v[176:179], v38 offset:22528
    v_mfma_f32_16x16x32_bf16 v[76:79], v[140:143], a[48:51], v[76:79]
    ds_read_b128 v[180:183], v38 offset:23552
    v_mfma_f32_16x16x32_bf16 v[80:83], v[144:147], a[48:51], v[80:83]
    ds_read_b128 v[184:187], v38 offset:24576
    s_waitcnt vmcnt(6) lgkmcnt(5)
    v_mfma_f32_16x16x32_bf16 v[64:67], v[148:151], a[52:55], v[64:67]
    ds_read_b128 v[128:131], v38 offset:25600
    v_mfma_f32_16x16x32_bf16 v[68:71], v[152:155], a[52:55], v[68:71]
    ds_read_b128 v[132:135], v38 offset:26624
    v_mfma_f32_16x16x32_bf16 v[72:75], v[156:159], a[52:55], v[72:75]
    ds_read_b128 v[136:139], v38 offset:27648
    v_mfma_f32_16x16x32_bf16 v[76:79], v[160:163], a[52:55], v[76:79]
    ds_read_b128 v[140:143], v38 offset:28672
    v_mfma_f32_16x16x32_bf16 v[80:83], v[164:167], a[52:55], v[80:83]
    ds_read_b128 v[144:147], v38 offset:29696
    s_waitcnt vmcnt(5) lgkmcnt(5)
    v_mfma_f32_16x16x32_bf16 v[64:67], v[168:171], a[56:59], v[64:67]
    ds_read_b128 v[148:151], v38 offset:30720
    v_mfma_f32_16x16x32_bf16 v[68:71], v[172:175], a[56:59], v[68:71]
    ds_read_b128 v[152:155], v38 offset:31744
    v_mfma_f32_16x16x32_bf16 v[72:75], v[176:179], a[56:59], v[72:75]
    ds_read_b128 v[156:159], v38 offset:32768
    v_mfma_f32_16x16x32_bf16 v[76:79], v[180:183], a[56:59], v[76:79]
    ds_read_b128 v[160:163], v38 offset:33792
    v_mfma_f32_16x16x32_bf16 v[80:83], v[184:187], a[56:59], v[80:83]
    ds_read_b128 v[164:167], v38 offset:34816
    s_waitcnt vmcnt(4) lgkmcnt(5)
    v_mfma_f32_16x16x32_bf16 v[64:67], v[128:131], a[60:63], v[64:67]
    ds_read_b128 v[168:171], v38 offset:35840
    v_mfma_f32_16x16x32_bf16 v[68:71], v[132:135], a[60:63], v[68:71]
    ds_read_b128 v[172:175], v38 offset:36864
    v_mfma_f32_16x16x32_bf16 v[72:75], v[136:139], a[60:63], v[72:75]
    ds_read_b128 v[176:179], v38 offset:37888
    v_mfma_f32_16x16x32_bf16 v[76:79], v[140:143], a[60:63], v[76:79]
    ds_read_b128 v[180:183], v38 offset:38912
    v_mfma_f32_16x16x32_bf16 v[80:83], v[144:147], a[60:63], v[80:83]
    ds_read_b128 v[184:187], v38 offset:39936
    s_waitcnt vmcnt(3) lgkmcnt(5)
    v_mfma_f32_16x16x32_bf16 v[64:67], v[148:151], a[64:67], v[64:67]
    ds_read_b128 v[128:131], v38 offset:40960
    v_mfma_f32_16x16x32_bf16 v[68:71], v[152:155], a[64:67], v[68:71]
    ds_read_b128 v[132:135], v38 offset:41984
    v_mfma_f32_16x16x32_bf16 v[72:75], v[156:159], a[64:67], v[72:75]
    ds_read_b128 v[136:139], v38 offset:43008
    v_mfma_f32_16x16x32_bf16 v[76:79], v[160:163], a[64:67], v[76:79]
    ds_read_b128 v[140:143], v38 offset:44032
    v_mfma_f32_16x16x32_bf16 v[80:83], v[164:167], a[64:67], v[80:83]
    ds_read_b128 v[144:147], v38 offset:45056
    s_waitcnt vmcnt(2) lgkmcnt(5)
    v_mfma_f32_16x16x32_bf16 v[64:67], v[168:171], a[68:71], v[64:67]
    ds_read_b128 v[148:151], v38 offset:46080
    v_mfma_f32_16x16x32_bf16 v[68:71], v[172:175], a[68:71], v[68:71]
    ds_read_b128 v[152:155], v38 offset:47104
    v_mfma_f32_16x16x32_bf16 v[72:75], v[176:179], a[68:71], v[72:75]
    ds_read_b128 v[156:159], v38 offset:48128
    v_mfma_f32_16x16x32_bf16 v[76:79], v[180:183], a[68:71], v[76:79]
    ds_read_b128 v[160:163], v38 offset:49152
    v_mfma_f32_16x16x32_bf16 v[80:83], v[184:187], a[68:71], v[80:83]
    ds_read_b128 v[164:167], v38 offset:50176
    s_waitcnt vmcnt(1) lgkmcnt(5)
    v_mfma_f32_16x16x32_bf16 v[64:67], v[128:131], a[72:75], v[64:67]
    v_mfma_f32_16x16x32_bf16 v[68:71], v[132:135], a[72:75], v[68:71]
    v_mfma_f32_16x16x32_bf16 v[72:75], v[136:139], a[72:75], v[72:75]
    v_mfma_f32_16x16x32_bf16 v[76:79], v[140:143], a[72:75], v[76:79]
    v_mfma_f32_16x16x32_bf16 v[80:83], v[144:147], a[72:75], v[80:83]
    s_waitcnt vmcnt(0) lgkmcnt(0)
    v_mfma_f32_16x16x32_bf16 v[64:67], v[148:151], a[76:79], v[64:67]
    v_mfma_f32_16x16x32_bf16 v[68:71], v[152:155], a[76:79], v[68:71]
    v_mfma_f32_16x16x32_bf16 v[72:75], v[156:159], a[76:79], v[72:75]
    v_mfma_f32_16x16x32_bf16 v[76:79], v[160:163], a[76:79], v[76:79]
    v_mfma_f32_16x16x32_bf16 v[80:83], v[164:167], a[76:79], v[80:83]
    s_nop 3
    v_cvt_pk_bf16_f32 v100, v64, v65
    v_cvt_pk_bf16_f32 v101, v66, v67
    v_cvt_pk_bf16_f32 v102, v68, v69
    v_cvt_pk_bf16_f32 v103, v70, v71
    v_cvt_pk_bf16_f32 v104, v72, v73
    v_cvt_pk_bf16_f32 v105, v74, v75
    v_cvt_pk_bf16_f32 v106, v76, v77
    v_cvt_pk_bf16_f32 v107, v78, v79
    v_cvt_pk_bf16_f32 v108, v80, v81
    v_cvt_pk_bf16_f32 v109, v82, v83
    buffer_store_dwordx4 v[100:103], v55, s[12:15], 0 offen sc1
    buffer_store_dwordx4 v[104:107], v55, s[12:15], 0 offen offset:64 sc1
    v_mov_b32 v110, v108
    v_mov_b32 v111, v109
    s_nop 0
    v_permlane16_swap_b32 v108, v110
    v_permlane16_swap_b32 v109, v111
    s_mov_b32 exec_lo, 0xffff
    s_mov_b32 exec_hi, 0xffff
    buffer_store_dwordx4 v[108:111], v56, s[12:15], 0 offen sc1
    s_mov_b64 exec, -1
L_end:
    s_add_u32 s40, s30, s22
    s_cmp_eq_u32 s40, 0
    s_cbranch_scc0 L_abort
    v_mov_b32 v4, s20
    v_mov_b32 v5, s21
    s_mov_b64 exec, 1
    buffer_store_dwordx2 v[4:5], v243, s[4:7], 0 offen sc1
L_abort:
    s_endpgm
L_fallback:
    s_mov_b32 s59, 1
    s_mov_b32 s44, 0
    v_add_u32 v27, 133120, v1
    v_add_u32 v28, 133120, v32
    s_lshl_b32 s45, s22, 10
    v_and_b32 v29, 31, v0
    v_lshlrev_b32 v29, 2, v29
    v_add_u32 v29, 102400, v29
    v_add_u32 v31, s45, v29
    s_waitcnt vmcnt(0)
L_fb_loop:
    ds_read_b128 v[160:163], v27
    ds_read_b64 v[164:165], v28 offset:1024
    s_waitcnt lgkmcnt(0)
    s_mov_b32 exec_lo, 0
    v_mov_b32 v164, 0
    s_mov_b32 exec_lo, -1
    v_mov_b32 v8, 0xff800000
    v_mfma_f32_32x32x16_bf16 v[64:79], a[0:3], v[160:163], 0
    v_mfma_f32_32x32x8_bf16 v[64:79], a[64:65], v[164:165], v[64:79]
    s_nop 11
    v_max3_f32 v8, v8, v64, v65
    v_max3_f32 v8, v8, v66, v67
    v_max3_f32 v8, v8, v68, v69
    v_max3_f32 v8, v8, v70, v71
    v_max3_f32 v8, v8, v72, v73
    v_max3_f32 v8, v8, v74, v75
    v_max3_f32 v8, v8, v76, v77
    v_max3_f32 v8, v8, v78, v79
    v_mfma_f32_32x32x16_bf16 v[64:79], a[4:7], v[160:163], 0
    v_mfma_f32_32x32x8_bf16 v[64:79], a[66:67], v[164:165], v[64:79]
    s_nop 11
    v_max3_f32 v8, v8, v64, v65
    v_max3_f32 v8, v8, v66, v67
    v_max3_f32 v8, v8, v68, v69
    v_max3_f32 v8, v8, v70, v71
    v_max3_f32 v8, v8, v72, v73
    v_max3_f32 v8, v8, v74, v75
    v_max3_f32 v8, v8, v76, v77
    v_max3_f32 v8, v8, v78, v79
    v_mfma_f32_32x32x16_bf16 v[64:79], a[8:11], v[160:163], 0
    v_mfma_f32_32x32x8_bf16 v[64:79], a[68:69], v[164:165], v[64:79]
    s_nop 11
    v_max3_f32 v8, v8, v64, v65
    v_max3_f32 v8, v8, v66, v67
    v_max3_f32 v8, v8, v68, v69
    v_max3_f32 v8, v8, v70, v71
    v_max3_f32 v8, v8, v72, v73
    v_max3_f32 v8, v8, v74, v75
    v_max3_f32 v8, v8, v76, v77
    v_max3_f32 v8, v8, v78, v79
    v_mfma_f32_32x32x16_bf16 v[64:79], a[12:15], v[160:163], 0
    v_mfma_f32_32x32x8_bf16 v[64:79], a[70:71], v[164:165], v[64:79]
    s_nop 11
    v_max3_f32 v8, v8, v64, v65
    v_max3_f32 v8, v8, v66, v67
    v_max3_f32 v8, v8, v68, v69
    v_max3_f32 v8, v8, v70, v71
    v_max3_f32 v8, v8, v72, v73
    v_max3_f32 v8, v8, v74, v75
    v_max3_f32 v8, v8, v76, v77
    v_max3_f32 v8, v8, v78, v79
    v_mfma_f32_32x32x16_bf16 v[64:79], a[16:19], v[160:163], 0
    v_mfma_f32_32x32x8_bf16 v[64:79], a[72:73], v[164:165], v[64:79]
    s_nop 11
    v_max3_f32 v8, v8, v64, v65
    v_max3_f32 v8, v8, v66, v67
    v_max3_f32 v8, v8, v68, v69
    v_max3_f32 v8, v8, v70, v71
    v_max3_f32 v8, v8, v72, v73
    v_max3_f32 v8, v8, v74, v75
    v_max3_f32 v8, v8, v76, v77
    v_max3_f32 v8, v8, v78, v79
    v_mfma_f32_32x32x16_bf16 v[64:79], a[20:23], v[160:163], 0
    v_mfma_f32_32x32x8_bf16 v[64:79], a[74:75], v[164:165], v[64:79]
    s_nop 11
    v_max3_f32 v8, v8, v64, v65
    v_max3_f32 v8, v8, v66, v67
    v_max3_f32 v8, v8, v68, v69
    v_max3_f32 v8, v8, v70, v71
    v_max3_f32 v8, v8, v72, v73
    v_max3_f32 v8, v8, v74, v75
    v_max3_f32 v8, v8, v76, v77
    v_max3_f32 v8, v8, v78, v79
    v_mfma_f32_32x32x16_bf16 v[64:79], a[24:27], v[160:163], 0
    v_mfma_f32_32x32x8_bf16 v[64:79], a[76:77], v[164:165], v[64:79]
    s_nop 11
    v_max3_f32 v8, v8, v64, v65
    v_max3_f32 v8, v8, v66, v67
    v_max3_f32 v8, v8, v68, v69
    v_max3_f32 v8, v8, v70, v71
    v_max3_f32 v8, v8, v72, v73
    v_max3_f32 v8, v8, v74, v75
    v_max3_f32 v8, v8, v76, v77
    v_max3_f32 v8, v8, v78, v79
    v_mfma_f32_32x32x16_bf16 v[64:79], a[28:31], v[160:163], 0
    v_mfma_f32_32x32x8_bf16 v[64:79], a[78:79], v[164:165], v[64:79]
    s_nop 11
    v_max3_f32 v8, v8, v64, v65
    v_max3_f32 v8, v8, v66, v67
    v_max3_f32 v8, v8, v68, v69
    v_max3_f32 v8, v8, v70, v71
    v_max3_f32 v8, v8, v72, v73
    v_max3_f32 v8, v8, v74, v75
    v_max3_f32 v8, v8, v76, v77
    v_max3_f32 v8, v8, v78, v79
    v_mfma_f32_32x32x16_bf16 v[64:79], a[32:35], v[160:163], 0
    v_mfma_f32_32x32x8_bf16 v[64:79], a[80:81], v[164:165], v[64:79]
    s_nop 11
    v_max3_f32 v8, v8, v64, v65
    v_max3_f32 v8, v8, v66, v67
    v_max3_f32 v8, v8, v68, v69
    v_max3_f32 v8, v8, v70, v71
    v_max3_f32 v8, v8, v72, v73
    v_max3_f32 v8, v8, v74, v75
    v_max3_f32 v8, v8, v76, v77
    v_max3_f32 v8, v8, v78, v79
    v_mfma_f32_32x32x16_bf16 v[64:79], a[36:39], v[160:163], 0
    v_mfma_f32_32x32x8_bf16 v[64:79], a[82:83], v[164:165], v[64:79]
    s_nop 11
    v_max3_f32 v8, v8, v64, v65
    v_max3_f32 v8, v8, v66, v67
    v_max3_f32 v8, v8, v68, v69
    v_max3_f32 v8, v8, v70, v71
    v_max3_f32 v8, v8, v72, v73
    v_max3_f32 v8, v8, v74, v75
    v_max3_f32 v8, v8, v76, v77
    v_max3_f32 v8, v8, v78, v79
    v_mfma_f32_32x32x16_bf16 v[64:79], a[40:43], v[160:163], 0
    v_mfma_f32_32x32x8_bf16 v[64:79], a[84:85], v[164:165], v[64:79]
    s_nop 11
    v_max3_f32 v8, v8, v64, v65
    v_max3_f32 v8, v8, v66, v67
    v_max3_f32 v8, v8, v68, v69
    v_max3_f32 v8, v8, v70, v71
    v_max3_f32 v8, v8, v72, v73
    v_max3_f32 v8, v8, v74, v75
    v_max3_f32 v8, v8, v76, v77
    v_max3_f32 v8, v8, v78, v79
    v_mfma_f32_32x32x16_bf16 v[64:79], a[44:47], v[160:163], 0
    v_mfma_f32_32x32x8_bf16 v[64:79], a[86:87], v[164:165], v[64:79]
    s_nop 11
    v_max3_f32 v8, v8, v64, v65
    v_max3_f32 v8, v8, v66, v67
    v_max3_f32 v8, v8, v68, v69
    v_max3_f32 v8, v8, v70, v71
    v_max3_f32 v8, v8, v72, v73
    v_max3_f32 v8, v8, v74, v75
    v_max3_f32 v8, v8, v76, v77
    v_max3_f32 v8, v8, v78, v79
    v_mfma_f32_32x32x16_bf16 v[64:79], a[48:51], v[160:163], 0
    v_mfma_f32_32x32x8_bf16 v[64:79], a[88:89], v[164:165], v[64:79]
    s_nop 11
    v_max3_f32 v8, v8, v64, v65
    v_max3_f32 v8, v8, v66, v67
    v_max3_f32 v8, v8, v68, v69
    v_max3_f32 v8, v8, v70, v71
    v_max3_f32 v8, v8, v72, v73
    v_max3_f32 v8, v8, v74, v75
    v_max3_f32 v8, v8, v76, v77
    v_max3_f32 v8, v8, v78, v79
    v_mfma_f32_32x32x16_bf16 v[64:79], a[52:55], v[160:163], 0
    v_mfma_f32_32x32x8_bf16 v[64:79], a[90:91], v[164:165], v[64:79]
    s_nop 11
    v_max3_f32 v8, v8, v64, v65
    v_max3_f32 v8, v8, v66, v67
    v_max3_f32 v8, v8, v68, v69
    v_max3_f32 v8, v8, v70, v71
    v_max3_f32 v8, v8, v72, v73
    v_max3_f32 v8, v8, v74, v75
    v_max3_f32 v8, v8, v76, v77
    v_max3_f32 v8, v8, v78, v79
    v_mfma_f32_32x32x16_bf16 v[64:79], a[56:59], v[160:163], 0
    v_mfma_f32_32x32x8_bf16 v[64:79], a[92:93], v[164:165], v[64:79]
    s_nop 11
    v_max3_f32 v8, v8, v64, v65
    v_max3_f32 v8, v8, v66, v67
    v_max3_f32 v8, v8, v68, v69
    v_max3_f32 v8, v8, v70, v71
    v_max3_f32 v8, v8, v72, v73
    v_max3_f32 v8, v8, v74, v75
    v_max3_f32 v8, v8, v76, v77
    v_max3_f32 v8, v8, v78, v79
    v_mfma_f32_32x32x16_bf16 v[64:79], a[60:63], v[160:163], 0
    v_mfma_f32_32x32x8_bf16 v[64:79], a[94:95], v[164:165], v[64:79]
    s_nop 11
    v_max3_f32 v8, v8, v64, v65
    v_max3_f32 v8, v8, v66, v67
    v_max3_f32 v8, v8, v68, v69
    v_max3_f32 v8, v8, v70, v71
    v_max3_f32 v8, v8, v72, v73
    v_max3_f32 v8, v8, v74, v75
    v_max3_f32 v8, v8, v76, v77
    v_max3_f32 v8, v8, v78, v79
    v_mov_b32 v9, v8
    s_nop 1
    v_permlane32_swap_b32 v8, v9
    v_max_f32 v8, v8, v9
    ds_write_b32 v31, v8
    v_add_u32 v27, 1536, v27
    v_add_u32 v28, 1536, v28
    v_add_u32 v31, 128, v31
    s_add_u32 s44, s44, 1
    s_cmp_lt_u32 s44, 8
    s_cbranch_scc1 L_fb_loop
    s_waitcnt lgkmcnt(0)
    s_barrier
    s_lshl_b32 s45, s22, 8
    v_add_u32 v31, s45, v29
    ds_read_b32 v8, v31 offset:0
    ds_read_b32 v9, v31 offset:1024
    ds_read_b32 v10, v31 offset:2048
    ds_read_b32 v11, v31 offset:3072
    ds_read_b32 v12, v31 offset:128
    ds_read_b32 v13, v31 offset:1152
    ds_read_b32 v14, v31 offset:2176
    ds_read_b32 v15, v31 offset:3200
    s_waitcnt lgkmcnt(0)
    v_max3_f32 v8, v8, v9, v10
    v_max_f32 v8, v8, v11
    v_sub_f32 v8, 0, v8
    v_and_b32 v9, 0xffff0000, v8
    v_sub_f32 v8, v8, v9
    v_cvt_pk_bf16_f32 v8, v9, v8
    v_max3_f32 v12, v12, v13, v14
    v_max_f32 v12, v12, v15
    v_sub_f32 v12, 0, v12
    v_and_b32 v13, 0xffff0000, v12
    v_sub_f32 v12, v12, v13
    v_cvt_pk_bf16_f32 v12, v13, v12
    s_mov_b32 exec_lo, 0
    ds_write_b32 v250, v8 offset:1024
    ds_write_b32 v250, v12 offset:2560
    s_mov_b32 exec_lo, -1
    s_mov_b32 s44, 0
    s_lshl_b32 s40, s22, 14
    s_add_u32 s40, s40, 6422528
    s_lshl_b32 s41, s22, 13
    s_add_u32 s41, s41, 6488064
    s_lshl_b32 s42, s22, 15
    s_add_u32 s42, s42, 6553600
    s_mov_b32 s45, s22
    s_mul_i32 s47, s45, 6144
    s_add_u32 s47, s47, 102400
    v_add_u32 v30, s47, v1
    s_mul_i32 s47, s45, 3072
    s_add_u32 s47, s47, 133120
    v_add_u32 v27, s47, v1
    v_add_u32 v28, s47, v32
    s_mul_i32 s54, s22, 12288
    s_min_u32 s54, s54, 35840
    s_add_u32 s53, s77, s54
    s_add_u32 s53, s53, 6291456
    s_add_u32 s52, s54, 51200
    s_add_u32 s43, s78, 1048576
    s_add_u32 s47, s77, 6291456
    s_cmp_eq_u32 s27, 0
    s_cselect_b32 s43, s43, s47
    s_add_u32 s43, s43, s52
    s_lshr_b32 s46, s30, 5
    s_and_b32 s47, s30, 1
    s_lshl_b32 s47, s47, 3
    s_add_u32 s46, s46, s47
    s_mul_i32 s46, s46, 153600
    s_bfe_u32 s47, s30, 0x20003
    s_lshl_b32 s47, s47, 2
    s_add_u32 s47, s47, s22
    s_mul_i32 s47, s47, 3200
    s_add_u32 s46, s46, s47
    s_add_u32 s46, s46, 1048576
    v_lshlrev_b32 v26, 7, v0
    s_mov_b32 s49, 33554432
    s_add_u32 s40, s40, 4096
    s_add_u32 s41, s41, 2048
    s_add_u32 s42, s42, 8192
    ds_read_b128 v[160:163], v27
    ds_read_b64 v[164:165], v28 offset:1024
    ds_read_b128 v[168:171], v27 offset:1536
    ds_read_b64 v[172:173], v28 offset:2560
    s_waitcnt lgkmcnt(0)
    s_branch L_att_start
L_s_5o:
    s_waitcnt vmcnt(16)
    s_barrier
    s_branch L_s_5
L_w_6o:
    s_mov_b32 m0, s54
    s_nop 0
    buffer_load_dwordx4 v1, s[4:7], s55 offen offset:0 sc1 lds
    buffer_load_dwordx4 v1, s[4:7], s55 offen offset:1024 sc1 lds
    s_branch L_w_6
L_w_7o:
    buffer_load_dwordx4 v1, s[4:7], s55 offen offset:2048 sc1 lds
    s_branch L_w_7
L_s_8o:
    s_waitcnt vmcnt(5)
    s_barrier
    v_pk_add_f32 v[192:193], v[192:193], v[196:197]
    v_pk_add_f32 v[192:193], v[192:193], v[200:201]
    v_pk_add_f32 v[194:195], v[194:195], v[198:199]
    v_pk_add_f32 v[194:195], v[194:195], v[202:203]
    v_add_f32_dpp v192, v192, v192 row_ror:8 row_mask:0xf bank_mask:0xf
    v_add_f32_dpp v193, v193, v193 row_ror:8 row_mask:0xf bank_mask:0xf
    v_add_f32_dpp v194, v194, v194 row_ror:8 row_mask:0xf bank_mask:0xf
    v_add_f32_dpp v195, v195, v195 row_ror:8 row_mask:0xf bank_mask:0xf
    v_mov_b32 v196, v192
    v_mov_b32 v197, v193
    v_mov_b32 v198, v194
    v_mov_b32 v199, v195
    v_permlane16_swap_b32 v192, v196
    v_permlane16_swap_b32 v193, v197
    v_permlane16_swap_b32 v194, v198
    v_permlane16_swap_b32 v195, v199
    v_add_f32 v192, v192, v196
    v_add_f32 v193, v193, v197
    v_add_f32 v194, v194, v198
    v_add_f32 v195, v195, v199
    v_mov_b32 v196, v192
    v_mov_b32 v197, v193
    v_mov_b32 v198, v194
    v_mov_b32 v199, v195
    v_permlane32_swap_b32 v192, v196
    v_permlane32_swap_b32 v193, v197
    v_permlane32_swap_b32 v194, v198
    v_permlane32_swap_b32 v195, v199
    v_add_f32 v192, v192, v196
    v_add_f32 v193, v193, v197
    v_add_f32 v194, v194, v198
    v_add_f32 v195, v195, v199
    s_lshl_b32 s39, s22, 7
    s_add_u32 s39, s39, 154624
    v_add_u32 v6, s39, v1
    s_mov_b64 exec, 0xff
    ds_write_b128 v6, v[192:195]
    s_mov_b64 exec, -1
    s_branch L_s_8
L_w_9o:
    buffer_load_dwordx4 v1, s[4:7], s55 offen offset:3072 sc1 lds
    s_branch L_w_9
L_w_10o:
    s_add_u32 m0, s54, 1024
    s_add_u32 s55, s55, 1024
    buffer_load_dwordx4 v1, s[4:7], s55 offen offset:3072 sc1 lds
    s_add_u32 s54, s54, 20480
    s_add_u32 s55, s55, 19456
    s_branch L_w_10
L_w_11o:
    s_mov_b32 m0, s54
    s_nop 0
    buffer_load_dwordx4 v1, s[4:7], s55 offen offset:0 sc1 lds
    buffer_load_dwordx4 v1, s[4:7], s55 offen offset:1024 sc1 lds
    s_branch L_w_11
L_w_12o:
    buffer_load_dwordx4 v1, s[4:7], s55 offen offset:2048 sc1 lds
    s_branch L_w_12
L_s_13o:
    s_waitcnt vmcnt(11)
    s_barrier
    s_cmp_eq_u32 s57, 0
    s_cbranch_scc1 L_s_13
    s_mov_b64 exec, 1
    buffer_store_dwordx2 v[4:5], v243, s[4:7], s57 offen sc1
    s_mov_b64 exec, -1
    s_branch L_s_13
L_w_14o:
    buffer_load_dwordx4 v1, s[4:7], s55 offen offset:3072 sc1 lds
    s_branch L_w_14
L_w_15o:
    s_add_u32 m0, s54, 1024
    s_add_u32 s55, s55, 1024
    buffer_load_dwordx4 v1, s[4:7], s55 offen offset:3072 sc1 lds
    s_add_u32 s54, s54, 20480
    s_add_u32 s55, s55, 19456
    s_branch L_w_15
L_w_16o:
    s_mov_b32 m0, s54
    s_nop 0
    buffer_load_dwordx4 v1, s[4:7], s55 offen offset:0 sc1 lds
    buffer_load_dwordx4 v1, s[4:7], s55 offen offset:1024 sc1 lds
    s_branch L_w_16
L_w_17o:
    buffer_load_dwordx4 v1, s[4:7], s55 offen offset:2048 sc1 lds
    s_branch L_w_17
L_s_18o:
    s_waitcnt vmcnt(9)
    s_barrier
    s_branch L_s_18
L_w_19o:
    buffer_load_dwordx4 v1, s[4:7], s55 offen offset:3072 sc1 lds
    s_branch L_w_19
L_w_20o:
    s_add_u32 m0, s54, 1024
    s_add_u32 s55, s55, 1024
    buffer_load_dwordx4 v1, s[4:7], s55 offen offset:3072 sc1 lds
    s_add_u32 s54, s54, 20480
    s_add_u32 s55, s55, 19456
    s_branch L_w_20
L_s_21o:
    s_waitcnt vmcnt(4)
    s_barrier
    s_branch L_s_21
L_p1_cso:
    s_mul_i32 s48, s24, 10240
    s_add_u32 s48, s48, 262144
    v_and_b32 v216, 7, v0
    v_lshlrev_b32 v216, 4, v216
    v_lshrrev_b32 v217, 3, v0
    v_lshl_add_u32 v216, v217, 9, v216
    s_lshl_b32 s39, s22, 7
    v_add_u32 v216, s39, v216
    v_mov_b32 v16, 0
    v_mov_b32 v17, 0
    v_mov_b32 v18, 0
    v_mov_b32 v19, 0
    buffer_load_dwordx4 v[8:11], v216, s[4:7], s48 offen sc1
    s_add_u32 s48, s48, 4096
    buffer_load_dwordx4 v[12:15], v216, s[4:7], s48 offen sc1
    s_add_u32 s48, s48, 4096
    s_mov_b32 exec_hi, 0
    buffer_load_dwordx4 v[16:19], v216, s[4:7], s48 offen sc1
    s_mov_b32 exec_hi, -1
    s_and_b32 s48, s24, 1
    s_mul_i32 s48, s48, 10240
    s_add_u32 s48, s48, 393216
    v_and_b32 v216, 7, v0
    v_lshlrev_b32 v216, 4, v216
    v_lshrrev_b32 v217, 3, v0
    v_lshl_add_u32 v216, v217, 9, v216
    s_lshl_b32 s39, s22, 7
    v_add_u32 v216, s39, v216
    v_mov_b32 v232, 0
    v_mov_b32 v233, 0
    v_mov_b32 v234, 0
    v_mov_b32 v235, 0
    buffer_load_dwordx4 v[224:227], v216, s[4:7], s48 offen sc1
    s_add_u32 s48, s48, 4096
    buffer_load_dwordx4 v[228:231], v216, s[4:7], s48 offen sc1
    s_add_u32 s48, s48, 4096
    s_mov_b32 exec_hi, 0
    buffer_load_dwordx4 v[232:235], v216, s[4:7], s48 offen sc1
    s_mov_b32 exec_hi, -1
    s_branch L_p1_cs
L_p1_c2o:
    s_waitcnt vmcnt(18)
    v_pk_add_f32 v[8:9], v[8:9], v[12:13]
    v_pk_add_f32 v[8:9], v[8:9], v[16:17]
    v_pk_add_f32 v[10:11], v[10:11], v[14:15]
    v_pk_add_f32 v[10:11], v[10:11], v[18:19]
    v_add_f32_dpp v8, v8, v8 row_ror:8 row_mask:0xf bank_mask:0xf
    v_add_f32_dpp v9, v9, v9 row_ror:8 row_mask:0xf bank_mask:0xf
    v_add_f32_dpp v10, v10, v10 row_ror:8 row_mask:0xf bank_mask:0xf
    v_add_f32_dpp v11, v11, v11 row_ror:8 row_mask:0xf bank_mask:0xf
    v_mov_b32 v12, v8
    v_mov_b32 v13, v9
    v_mov_b32 v14, v10
    v_mov_b32 v15, v11
    v_permlane16_swap_b32 v8, v12
    v_permlane16_swap_b32 v9, v13
    v_permlane16_swap_b32 v10, v14
    v_permlane16_swap_b32 v11, v15
    v_add_f32 v8, v8, v12
    v_add_f32 v9, v9, v13
    v_add_f32 v10, v10, v14
    v_add_f32 v11, v11, v15
    v_mov_b32 v12, v8
    v_mov_b32 v13, v9
    v_mov_b32 v14, v10
    v_mov_b32 v15, v11
    v_permlane32_swap_b32 v8, v12
    v_permlane32_swap_b32 v9, v13
    v_permlane32_swap_b32 v10, v14
    v_permlane32_swap_b32 v11, v15
    v_add_f32 v8, v8, v12
    v_add_f32 v9, v9, v13
    v_add_f32 v10, v10, v14
    v_add_f32 v11, v11, v15
    s_lshl_b32 s39, s22, 7
    s_add_u32 s39, s39, 155136
    v_add_u32 v6, s39, v1
    s_mov_b64 exec, 0xff
    ds_write_b128 v6, v[8:11]
    s_mov_b64 exec, -1
    v_pk_add_f32 v[224:225], v[224:225], v[228:229]
    v_pk_add_f32 v[224:225], v[224:225], v[232:233]
    v_pk_add_f32 v[226:227], v[226:227], v[230:231]
    v_pk_add_f32 v[226:227], v[226:227], v[234:235]
    v_add_f32_dpp v224, v224, v224 row_ror:8 row_mask:0xf bank_mask:0xf
    v_add_f32_dpp v225, v225, v225 row_ror:8 row_mask:0xf bank_mask:0xf
    v_add_f32_dpp v226, v226, v226 row_ror:8 row_mask:0xf bank_mask:0xf
    v_add_f32_dpp v227, v227, v227 row_ror:8 row_mask:0xf bank_mask:0xf
    v_mov_b32 v228, v224
    v_mov_b32 v229, v225
    v_mov_b32 v230, v226
    v_mov_b32 v231, v227
    v_permlane16_swap_b32 v224, v228
    v_permlane16_swap_b32 v225, v229
    v_permlane16_swap_b32 v226, v230
    v_permlane16_swap_b32 v227, v231
    v_add_f32 v224, v224, v228
    v_add_f32 v225, v225, v229
    v_add_f32 v226, v226, v230
    v_add_f32 v227, v227, v231
    v_mov_b32 v228, v224
    v_mov_b32 v229, v225
    v_mov_b32 v230, v226
    v_mov_b32 v231, v227
    v_permlane32_swap_b32 v224, v228
    v_permlane32_swap_b32 v225, v229
    v_permlane32_swap_b32 v226, v230
    v_permlane32_swap_b32 v227, v231
    v_add_f32 v224, v224, v228
    v_add_f32 v225, v225, v229
    v_add_f32 v226, v226, v230
    v_add_f32 v227, v227, v231
    s_lshl_b32 s39, s22, 7
    s_add_u32 s39, s39, 155648
    v_add_u32 v6, s39, v1
    s_mov_b64 exec, 0xff
    ds_write_b128 v6, v[224:227]
    s_mov_b64 exec, -1
    s_branch L_p1_c2
.section .rodata,"a"
.p2align 6
.amdhsa_kernel interleave_layers__linear_attn_block__grouped_kv_mqa__prompt_kernel
  .amdhsa_next_free_vgpr 512
  .amdhsa_next_free_sgpr 102
  .amdhsa_accum_offset 256
  .amdhsa_group_segment_fixed_size 0
  .amdhsa_kernarg_size 88
  .amdhsa_user_sgpr_count 2
  .amdhsa_user_sgpr_kernarg_segment_ptr 1
  .amdhsa_system_sgpr_workgroup_id_x 1
  .amdhsa_float_denorm_mode_32 3
.end_amdhsa_kernel
```
